```python
import torch

def _softmax(x, axis=-1):
    return torch.softmax(x, dim=axis)

def _gelu(x):
    return torch.nn.functional.gelu(x, approximate='tanh')

def _silu(x):
    return torch.nn.functional.silu(x)

def _sigmoid(x):
    return torch.sigmoid(x)

def _layernorm(x, axis=-1, eps=1e-05):
    m = x.mean(dim=axis, keepdim=True)
    v = x.var(dim=axis, keepdim=True, unbiased=False)
    return (x - m) / torch.sqrt(v + eps)

def _scatter_add(tgt, idx, src, axis=0):
    return tgt.clone().index_add_(axis, idx, src)

def _segment_sum(src, seg, n):
    out = torch.zeros((n,) + src.shape[1:], dtype=src.dtype)
    return out.index_add_(0, seg, src)

def _pad(x, pw):
    flat = tuple((v for pair in reversed(pw) for v in pair))
    return torch.nn.functional.pad(x, flat)
kernel_name = 'adaLN_cond__sliding_local_dilated__dense_activation_silu__prompt'

def setup_inputs():

    _w = lambda a: (lambda t: t.to(torch.bfloat16) if t.is_floating_point() else t)(torch.as_tensor(a))

    def _A_setup():
        B, S, D = (1, 2048, 640)
        return {'x': _w((lambda *s: torch.randn(*s, dtype=torch.bfloat16) * 0.05)(B, S, D)), 'wqkv': _w((lambda *s: torch.randn(*s, dtype=torch.bfloat16) * 0.05)(D, 3 * D)), 'wo': _w((lambda *s: torch.randn(*s, dtype=torch.bfloat16) * 0.05)(D, D))}
    _A_in = _A_setup()

    def _B_setup():
        B, S, D, F = (1, 2048, 640, 1536)
        return {'x': _w((lambda *s: torch.randn(*s, dtype=torch.bfloat16) * 0.05)(B, S, D)), 'w1': _w((lambda *s: torch.randn(*s, dtype=torch.bfloat16) * 3.2)(D, F) * D ** (-0.5)), 'w2': _w((lambda *s: torch.randn(*s, dtype=torch.bfloat16) * 0.4)(F, D) * F ** (-0.5))}
    _B_in = _B_setup()
    return {'A_x': _A_in['x'], 'A_wqkv': _A_in['wqkv'], 'A_wo': _A_in['wo'], 'B_x': _B_in['x'], 'B_w1': _B_in['w1'], 'B_w2': _B_in['w2'], 'c': _w((lambda *s: torch.randn(*s, dtype=torch.bfloat16) * 0.1)(1, 640) * 8.0), 'w_mod': _w((lambda *s: torch.randn(*s, dtype=torch.bfloat16) * 0.1)(640, 6 * 640) * 640 ** (-0.5) * 8.0)}

def reference(A_x, A_wqkv, A_wo, B_x, B_w1, B_w2, c, w_mod):

    def _A_ref(x, wqkv, wo):
        B, S, D = x.shape
        H = 32
        Dh = D // H
        W, dil = (8, 2)
        qkv = (lambda x, *d: x.permute(*d))((x @ wqkv).reshape(B, S, 3, H, Dh), 2, 0, 3, 1, 4)
        q, k, v = (qkv[0], qkv[1], qkv[2])
        scale = Dh ** (-0.5)
        pos = torch.arange(S)
        off = torch.arange(W) * dil
        idx = pos[:, None] - off[None, :]
        mask = idx >= 0
        idx_c = torch.where(mask, idx, 0).reshape(-1)
        kg = k[:, :, idx_c, :].reshape(B, H, S, W, Dh)
        vg = v[:, :, idx_c, :].reshape(B, H, S, W, Dh)
        logits = torch.einsum('bhsd,bhswd->bhsw', q, kg) * scale
        logits = torch.where(mask[None, None, :, :], logits, -1000000000.0)
        attn = _softmax(logits, axis=-1)
        o = torch.einsum('bhsw,bhswd->bhsd', attn, vg)
        return (lambda x, *d: x.permute(*d))(o, 0, 2, 1, 3).reshape(B, S, D) @ wo

    def _B_ref(x, w1, w2):
        h = torch.einsum('bsd,df->bsf', x, w1)
        h = _silu(h)
        out = torch.einsum('bsf,fd->bsd', h, w2)
        return out
    x = A_x
    mod = (_silu(c) @ w_mod).reshape(c.shape[0], 6, 1, -1)
    sa, ca, ga, sb, cb, gb = (mod[:, 0].clone(), mod[:, 1].clone(), mod[:, 2].clone(), mod[:, 3].clone(), mod[:, 4].clone(), mod[:, 5].clone())
    h = _layernorm(x, axis=-1) * (1 + ca) + sa
    x = x + ga * _A_ref(h, A_wqkv, A_wo)
    h = _layernorm(x, axis=-1) * (1 + cb) + sb
    x = x + gb * _B_ref(h, B_w1, B_w2)
    return x
```

```asm
; @launch grid=(256,1,1) block=(256,1,1) lds=163840
.amdgcn_target "amdgcn-amd-amdhsa--gfx950"
.text
.globl adaLN_cond__sliding_local_dilated__dense_activation_silu__prompt_kernel
.p2align 8
.type adaLN_cond__sliding_local_dilated__dense_activation_silu__prompt_kernel,@function
adaLN_cond__sliding_local_dilated__dense_activation_silu__prompt_kernel:
  s_cmp_ge_u32 s2, 256
  s_cbranch_scc1 EXIT_p0
  s_load_dwordx4 s[36:39], s[0:1], 8
  s_load_dwordx2 s[4:5], s[0:1], 80
  s_load_dwordx2 s[52:53], s[0:1], 48
  s_load_dwordx2 s[56:57], s[0:1], 56
  s_load_dwordx2 s[8:9], s[0:1], 0
  s_load_dwordx2 s[64:65], s[0:1], 40
  s_load_dwordx2 s[68:69], s[0:1], 32
  s_load_dwordx2 s[16:17], s[0:1], 64
  v_lshrrev_b32 v2, 6, v0
  v_and_b32 v0, 63, v0
  v_readfirstlane_b32 s22, v2
  v_and_b32 v1, 15, v0
  v_lshrrev_b32 v2, 4, v0
  s_and_b32 s3, s2, 7
  s_lshr_b32 s21, s2, 5
  s_bfe_u32 s20, s2, 0x20003
  s_lshl2_add_u32 s20, s3, s20
  s_mov_b32 s6, 0x10000000
  s_mov_b32 s7, 0x20000
  s_cmp_ge_u32 s2, 160
  s_cbranch_scc1 FRONT_B
  s_lshl_b32 s47, s22, 13
  s_add_u32 s47, s47, 102400
  s_mov_b32 s71, 0x20000
  v_and_b32 v5, 7, v0
  v_lshlrev_b32 v5, 4, v5
  s_cmp_ge_u32 s2, 120
  s_cbranch_scc1 DEC_WO
  s_mul_i32 s28, s2, 10923
  s_lshr_b32 s28, s28, 16
  s_mul_i32 s29, s28, 6
  s_sub_u32 s29, s2, s29
  s_lshl2_add_u32 s33, s28, s22
  s_mul_i32 s33, s33, 30720
  s_mul_i32 s3, s29, 640
  s_add_u32 s33, s33, s3
  v_lshrrev_b32 v3, 3, v0
  s_movk_i32 s3, 3840
  v_mad_u32_u24 v33, v3, s3, v5
  s_mov_b32 s70, 2457600
DEC_WO_RET:
  s_waitcnt lgkmcnt(0)
  s_cmp_ge_u32 s2, 120
  s_cselect_b64 s[68:69], s[38:39], s[36:37]
  s_and_b32 s69, s69, 0xffff
  s_add_u32 m0, s47, 0
  s_nop 0
  buffer_load_dwordx4 v33, s[68:71], s33 offen offset:0 nt lds
  s_add_u32 m0, s47, 896
  s_nop 0
  buffer_load_dwordx4 v33, s[68:71], s33 offen offset:128 nt lds
  s_add_u32 m0, s47, 1792
  s_nop 0
  buffer_load_dwordx4 v33, s[68:71], s33 offen offset:256 nt lds
  s_add_u32 m0, s47, 2688
  s_nop 0
  buffer_load_dwordx4 v33, s[68:71], s33 offen offset:384 nt lds
  s_add_u32 m0, s47, 3584
  s_nop 0
  buffer_load_dwordx4 v33, s[68:71], s33 offen offset:512 nt lds
  s_and_b32 s5, s5, 0xffff
  s_mov_b32 s3, 294912
  buffer_load_dword v38, off, s[4:7], s3 sc1
  s_branch FRONT_A2
FRONT_B:
  v_lshrrev_b32 v36, 3, v0
  v_and_b32 v37, 7, v0
  v_lshlrev_b32 v37, 4, v37
  s_and_b32 s44, s2, 7
  s_lshl3_add_u32 s44, s21, s44
  s_sub_u32 s44, s44, 40
  s_bfe_u32 s45, s2, 0x20003
  s_lshl2_add_u32 s74, s45, s22
  s_mul_i32 s74, s74, 40
  v_add_u32 v36, s74, v36
  s_movk_i32 s74, 7680
  v_mad_u32_u24 v35, v36, s74, v37
  s_lshl_b32 s74, s44, 7
  v_lshlrev_b32 v36, 1, v36
  s_movk_i32 s54, 1280
  s_mov_b32 s55, 0x20000
  s_mov_b32 s59, 0x20000
  s_mov_b32 s58, 4915200
  s_waitcnt lgkmcnt(0)
  s_and_b32 s53, s53, 0xffff
  s_and_b32 s57, s57, 0xffff
  buffer_load_ushort v28, v36, s[52:55], 0 offen offset:0 sc1
  buffer_load_ushort v29, v36, s[52:55], 0 offen offset:16 sc1
  buffer_load_ushort v30, v36, s[52:55], 0 offen offset:32 sc1
  buffer_load_ushort v31, v36, s[52:55], 0 offen offset:48 sc1
  buffer_load_ushort v32, v36, s[52:55], 0 offen offset:64 sc1
  buffer_load_dwordx4 v[8:11], v35, s[56:59], s74 offen nt
  s_add_u32 s74, s74, 61440
  buffer_load_dwordx4 v[12:15], v35, s[56:59], s74 offen nt
  s_add_u32 s74, s74, 61440
  buffer_load_dwordx4 v[16:19], v35, s[56:59], s74 offen nt
  s_add_u32 s74, s74, 61440
  buffer_load_dwordx4 v[20:23], v35, s[56:59], s74 offen nt
  s_add_u32 s74, s74, 61440
  buffer_load_dwordx4 v[24:27], v35, s[56:59], s74 offen nt
  s_and_b32 s5, s5, 0xffff
  s_mov_b32 s3, 294912
  buffer_load_dword v38, off, s[4:7], s3 sc1
  s_branch FRONT_B2
FRONT_A2:
  s_lshl_b32 s3, s21, 2
  s_mov_b32 s50, 0x21043210
  s_movk_i32 s51, 0x1043
  s_lshr_b64 s[50:51], s[50:51], s3
  s_mov_b32 s73, s50
  s_lshl_b32 s3, s20, 6
  s_mul_i32 s79, s22, 20
  s_add_u32 s3, s3, s79
  s_sub_u32 s3, s3, 16
  s_movk_i32 s51, 1280
  v_add_u32 v244, s3, v2
  v_lshlrev_b32 v39, 4, v1
  s_mov_b32 s10, 2621440
  s_mov_b32 s11, 0x20000
  s_bfe_u32 s3, s73, 0x40000
  v_lshl_add_u32 v3, s3, 2, v244
  v_max_i32 v3, 0, v3
  v_mad_u32_u24 v240, v3, s51, v39
  s_bfe_u32 s3, s73, 0x40004
  v_lshl_add_u32 v3, s3, 2, v244
  v_max_i32 v3, 0, v3
  v_mad_u32_u24 v241, v3, s51, v39
  s_bfe_u32 s3, s73, 0x40008
  v_lshl_add_u32 v3, s3, 2, v244
  v_max_i32 v3, 0, v3
  v_mad_u32_u24 v242, v3, s51, v39
  s_bfe_u32 s3, s73, 0x4000c
  v_lshl_add_u32 v3, s3, 2, v244
  v_max_i32 v3, 0, v3
  v_mad_u32_u24 v243, v3, s51, v39
  s_bfe_u32 s3, s73, 0x40010
  v_lshl_add_u32 v3, s3, 2, v244
  v_max_i32 v3, 0, v3
  v_mad_u32_u24 v244, v3, s51, v39
  s_and_b32 s9, s9, 0xffff
  s_getpc_b64 s[50:51]
PCA:
  s_lshr_b32 s3, s2, 3
  s_lshl2_add_u32 s3, s3, s22
  s_mul_i32 s3, s3, 3
  v_min_u32 v237, 2, v0
  v_add_u32 v237, s3, v237
  v_min_u32 v237, (CODE_END-FRONT_A2-4)/128, v237
  v_lshlrev_b32 v237, 7, v237
  s_add_u32 s50, s50, FRONT_A2-PCA
  s_addc_u32 s51, s51, -1
  v_mov_b32 v239, s51
  v_add_co_u32 v238, vcc, s50, v237
  s_nop 1
  v_addc_co_u32 v239, vcc, 0, v239, vcc
  global_load_dword v237, v[238:239], off sc1
  s_movk_i32 s3, 8192
  v_and_b32 v3, 3, v1
  v_lshlrev_b32 v3, 3, v3
  v_mad_u32_u24 v245, v2, s3, v3
  v_lshrrev_b32 v3, 2, v1
  v_lshl_add_u32 v245, v3, 7, v245
  s_lshl_b32 s3, s22, 5
  s_add_u32 s3, s3, 102400
  v_add_u32 v245, s3, v245
  s_cmp_ge_u32 s2, 120
  s_mov_b32 s34, 1048576
  s_cselect_b32 s34, 4194304, s34
  s_mov_b32 s35, 299008
  s_cselect_b32 s35, 301056, s35
  s_and_b32 s3, s29, 1
  s_mul_i32 s3, s3, 3
  s_lshr_b32 s48, s29, 1
  s_add_u32 s3, s3, s48
  s_mul_i32 s3, s3, 20
  s_add_u32 s3, s3, s28
  s_lshl2_add_u32 s3, s3, s22
  s_lshl2_add_u32 s35, s3, s35
  s_mul_i32 s3, s29, 20
  s_add_u32 s3, s3, s22
  s_mul_i32 s3, s3, 20480
  s_add_u32 s34, s34, s3
  s_lshl_b32 s3, s28, 10
  s_add_u32 s34, s34, s3
  s_mov_b32 s18, 2621440
  s_mov_b32 s19, 0x20000
  s_and_b32 s17, s17, 0xffff
  v_lshlrev_b32 v4, 4, v0
  v_add_u32 v5, 4096, v4
  v_add_u32 v6, 8192, v4
  v_add_u32 v7, 12288, v4
  v_lshrrev_b32 v36, 3, v0
  v_and_b32 v37, 7, v0
  v_lshlrev_b32 v37, 4, v37
  s_and_b32 s29, s2, 7
  s_lshl3_add_u32 s29, s21, s29
  s_add_u32 s29, s29, 24
  s_min_u32 s29, s29, 59
  s_bfe_u32 s30, s2, 0x20003
  s_lshl2_add_u32 s74, s30, s22
  s_mul_i32 s74, s74, 40
  v_add_u32 v36, s74, v36
  s_movk_i32 s74, 7680
  v_mad_u32_u24 v35, v36, s74, v37
  s_lshl_b32 s74, s29, 7
  v_lshlrev_b32 v36, 1, v36
  s_movk_i32 s54, 1280
  s_mov_b32 s55, 0x20000
  s_mov_b32 s59, 0x20000
  s_mov_b32 s58, 4915200
  s_lshl_b32 s29, s29, 10
  s_lshl2_add_u32 s30, s30, s29
  s_add_u32 s30, s30, 16384
  s_waitcnt vmcnt(2)
  s_barrier
  ds_read_b64_tr_b16 a[156:157], v245 offset:0
  ds_read_b64_tr_b16 a[158:159], v245 offset:512
  ds_read_b64_tr_b16 a[160:161], v245 offset:1024
  ds_read_b64_tr_b16 a[162:163], v245 offset:1536
  ds_read_b64_tr_b16 a[164:165], v245 offset:2048
  ds_read_b64_tr_b16 a[166:167], v245 offset:2560
  ds_read_b64_tr_b16 a[168:169], v245 offset:3072
  ds_read_b64_tr_b16 a[170:171], v245 offset:3584
  ds_read_b64_tr_b16 a[172:173], v245 offset:4096
  ds_read_b64_tr_b16 a[174:175], v245 offset:4608
  s_waitcnt lgkmcnt(8)
  buffer_store_dwordx4 a[156:159], v4, s[4:7], s34 offen sc1
  s_add_u32 s34, s34, 81920
  s_waitcnt lgkmcnt(6)
  buffer_store_dwordx4 a[160:163], v4, s[4:7], s34 offen sc1
  s_add_u32 s34, s34, 81920
  s_waitcnt lgkmcnt(4)
  buffer_store_dwordx4 a[164:167], v4, s[4:7], s34 offen sc1
  s_add_u32 s34, s34, 81920
  s_waitcnt lgkmcnt(2)
  buffer_store_dwordx4 a[168:171], v4, s[4:7], s34 offen sc1
  s_add_u32 s34, s34, 81920
  s_waitcnt lgkmcnt(0)
  buffer_store_dwordx4 a[172:175], v4, s[4:7], s34 offen sc1
  s_mov_b32 s62, 0
  buffer_load_dwordx4 v[44:47], v240, s[8:11], 0 offen offset:0
  buffer_load_dwordx4 v[52:55], v240, s[8:11], 0 offen offset:256
  buffer_load_dwordx4 v[60:63], v240, s[8:11], 0 offen offset:512
  buffer_load_dwordx4 v[68:71], v240, s[8:11], 0 offen offset:768
  buffer_load_dwordx4 v[76:79], v240, s[8:11], 0 offen offset:1024
  s_waitcnt vmcnt(11)
  v_readfirstlane_b32 s24, v38
  s_add_u32 s24, s24, 0x9E3779B1
  s_nop 0
  v_mov_b32 v3, s24
  s_waitcnt vmcnt(5)
  buffer_store_dword v3, off, s[4:7], s35 sc1
  s_waitcnt vmcnt(5)
  v_lshlrev_b32 v40, 16, v44
  buffer_load_dwordx4 v[84:87], v241, s[8:11], 0 offen offset:0
  v_and_b32 v41, 0xffff0000, v44
  v_lshlrev_b32 v42, 16, v45
  v_and_b32 v43, 0xffff0000, v45
  v_lshlrev_b32 v44, 16, v46
  v_and_b32 v45, 0xffff0000, v46
  v_lshlrev_b32 v46, 16, v47
  buffer_load_dwordx4 v[92:95], v241, s[8:11], 0 offen offset:256
  v_and_b32 v47, 0xffff0000, v47
  v_pk_mul_f32 v[252:253], v[40:41], v[40:41]
  v_pk_fma_f32 v[252:253], v[42:43], v[42:43], v[252:253]
  v_pk_add_f32 v[250:251], v[40:41], v[42:43]
  v_pk_fma_f32 v[252:253], v[44:45], v[44:45], v[252:253]
  v_pk_add_f32 v[250:251], v[250:251], v[44:45]
  buffer_load_dwordx4 v[100:103], v241, s[8:11], 0 offen offset:512
  v_pk_fma_f32 v[252:253], v[46:47], v[46:47], v[252:253]
  v_pk_add_f32 v[250:251], v[250:251], v[46:47]
  s_waitcnt vmcnt(7)
  v_lshlrev_b32 v48, 16, v52
  v_and_b32 v49, 0xffff0000, v52
  v_lshlrev_b32 v50, 16, v53
  v_and_b32 v51, 0xffff0000, v53
  buffer_load_dwordx4 v[108:111], v241, s[8:11], 0 offen offset:768
  v_lshlrev_b32 v52, 16, v54
  v_and_b32 v53, 0xffff0000, v54
  v_lshlrev_b32 v54, 16, v55
  v_and_b32 v55, 0xffff0000, v55
  v_pk_fma_f32 v[252:253], v[48:49], v[48:49], v[252:253]
  v_pk_add_f32 v[250:251], v[250:251], v[48:49]
  buffer_load_dwordx4 v[116:119], v241, s[8:11], 0 offen offset:1024
  v_pk_fma_f32 v[252:253], v[50:51], v[50:51], v[252:253]
  v_pk_add_f32 v[250:251], v[250:251], v[50:51]
  v_pk_fma_f32 v[252:253], v[52:53], v[52:53], v[252:253]
  v_pk_add_f32 v[250:251], v[250:251], v[52:53]
  v_pk_fma_f32 v[252:253], v[54:55], v[54:55], v[252:253]
  v_pk_add_f32 v[250:251], v[250:251], v[54:55]
  buffer_load_dwordx4 v[124:127], v242, s[8:11], 0 offen offset:0
  s_waitcnt vmcnt(9)
  v_lshlrev_b32 v56, 16, v60
  v_and_b32 v57, 0xffff0000, v60
  v_lshlrev_b32 v58, 16, v61
  v_and_b32 v59, 0xffff0000, v61
  v_lshlrev_b32 v60, 16, v62
  v_and_b32 v61, 0xffff0000, v62
  buffer_load_dwordx4 v[132:135], v242, s[8:11], 0 offen offset:256
  v_lshlrev_b32 v62, 16, v63
  v_and_b32 v63, 0xffff0000, v63
  v_pk_fma_f32 v[252:253], v[56:57], v[56:57], v[252:253]
  v_pk_add_f32 v[250:251], v[250:251], v[56:57]
  v_pk_fma_f32 v[252:253], v[58:59], v[58:59], v[252:253]
  v_pk_add_f32 v[250:251], v[250:251], v[58:59]
  buffer_load_dwordx4 v[140:143], v242, s[8:11], 0 offen offset:512
  v_pk_fma_f32 v[252:253], v[60:61], v[60:61], v[252:253]
  v_pk_add_f32 v[250:251], v[250:251], v[60:61]
  v_pk_fma_f32 v[252:253], v[62:63], v[62:63], v[252:253]
  v_pk_add_f32 v[250:251], v[250:251], v[62:63]
  s_waitcnt vmcnt(10)
  v_lshlrev_b32 v64, 16, v68
  v_and_b32 v65, 0xffff0000, v68
  buffer_load_dwordx4 v[148:151], v242, s[8:11], 0 offen offset:768
  v_lshlrev_b32 v66, 16, v69
  v_and_b32 v67, 0xffff0000, v69
  v_lshlrev_b32 v68, 16, v70
  v_and_b32 v69, 0xffff0000, v70
  v_lshlrev_b32 v70, 16, v71
  v_and_b32 v71, 0xffff0000, v71
  buffer_load_dwordx4 v[156:159], v242, s[8:11], 0 offen offset:1024
  v_pk_fma_f32 v[252:253], v[64:65], v[64:65], v[252:253]
  v_pk_add_f32 v[250:251], v[250:251], v[64:65]
  v_pk_fma_f32 v[252:253], v[66:67], v[66:67], v[252:253]
  v_pk_add_f32 v[250:251], v[250:251], v[66:67]
  v_pk_fma_f32 v[252:253], v[68:69], v[68:69], v[252:253]
  v_pk_add_f32 v[250:251], v[250:251], v[68:69]
  v_pk_fma_f32 v[252:253], v[70:71], v[70:71], v[252:253]
  v_pk_add_f32 v[250:251], v[250:251], v[70:71]
  s_waitcnt vmcnt(11)
  v_lshlrev_b32 v72, 16, v76
  v_and_b32 v73, 0xffff0000, v76
  v_lshlrev_b32 v74, 16, v77
  v_and_b32 v75, 0xffff0000, v77
  v_lshlrev_b32 v76, 16, v78
  v_and_b32 v77, 0xffff0000, v78
  v_lshlrev_b32 v78, 16, v79
  v_and_b32 v79, 0xffff0000, v79
  v_pk_fma_f32 v[252:253], v[72:73], v[72:73], v[252:253]
  v_pk_add_f32 v[250:251], v[250:251], v[72:73]
  v_pk_fma_f32 v[252:253], v[74:75], v[74:75], v[252:253]
  v_pk_add_f32 v[250:251], v[250:251], v[74:75]
  v_pk_fma_f32 v[252:253], v[76:77], v[76:77], v[252:253]
  v_pk_add_f32 v[250:251], v[250:251], v[76:77]
  v_pk_fma_f32 v[252:253], v[78:79], v[78:79], v[252:253]
  v_pk_add_f32 v[250:251], v[250:251], v[78:79]
  v_add_f32 v240, v250, v251
  v_add_f32 v241, v252, v253
  s_waitcnt vmcnt(9)
  v_lshlrev_b32 v80, 16, v84
  buffer_load_dwordx4 v[164:167], v243, s[8:11], 0 offen offset:0
  v_and_b32 v81, 0xffff0000, v84
  v_lshlrev_b32 v82, 16, v85
  buffer_load_dwordx4 v[172:175], v243, s[8:11], 0 offen offset:256
  v_and_b32 v83, 0xffff0000, v85
  v_lshlrev_b32 v84, 16, v86
  v_and_b32 v85, 0xffff0000, v86
  buffer_load_dwordx4 v[180:183], v243, s[8:11], 0 offen offset:512
  v_lshlrev_b32 v86, 16, v87
  v_and_b32 v87, 0xffff0000, v87
  buffer_load_dwordx4 v[188:191], v243, s[8:11], 0 offen offset:768
  v_pk_mul_f32 v[252:253], v[80:81], v[80:81]
  v_pk_fma_f32 v[252:253], v[82:83], v[82:83], v[252:253]
  v_pk_add_f32 v[250:251], v[80:81], v[82:83]
  buffer_load_dwordx4 v[196:199], v243, s[8:11], 0 offen offset:1024
  v_pk_fma_f32 v[252:253], v[84:85], v[84:85], v[252:253]
  v_pk_add_f32 v[250:251], v[250:251], v[84:85]
  buffer_load_dwordx4 v[204:207], v244, s[8:11], 0 offen offset:0
  v_pk_fma_f32 v[252:253], v[86:87], v[86:87], v[252:253]
  v_pk_add_f32 v[250:251], v[250:251], v[86:87]
  s_waitcnt vmcnt(14)
  v_lshlrev_b32 v88, 16, v92
  buffer_load_dwordx4 v[212:215], v244, s[8:11], 0 offen offset:256
  v_and_b32 v89, 0xffff0000, v92
  v_lshlrev_b32 v90, 16, v93
  buffer_load_dwordx4 v[220:223], v244, s[8:11], 0 offen offset:512
  v_and_b32 v91, 0xffff0000, v93
  v_lshlrev_b32 v92, 16, v94
  v_and_b32 v93, 0xffff0000, v94
  buffer_load_dwordx4 v[228:231], v244, s[8:11], 0 offen offset:768
  v_lshlrev_b32 v94, 16, v95
  v_and_b32 v95, 0xffff0000, v95
  buffer_load_dwordx4 v[236:239], v244, s[8:11], 0 offen offset:1024
  v_pk_fma_f32 v[252:253], v[88:89], v[88:89], v[252:253]
  v_pk_add_f32 v[250:251], v[250:251], v[88:89]
  v_pk_fma_f32 v[252:253], v[90:91], v[90:91], v[252:253]
  s_and_b32 s53, s53, 0xffff
  s_and_b32 s57, s57, 0xffff
  v_pk_add_f32 v[250:251], v[250:251], v[90:91]
  v_pk_fma_f32 v[252:253], v[92:93], v[92:93], v[252:253]
  buffer_load_ushort a196, v36, s[52:55], 0 offen offset:0 sc1
  v_pk_add_f32 v[250:251], v[250:251], v[92:93]
  v_pk_fma_f32 v[252:253], v[94:95], v[94:95], v[252:253]
  v_pk_add_f32 v[250:251], v[250:251], v[94:95]
  buffer_load_ushort a197, v36, s[52:55], 0 offen offset:16 sc1
  s_waitcnt vmcnt(19)
  v_lshlrev_b32 v96, 16, v100
  v_and_b32 v97, 0xffff0000, v100
  buffer_load_ushort a198, v36, s[52:55], 0 offen offset:32 sc1
  v_lshlrev_b32 v98, 16, v101
  v_and_b32 v99, 0xffff0000, v101
  v_lshlrev_b32 v100, 16, v102
  buffer_load_ushort a199, v36, s[52:55], 0 offen offset:48 sc1
  v_and_b32 v101, 0xffff0000, v102
  v_lshlrev_b32 v102, 16, v103
  buffer_load_ushort a200, v36, s[52:55], 0 offen offset:64 sc1
  v_and_b32 v103, 0xffff0000, v103
  v_pk_fma_f32 v[252:253], v[96:97], v[96:97], v[252:253]
  v_pk_add_f32 v[250:251], v[250:251], v[96:97]
  v_pk_fma_f32 v[252:253], v[98:99], v[98:99], v[252:253]
  v_pk_add_f32 v[250:251], v[250:251], v[98:99]
  v_pk_fma_f32 v[252:253], v[100:101], v[100:101], v[252:253]
  v_pk_add_f32 v[250:251], v[250:251], v[100:101]
  v_pk_fma_f32 v[252:253], v[102:103], v[102:103], v[252:253]
  v_pk_add_f32 v[250:251], v[250:251], v[102:103]
  s_waitcnt vmcnt(21)
  v_lshlrev_b32 v104, 16, v108
  v_and_b32 v105, 0xffff0000, v108
  v_lshlrev_b32 v106, 16, v109
  v_and_b32 v107, 0xffff0000, v109
  v_lshlrev_b32 v108, 16, v110
  v_and_b32 v109, 0xffff0000, v110
  v_lshlrev_b32 v110, 16, v111
  v_and_b32 v111, 0xffff0000, v111
  v_pk_fma_f32 v[252:253], v[104:105], v[104:105], v[252:253]
  v_pk_add_f32 v[250:251], v[250:251], v[104:105]
  v_pk_fma_f32 v[252:253], v[106:107], v[106:107], v[252:253]
  v_pk_add_f32 v[250:251], v[250:251], v[106:107]
  v_pk_fma_f32 v[252:253], v[108:109], v[108:109], v[252:253]
  v_pk_add_f32 v[250:251], v[250:251], v[108:109]
  v_pk_fma_f32 v[252:253], v[110:111], v[110:111], v[252:253]
  v_pk_add_f32 v[250:251], v[250:251], v[110:111]
  s_waitcnt vmcnt(20)
  v_lshlrev_b32 v112, 16, v116
  v_and_b32 v113, 0xffff0000, v116
  v_lshlrev_b32 v114, 16, v117
  v_and_b32 v115, 0xffff0000, v117
  v_lshlrev_b32 v116, 16, v118
  v_and_b32 v117, 0xffff0000, v118
  v_lshlrev_b32 v118, 16, v119
  v_and_b32 v119, 0xffff0000, v119
  v_pk_fma_f32 v[252:253], v[112:113], v[112:113], v[252:253]
  v_pk_add_f32 v[250:251], v[250:251], v[112:113]
  v_pk_fma_f32 v[252:253], v[114:115], v[114:115], v[252:253]
  v_pk_add_f32 v[250:251], v[250:251], v[114:115]
  v_pk_fma_f32 v[252:253], v[116:117], v[116:117], v[252:253]
  v_pk_add_f32 v[250:251], v[250:251], v[116:117]
  v_pk_fma_f32 v[252:253], v[118:119], v[118:119], v[252:253]
  v_pk_add_f32 v[250:251], v[250:251], v[118:119]
  v_add_f32 v242, v250, v251
  v_add_f32 v243, v252, v253
  v_min_u32 v31, 59, v0
  s_mul_i32 s3, s22, 240
  v_lshl_add_u32 v31, v31, 2, s3
  s_lshr_b32 s50, s21, 2
  s_mul_i32 s50, s50, 960
  s_add_u32 s50, s50, 299008
  s_mul_i32 s49, s22, 5120
  s_add_u32 s49, s49, 16384
  s_min_u32 s52, s2, 239
  s_mul_i32 s28, s52, 13108
  s_lshr_b32 s28, s28, 16
  s_mul_i32 s53, s28, 5
  s_sub_u32 s52, s52, s53
  s_lshl3_add_u32 s63, s52, s22
  s_mul_i32 s63, s63, 49152
  s_lshl_b32 s53, s28, 10
  s_add_u32 s63, s63, s53
  s_add_u32 s63, s63, 7340032
  s_lshl_b32 s52, s52, 8
  v_and_b32 v34, 7, v0
  v_lshlrev_b32 v34, 4, v34
  s_mul_i32 s53, s28, 10923
  s_lshr_b32 s53, s53, 16
  s_mul_i32 s55, s53, 6
  s_sub_u32 s3, s28, s55
  s_lshl_b32 s3, s3, 2
  s_lshr_b32 s53, 0x829630, s3
  s_and_b32 s53, s53, 15
  s_lshl1_add_u32 s53, s55, s53
  s_lshr_b32 s3, 0xb5a741, s3
  s_and_b32 s3, s3, 15
  s_lshl1_add_u32 s55, s55, s3
  s_sub_u32 s55, s55, s53
  s_mul_i32 s55, s55, 20480
  s_lshl2_add_u32 s53, s53, s22
  s_mul_i32 s53, s53, 5120
  s_add_u32 s52, s53, s52
  v_bfe_u32 v3, v0, 3, 2
  s_movk_i32 s3, 1280
  v_mad_u32_u24 v34, v3, s3, v34
  v_lshrrev_b32 v3, 5, v0
  v_mad_u32_u24 v34, v3, s55, v34
  s_mov_b32 s66, 1966080
  s_mov_b32 s67, 0x20000
  s_and_b32 s65, s65, 0xffff
  s_lshl_b32 s53, s22, 11
  s_add_u32 s53, s53, 135168
  s_lshl3_add_u32 s61, s20, s21
  s_and_b32 s3, s22, 1
  s_lshl1_add_u32 s61, s61, s3
  s_mul_i32 s61, s61, 6144
  s_lshr_b32 s3, s22, 1
  s_mul_i32 s3, s3, 3145728
  s_add_u32 s61, s61, s3
  s_add_u32 s61, s61, 9437184
  s_mul_i32 s3, s22, 1280
  s_add_u32 s3, s3, 147456
  v_lshl_add_u32 v30, v0, 2, s3
  s_cmp_ge_u32 s22, 2
  s_cselect_b32 s51, 1.0, 0
  s_mov_b32 s48, s24
  s_waitcnt vmcnt(19)
  v_lshlrev_b32 v120, 16, v124
  buffer_load_dwordx4 a[176:179], v35, s[56:59], s74 offen nt
  v_and_b32 v121, 0xffff0000, v124
  v_lshlrev_b32 v122, 16, v125
  v_and_b32 v123, 0xffff0000, v125
  v_lshlrev_b32 v124, 16, v126
  v_and_b32 v125, 0xffff0000, v126
  v_lshlrev_b32 v126, 16, v127
  v_and_b32 v127, 0xffff0000, v127
  v_pk_mul_f32 v[252:253], v[120:121], v[120:121]
  v_pk_fma_f32 v[252:253], v[122:123], v[122:123], v[252:253]
  v_pk_add_f32 v[250:251], v[120:121], v[122:123]
  s_add_u32 s74, s74, 61440
  buffer_load_dwordx4 a[180:183], v35, s[56:59], s74 offen nt
  v_pk_fma_f32 v[252:253], v[124:125], v[124:125], v[252:253]
  v_pk_add_f32 v[250:251], v[250:251], v[124:125]
  v_pk_fma_f32 v[252:253], v[126:127], v[126:127], v[252:253]
  v_pk_add_f32 v[250:251], v[250:251], v[126:127]
  s_waitcnt vmcnt(20)
  v_lshlrev_b32 v128, 16, v132
  v_and_b32 v129, 0xffff0000, v132
  v_lshlrev_b32 v130, 16, v133
  v_and_b32 v131, 0xffff0000, v133
  v_lshlrev_b32 v132, 16, v134
  v_and_b32 v133, 0xffff0000, v134
  s_add_u32 s74, s74, 61440
  buffer_load_dwordx4 a[184:187], v35, s[56:59], s74 offen nt
  v_lshlrev_b32 v134, 16, v135
  v_and_b32 v135, 0xffff0000, v135
  v_pk_fma_f32 v[252:253], v[128:129], v[128:129], v[252:253]
  v_pk_add_f32 v[250:251], v[250:251], v[128:129]
  v_pk_fma_f32 v[252:253], v[130:131], v[130:131], v[252:253]
  v_pk_add_f32 v[250:251], v[250:251], v[130:131]
  v_pk_fma_f32 v[252:253], v[132:133], v[132:133], v[252:253]
  v_pk_add_f32 v[250:251], v[250:251], v[132:133]
  v_pk_fma_f32 v[252:253], v[134:135], v[134:135], v[252:253]
  v_pk_add_f32 v[250:251], v[250:251], v[134:135]
  s_add_u32 s74, s74, 61440
  buffer_load_dwordx4 a[188:191], v35, s[56:59], s74 offen nt
  s_waitcnt vmcnt(21)
  v_lshlrev_b32 v136, 16, v140
  v_and_b32 v137, 0xffff0000, v140
  v_lshlrev_b32 v138, 16, v141
  v_and_b32 v139, 0xffff0000, v141
  v_lshlrev_b32 v140, 16, v142
  v_and_b32 v141, 0xffff0000, v142
  v_lshlrev_b32 v142, 16, v143
  v_and_b32 v143, 0xffff0000, v143
  v_pk_fma_f32 v[252:253], v[136:137], v[136:137], v[252:253]
  v_pk_add_f32 v[250:251], v[250:251], v[136:137]
  s_add_u32 s74, s74, 61440
  buffer_load_dwordx4 a[192:195], v35, s[56:59], s74 offen nt
  v_pk_fma_f32 v[252:253], v[138:139], v[138:139], v[252:253]
  v_pk_add_f32 v[250:251], v[250:251], v[138:139]
  v_pk_fma_f32 v[252:253], v[140:141], v[140:141], v[252:253]
  v_pk_add_f32 v[250:251], v[250:251], v[140:141]
  v_pk_fma_f32 v[252:253], v[142:143], v[142:143], v[252:253]
  v_pk_add_f32 v[250:251], v[250:251], v[142:143]
  s_waitcnt vmcnt(21)
  v_lshlrev_b32 v144, 16, v148
  v_and_b32 v145, 0xffff0000, v148
  v_lshlrev_b32 v146, 16, v149
  v_and_b32 v147, 0xffff0000, v149
  s_add_u32 m0, s53, 0
  s_nop 0
  buffer_load_dwordx4 v34, s[64:67], s52 offen offset:0 nt lds
  v_lshlrev_b32 v148, 16, v150
  v_and_b32 v149, 0xffff0000, v150
  v_lshlrev_b32 v150, 16, v151
  v_and_b32 v151, 0xffff0000, v151
  v_pk_fma_f32 v[252:253], v[144:145], v[144:145], v[252:253]
  v_pk_add_f32 v[250:251], v[250:251], v[144:145]
  v_pk_fma_f32 v[252:253], v[146:147], v[146:147], v[252:253]
  v_pk_add_f32 v[250:251], v[250:251], v[146:147]
  v_pk_fma_f32 v[252:253], v[148:149], v[148:149], v[252:253]
  v_pk_add_f32 v[250:251], v[250:251], v[148:149]
  s_add_u32 m0, s53, 896
  s_nop 0
  buffer_load_dwordx4 v34, s[64:67], s52 offen offset:128 nt lds
  v_pk_fma_f32 v[252:253], v[150:151], v[150:151], v[252:253]
  v_pk_add_f32 v[250:251], v[250:251], v[150:151]
  s_waitcnt vmcnt(22)
  v_lshlrev_b32 v152, 16, v156
  v_and_b32 v153, 0xffff0000, v156
  v_lshlrev_b32 v154, 16, v157
  v_and_b32 v155, 0xffff0000, v157
  v_lshlrev_b32 v156, 16, v158
  v_and_b32 v157, 0xffff0000, v158
  v_lshlrev_b32 v158, 16, v159
  v_and_b32 v159, 0xffff0000, v159
  v_pk_fma_f32 v[252:253], v[152:153], v[152:153], v[252:253]
  v_pk_add_f32 v[250:251], v[250:251], v[152:153]
  v_pk_fma_f32 v[252:253], v[154:155], v[154:155], v[252:253]
  v_pk_add_f32 v[250:251], v[250:251], v[154:155]
  v_pk_fma_f32 v[252:253], v[156:157], v[156:157], v[252:253]
  v_pk_add_f32 v[250:251], v[250:251], v[156:157]
  v_pk_fma_f32 v[252:253], v[158:159], v[158:159], v[252:253]
  v_pk_add_f32 v[250:251], v[250:251], v[158:159]
  v_add_f32 v244, v250, v251
  v_add_f32 v245, v252, v253
  s_waitcnt vmcnt(21)
  v_lshlrev_b32 v160, 16, v164
  v_and_b32 v161, 0xffff0000, v164
  v_lshlrev_b32 v162, 16, v165
  v_and_b32 v163, 0xffff0000, v165
  v_lshlrev_b32 v164, 16, v166
  v_and_b32 v165, 0xffff0000, v166
  v_lshlrev_b32 v166, 16, v167
  v_and_b32 v167, 0xffff0000, v167
  v_pk_mul_f32 v[252:253], v[160:161], v[160:161]
  v_pk_fma_f32 v[252:253], v[162:163], v[162:163], v[252:253]
  v_pk_add_f32 v[250:251], v[160:161], v[162:163]
  v_pk_fma_f32 v[252:253], v[164:165], v[164:165], v[252:253]
  v_pk_add_f32 v[250:251], v[250:251], v[164:165]
  v_pk_fma_f32 v[252:253], v[166:167], v[166:167], v[252:253]
  v_pk_add_f32 v[250:251], v[250:251], v[166:167]
  s_waitcnt vmcnt(20)
  v_lshlrev_b32 v168, 16, v172
  v_and_b32 v169, 0xffff0000, v172
  v_lshlrev_b32 v170, 16, v173
  v_and_b32 v171, 0xffff0000, v173
  v_lshlrev_b32 v172, 16, v174
  v_and_b32 v173, 0xffff0000, v174
  v_lshlrev_b32 v174, 16, v175
  v_and_b32 v175, 0xffff0000, v175
  v_pk_fma_f32 v[252:253], v[168:169], v[168:169], v[252:253]
  v_pk_add_f32 v[250:251], v[250:251], v[168:169]
  v_pk_fma_f32 v[252:253], v[170:171], v[170:171], v[252:253]
  v_pk_add_f32 v[250:251], v[250:251], v[170:171]
  v_pk_fma_f32 v[252:253], v[172:173], v[172:173], v[252:253]
  v_pk_add_f32 v[250:251], v[250:251], v[172:173]
  v_pk_fma_f32 v[252:253], v[174:175], v[174:175], v[252:253]
  v_pk_add_f32 v[250:251], v[250:251], v[174:175]
  s_waitcnt vmcnt(19)
  v_lshlrev_b32 v176, 16, v180
  v_and_b32 v177, 0xffff0000, v180
  v_lshlrev_b32 v178, 16, v181
  v_and_b32 v179, 0xffff0000, v181
  v_lshlrev_b32 v180, 16, v182
  v_and_b32 v181, 0xffff0000, v182
  v_lshlrev_b32 v182, 16, v183
  v_and_b32 v183, 0xffff0000, v183
  v_pk_fma_f32 v[252:253], v[176:177], v[176:177], v[252:253]
  v_pk_add_f32 v[250:251], v[250:251], v[176:177]
  v_pk_fma_f32 v[252:253], v[178:179], v[178:179], v[252:253]
  v_pk_add_f32 v[250:251], v[250:251], v[178:179]
  v_pk_fma_f32 v[252:253], v[180:181], v[180:181], v[252:253]
  v_pk_add_f32 v[250:251], v[250:251], v[180:181]
  v_pk_fma_f32 v[252:253], v[182:183], v[182:183], v[252:253]
  v_pk_add_f32 v[250:251], v[250:251], v[182:183]
  s_waitcnt vmcnt(18)
  v_lshlrev_b32 v184, 16, v188
  v_and_b32 v185, 0xffff0000, v188
  v_lshlrev_b32 v186, 16, v189
  v_and_b32 v187, 0xffff0000, v189
  v_lshlrev_b32 v188, 16, v190
  v_and_b32 v189, 0xffff0000, v190
  v_lshlrev_b32 v190, 16, v191
  v_and_b32 v191, 0xffff0000, v191
  v_pk_fma_f32 v[252:253], v[184:185], v[184:185], v[252:253]
  v_pk_add_f32 v[250:251], v[250:251], v[184:185]
  v_pk_fma_f32 v[252:253], v[186:187], v[186:187], v[252:253]
  v_pk_add_f32 v[250:251], v[250:251], v[186:187]
  v_pk_fma_f32 v[252:253], v[188:189], v[188:189], v[252:253]
  v_pk_add_f32 v[250:251], v[250:251], v[188:189]
  v_pk_fma_f32 v[252:253], v[190:191], v[190:191], v[252:253]
  v_pk_add_f32 v[250:251], v[250:251], v[190:191]
  s_waitcnt vmcnt(17)
  v_lshlrev_b32 v192, 16, v196
  v_and_b32 v193, 0xffff0000, v196
  v_lshlrev_b32 v194, 16, v197
  v_and_b32 v195, 0xffff0000, v197
  v_lshlrev_b32 v196, 16, v198
  v_and_b32 v197, 0xffff0000, v198
  v_lshlrev_b32 v198, 16, v199
  v_and_b32 v199, 0xffff0000, v199
  v_pk_fma_f32 v[252:253], v[192:193], v[192:193], v[252:253]
  v_pk_add_f32 v[250:251], v[250:251], v[192:193]
  v_pk_fma_f32 v[252:253], v[194:195], v[194:195], v[252:253]
  v_pk_add_f32 v[250:251], v[250:251], v[194:195]
  v_pk_fma_f32 v[252:253], v[196:197], v[196:197], v[252:253]
  v_pk_add_f32 v[250:251], v[250:251], v[196:197]
  v_pk_fma_f32 v[252:253], v[198:199], v[198:199], v[252:253]
  v_pk_add_f32 v[250:251], v[250:251], v[198:199]
  v_add_f32 v246, v250, v251
  v_add_f32 v247, v252, v253
  s_waitcnt vmcnt(16)
  v_lshlrev_b32 v200, 16, v204
  v_and_b32 v201, 0xffff0000, v204
  v_lshlrev_b32 v202, 16, v205
  v_and_b32 v203, 0xffff0000, v205
  v_lshlrev_b32 v204, 16, v206
  v_and_b32 v205, 0xffff0000, v206
  v_lshlrev_b32 v206, 16, v207
  v_and_b32 v207, 0xffff0000, v207
  v_pk_mul_f32 v[252:253], v[200:201], v[200:201]
  v_pk_fma_f32 v[252:253], v[202:203], v[202:203], v[252:253]
  v_pk_add_f32 v[250:251], v[200:201], v[202:203]
  v_pk_fma_f32 v[252:253], v[204:205], v[204:205], v[252:253]
  v_pk_add_f32 v[250:251], v[250:251], v[204:205]
  v_pk_fma_f32 v[252:253], v[206:207], v[206:207], v[252:253]
  v_pk_add_f32 v[250:251], v[250:251], v[206:207]
  s_waitcnt vmcnt(15)
  v_lshlrev_b32 v208, 16, v212
  v_and_b32 v209, 0xffff0000, v212
  v_lshlrev_b32 v210, 16, v213
  v_and_b32 v211, 0xffff0000, v213
  v_lshlrev_b32 v212, 16, v214
  v_and_b32 v213, 0xffff0000, v214
  v_lshlrev_b32 v214, 16, v215
  v_and_b32 v215, 0xffff0000, v215
  v_pk_fma_f32 v[252:253], v[208:209], v[208:209], v[252:253]
  v_pk_add_f32 v[250:251], v[250:251], v[208:209]
  v_pk_fma_f32 v[252:253], v[210:211], v[210:211], v[252:253]
  v_pk_add_f32 v[250:251], v[250:251], v[210:211]
  v_pk_fma_f32 v[252:253], v[212:213], v[212:213], v[252:253]
  v_pk_add_f32 v[250:251], v[250:251], v[212:213]
  v_pk_fma_f32 v[252:253], v[214:215], v[214:215], v[252:253]
  v_pk_add_f32 v[250:251], v[250:251], v[214:215]
  s_waitcnt vmcnt(14)
  v_lshlrev_b32 v216, 16, v220
  v_and_b32 v217, 0xffff0000, v220
  v_lshlrev_b32 v218, 16, v221
  v_and_b32 v219, 0xffff0000, v221
  v_lshlrev_b32 v220, 16, v222
  v_and_b32 v221, 0xffff0000, v222
  v_lshlrev_b32 v222, 16, v223
  v_and_b32 v223, 0xffff0000, v223
  v_pk_fma_f32 v[252:253], v[216:217], v[216:217], v[252:253]
  v_pk_add_f32 v[250:251], v[250:251], v[216:217]
  v_pk_fma_f32 v[252:253], v[218:219], v[218:219], v[252:253]
  v_pk_add_f32 v[250:251], v[250:251], v[218:219]
  v_pk_fma_f32 v[252:253], v[220:221], v[220:221], v[252:253]
  v_pk_add_f32 v[250:251], v[250:251], v[220:221]
  v_pk_fma_f32 v[252:253], v[222:223], v[222:223], v[252:253]
  v_pk_add_f32 v[250:251], v[250:251], v[222:223]
  s_waitcnt vmcnt(13)
  v_lshlrev_b32 v224, 16, v228
  v_and_b32 v225, 0xffff0000, v228
  v_lshlrev_b32 v226, 16, v229
  v_and_b32 v227, 0xffff0000, v229
  v_lshlrev_b32 v228, 16, v230
  v_and_b32 v229, 0xffff0000, v230
  v_lshlrev_b32 v230, 16, v231
  v_and_b32 v231, 0xffff0000, v231
  v_pk_fma_f32 v[252:253], v[224:225], v[224:225], v[252:253]
  v_pk_add_f32 v[250:251], v[250:251], v[224:225]
  v_pk_fma_f32 v[252:253], v[226:227], v[226:227], v[252:253]
  v_pk_add_f32 v[250:251], v[250:251], v[226:227]
  v_pk_fma_f32 v[252:253], v[228:229], v[228:229], v[252:253]
  v_pk_add_f32 v[250:251], v[250:251], v[228:229]
  v_pk_fma_f32 v[252:253], v[230:231], v[230:231], v[252:253]
  v_pk_add_f32 v[250:251], v[250:251], v[230:231]
  s_waitcnt vmcnt(12)
  v_lshlrev_b32 v232, 16, v236
  v_and_b32 v233, 0xffff0000, v236
  v_lshlrev_b32 v234, 16, v237
  v_and_b32 v235, 0xffff0000, v237
  v_lshlrev_b32 v236, 16, v238
  v_and_b32 v237, 0xffff0000, v238
  v_lshlrev_b32 v238, 16, v239
  v_and_b32 v239, 0xffff0000, v239
  v_pk_fma_f32 v[252:253], v[232:233], v[232:233], v[252:253]
  v_pk_add_f32 v[250:251], v[250:251], v[232:233]
  v_pk_fma_f32 v[252:253], v[234:235], v[234:235], v[252:253]
  v_pk_add_f32 v[250:251], v[250:251], v[234:235]
  v_pk_fma_f32 v[252:253], v[236:237], v[236:237], v[252:253]
  v_pk_add_f32 v[250:251], v[250:251], v[236:237]
  v_pk_fma_f32 v[252:253], v[238:239], v[238:239], v[252:253]
  buffer_load_dwordx4 v[8:11], v4, s[4:7], s49 offen offset:0 sc1
  buffer_load_dwordx4 v[12:15], v4, s[4:7], s49 offen offset:1024 sc1
  buffer_load_dwordx4 v[16:19], v4, s[4:7], s49 offen offset:2048 sc1
  buffer_load_dwordx4 v[20:23], v4, s[4:7], s49 offen offset:3072 sc1
  buffer_load_dwordx4 v[24:27], v5, s[4:7], s49 offen offset:0 sc1
  buffer_load_dword v28, v31, s[4:7], s50 offen sc1 sc0
  v_pk_add_f32 v[250:251], v[250:251], v[238:239]
  v_add_f32 v248, v250, v251
  v_add_f32 v249, v252, v253
  v_add_f32_dpp v240, v240, v240 row_ror:8 row_mask:0xf bank_mask:0xf
  v_add_f32_dpp v241, v241, v241 row_ror:8 row_mask:0xf bank_mask:0xf
  v_add_f32_dpp v242, v242, v242 row_ror:8 row_mask:0xf bank_mask:0xf
  v_add_f32_dpp v243, v243, v243 row_ror:8 row_mask:0xf bank_mask:0xf
  v_add_f32_dpp v244, v244, v244 row_ror:8 row_mask:0xf bank_mask:0xf
  v_add_f32_dpp v245, v245, v245 row_ror:8 row_mask:0xf bank_mask:0xf
  v_add_f32_dpp v246, v246, v246 row_ror:8 row_mask:0xf bank_mask:0xf
  v_add_f32_dpp v247, v247, v247 row_ror:8 row_mask:0xf bank_mask:0xf
  v_add_f32_dpp v248, v248, v248 row_ror:8 row_mask:0xf bank_mask:0xf
  v_add_f32_dpp v249, v249, v249 row_ror:8 row_mask:0xf bank_mask:0xf
  v_add_f32_dpp v240, v240, v240 row_ror:4 row_mask:0xf bank_mask:0xf
  v_add_f32_dpp v241, v241, v241 row_ror:4 row_mask:0xf bank_mask:0xf
  v_add_f32_dpp v242, v242, v242 row_ror:4 row_mask:0xf bank_mask:0xf
  v_add_f32_dpp v243, v243, v243 row_ror:4 row_mask:0xf bank_mask:0xf
  v_add_f32_dpp v244, v244, v244 row_ror:4 row_mask:0xf bank_mask:0xf
  v_add_f32_dpp v245, v245, v245 row_ror:4 row_mask:0xf bank_mask:0xf
  v_add_f32_dpp v246, v246, v246 row_ror:4 row_mask:0xf bank_mask:0xf
  v_add_f32_dpp v247, v247, v247 row_ror:4 row_mask:0xf bank_mask:0xf
  v_add_f32_dpp v248, v248, v248 row_ror:4 row_mask:0xf bank_mask:0xf
  v_add_f32_dpp v249, v249, v249 row_ror:4 row_mask:0xf bank_mask:0xf
  v_add_f32_dpp v240, v240, v240 row_ror:2 row_mask:0xf bank_mask:0xf
  v_add_f32_dpp v241, v241, v241 row_ror:2 row_mask:0xf bank_mask:0xf
  v_add_f32_dpp v242, v242, v242 row_ror:2 row_mask:0xf bank_mask:0xf
  v_add_f32_dpp v243, v243, v243 row_ror:2 row_mask:0xf bank_mask:0xf
  v_add_f32_dpp v244, v244, v244 row_ror:2 row_mask:0xf bank_mask:0xf
  v_add_f32_dpp v245, v245, v245 row_ror:2 row_mask:0xf bank_mask:0xf
  v_add_f32_dpp v246, v246, v246 row_ror:2 row_mask:0xf bank_mask:0xf
  v_add_f32_dpp v247, v247, v247 row_ror:2 row_mask:0xf bank_mask:0xf
  v_add_f32_dpp v248, v248, v248 row_ror:2 row_mask:0xf bank_mask:0xf
  v_add_f32_dpp v249, v249, v249 row_ror:2 row_mask:0xf bank_mask:0xf
  v_add_f32_dpp v240, v240, v240 row_ror:1 row_mask:0xf bank_mask:0xf
  v_add_f32_dpp v241, v241, v241 row_ror:1 row_mask:0xf bank_mask:0xf
  v_add_f32_dpp v242, v242, v242 row_ror:1 row_mask:0xf bank_mask:0xf
  v_add_f32_dpp v243, v243, v243 row_ror:1 row_mask:0xf bank_mask:0xf
  v_add_f32_dpp v244, v244, v244 row_ror:1 row_mask:0xf bank_mask:0xf
  v_add_f32_dpp v245, v245, v245 row_ror:1 row_mask:0xf bank_mask:0xf
  v_add_f32_dpp v246, v246, v246 row_ror:1 row_mask:0xf bank_mask:0xf
  v_add_f32_dpp v247, v247, v247 row_ror:1 row_mask:0xf bank_mask:0xf
  v_add_f32_dpp v248, v248, v248 row_ror:1 row_mask:0xf bank_mask:0xf
  v_add_f32_dpp v249, v249, v249 row_ror:1 row_mask:0xf bank_mask:0xf
  s_mov_b32 s60, 0x3acccccd
  v_mov_b32 v3, 0x3727c5ac
  v_mul_f32 v250, s60, v240
  v_mul_f32 v251, s60, v242
  v_mul_f32 v252, s60, v244
  v_mul_f32 v253, s60, v246
  v_mul_f32 v254, s60, v248
  v_fma_f32 v241, v241, s60, v3
  v_fma_f32 v243, v243, s60, v3
  v_fma_f32 v245, v245, s60, v3
  v_fma_f32 v247, v247, s60, v3
  v_fma_f32 v249, v249, s60, v3
  v_fma_f32 v241, -v250, v250, v241
  v_fma_f32 v243, -v251, v251, v243
  v_fma_f32 v245, -v252, v252, v245
  v_fma_f32 v247, -v253, v253, v247
  v_fma_f32 v249, -v254, v254, v249
  v_max_f32 v241, v241, v3
  v_max_f32 v243, v243, v3
  v_max_f32 v245, v245, v3
  v_max_f32 v247, v247, v3
  v_max_f32 v249, v249, v3
  v_rsq_f32 v240, v241
  v_rsq_f32 v242, v243
  v_rsq_f32 v244, v245
  v_rsq_f32 v246, v247
  v_rsq_f32 v248, v249
  v_mul_f32 v241, -v250, v240
  v_mul_f32 v243, -v251, v242
  v_mul_f32 v245, -v252, v244
  v_mul_f32 v247, -v253, v246
  v_mul_f32 v249, -v254, v248
  v_pk_fma_f32 v[40:41], v[40:41], v[240:241], v[240:241] op_sel:[0,0,1] op_sel_hi:[1,0,1]
  v_pk_fma_f32 v[42:43], v[42:43], v[240:241], v[240:241] op_sel:[0,0,1] op_sel_hi:[1,0,1]
  v_pk_fma_f32 v[44:45], v[44:45], v[240:241], v[240:241] op_sel:[0,0,1] op_sel_hi:[1,0,1]
  v_pk_fma_f32 v[46:47], v[46:47], v[240:241], v[240:241] op_sel:[0,0,1] op_sel_hi:[1,0,1]
  v_pk_fma_f32 v[48:49], v[48:49], v[240:241], v[240:241] op_sel:[0,0,1] op_sel_hi:[1,0,1]
  v_pk_fma_f32 v[50:51], v[50:51], v[240:241], v[240:241] op_sel:[0,0,1] op_sel_hi:[1,0,1]
  v_pk_fma_f32 v[52:53], v[52:53], v[240:241], v[240:241] op_sel:[0,0,1] op_sel_hi:[1,0,1]
  v_pk_fma_f32 v[54:55], v[54:55], v[240:241], v[240:241] op_sel:[0,0,1] op_sel_hi:[1,0,1]
  v_pk_fma_f32 v[56:57], v[56:57], v[240:241], v[240:241] op_sel:[0,0,1] op_sel_hi:[1,0,1]
  v_pk_fma_f32 v[58:59], v[58:59], v[240:241], v[240:241] op_sel:[0,0,1] op_sel_hi:[1,0,1]
  v_pk_fma_f32 v[60:61], v[60:61], v[240:241], v[240:241] op_sel:[0,0,1] op_sel_hi:[1,0,1]
  v_pk_fma_f32 v[62:63], v[62:63], v[240:241], v[240:241] op_sel:[0,0,1] op_sel_hi:[1,0,1]
  v_pk_fma_f32 v[64:65], v[64:65], v[240:241], v[240:241] op_sel:[0,0,1] op_sel_hi:[1,0,1]
  v_pk_fma_f32 v[66:67], v[66:67], v[240:241], v[240:241] op_sel:[0,0,1] op_sel_hi:[1,0,1]
  v_pk_fma_f32 v[68:69], v[68:69], v[240:241], v[240:241] op_sel:[0,0,1] op_sel_hi:[1,0,1]
  v_pk_fma_f32 v[70:71], v[70:71], v[240:241], v[240:241] op_sel:[0,0,1] op_sel_hi:[1,0,1]
  v_pk_fma_f32 v[72:73], v[72:73], v[240:241], v[240:241] op_sel:[0,0,1] op_sel_hi:[1,0,1]
  v_pk_fma_f32 v[74:75], v[74:75], v[240:241], v[240:241] op_sel:[0,0,1] op_sel_hi:[1,0,1]
  v_pk_fma_f32 v[76:77], v[76:77], v[240:241], v[240:241] op_sel:[0,0,1] op_sel_hi:[1,0,1]
  v_pk_fma_f32 v[78:79], v[78:79], v[240:241], v[240:241] op_sel:[0,0,1] op_sel_hi:[1,0,1]
  v_pk_fma_f32 v[80:81], v[80:81], v[242:243], v[242:243] op_sel:[0,0,1] op_sel_hi:[1,0,1]
  v_pk_fma_f32 v[82:83], v[82:83], v[242:243], v[242:243] op_sel:[0,0,1] op_sel_hi:[1,0,1]
  v_pk_fma_f32 v[84:85], v[84:85], v[242:243], v[242:243] op_sel:[0,0,1] op_sel_hi:[1,0,1]
  v_pk_fma_f32 v[86:87], v[86:87], v[242:243], v[242:243] op_sel:[0,0,1] op_sel_hi:[1,0,1]
  v_pk_fma_f32 v[88:89], v[88:89], v[242:243], v[242:243] op_sel:[0,0,1] op_sel_hi:[1,0,1]
  v_pk_fma_f32 v[90:91], v[90:91], v[242:243], v[242:243] op_sel:[0,0,1] op_sel_hi:[1,0,1]
  v_pk_fma_f32 v[92:93], v[92:93], v[242:243], v[242:243] op_sel:[0,0,1] op_sel_hi:[1,0,1]
  v_pk_fma_f32 v[94:95], v[94:95], v[242:243], v[242:243] op_sel:[0,0,1] op_sel_hi:[1,0,1]
  v_pk_fma_f32 v[96:97], v[96:97], v[242:243], v[242:243] op_sel:[0,0,1] op_sel_hi:[1,0,1]
  v_pk_fma_f32 v[98:99], v[98:99], v[242:243], v[242:243] op_sel:[0,0,1] op_sel_hi:[1,0,1]
  v_pk_fma_f32 v[100:101], v[100:101], v[242:243], v[242:243] op_sel:[0,0,1] op_sel_hi:[1,0,1]
  v_pk_fma_f32 v[102:103], v[102:103], v[242:243], v[242:243] op_sel:[0,0,1] op_sel_hi:[1,0,1]
  v_pk_fma_f32 v[104:105], v[104:105], v[242:243], v[242:243] op_sel:[0,0,1] op_sel_hi:[1,0,1]
  v_pk_fma_f32 v[106:107], v[106:107], v[242:243], v[242:243] op_sel:[0,0,1] op_sel_hi:[1,0,1]
  v_pk_fma_f32 v[108:109], v[108:109], v[242:243], v[242:243] op_sel:[0,0,1] op_sel_hi:[1,0,1]
  v_pk_fma_f32 v[110:111], v[110:111], v[242:243], v[242:243] op_sel:[0,0,1] op_sel_hi:[1,0,1]
  v_pk_fma_f32 v[112:113], v[112:113], v[242:243], v[242:243] op_sel:[0,0,1] op_sel_hi:[1,0,1]
  v_pk_fma_f32 v[114:115], v[114:115], v[242:243], v[242:243] op_sel:[0,0,1] op_sel_hi:[1,0,1]
  v_pk_fma_f32 v[116:117], v[116:117], v[242:243], v[242:243] op_sel:[0,0,1] op_sel_hi:[1,0,1]
  v_pk_fma_f32 v[118:119], v[118:119], v[242:243], v[242:243] op_sel:[0,0,1] op_sel_hi:[1,0,1]
  v_pk_fma_f32 v[120:121], v[120:121], v[244:245], v[244:245] op_sel:[0,0,1] op_sel_hi:[1,0,1]
  v_pk_fma_f32 v[122:123], v[122:123], v[244:245], v[244:245] op_sel:[0,0,1] op_sel_hi:[1,0,1]
  v_pk_fma_f32 v[124:125], v[124:125], v[244:245], v[244:245] op_sel:[0,0,1] op_sel_hi:[1,0,1]
  v_pk_fma_f32 v[126:127], v[126:127], v[244:245], v[244:245] op_sel:[0,0,1] op_sel_hi:[1,0,1]
  v_pk_fma_f32 v[128:129], v[128:129], v[244:245], v[244:245] op_sel:[0,0,1] op_sel_hi:[1,0,1]
  v_pk_fma_f32 v[130:131], v[130:131], v[244:245], v[244:245] op_sel:[0,0,1] op_sel_hi:[1,0,1]
  v_pk_fma_f32 v[132:133], v[132:133], v[244:245], v[244:245] op_sel:[0,0,1] op_sel_hi:[1,0,1]
  v_pk_fma_f32 v[134:135], v[134:135], v[244:245], v[244:245] op_sel:[0,0,1] op_sel_hi:[1,0,1]
  v_pk_fma_f32 v[136:137], v[136:137], v[244:245], v[244:245] op_sel:[0,0,1] op_sel_hi:[1,0,1]
  v_pk_fma_f32 v[138:139], v[138:139], v[244:245], v[244:245] op_sel:[0,0,1] op_sel_hi:[1,0,1]
  v_pk_fma_f32 v[140:141], v[140:141], v[244:245], v[244:245] op_sel:[0,0,1] op_sel_hi:[1,0,1]
  v_pk_fma_f32 v[142:143], v[142:143], v[244:245], v[244:245] op_sel:[0,0,1] op_sel_hi:[1,0,1]
  v_pk_fma_f32 v[144:145], v[144:145], v[244:245], v[244:245] op_sel:[0,0,1] op_sel_hi:[1,0,1]
  v_pk_fma_f32 v[146:147], v[146:147], v[244:245], v[244:245] op_sel:[0,0,1] op_sel_hi:[1,0,1]
  v_pk_fma_f32 v[148:149], v[148:149], v[244:245], v[244:245] op_sel:[0,0,1] op_sel_hi:[1,0,1]
  v_pk_fma_f32 v[150:151], v[150:151], v[244:245], v[244:245] op_sel:[0,0,1] op_sel_hi:[1,0,1]
  v_pk_fma_f32 v[152:153], v[152:153], v[244:245], v[244:245] op_sel:[0,0,1] op_sel_hi:[1,0,1]
  v_pk_fma_f32 v[154:155], v[154:155], v[244:245], v[244:245] op_sel:[0,0,1] op_sel_hi:[1,0,1]
  v_pk_fma_f32 v[156:157], v[156:157], v[244:245], v[244:245] op_sel:[0,0,1] op_sel_hi:[1,0,1]
  v_pk_fma_f32 v[158:159], v[158:159], v[244:245], v[244:245] op_sel:[0,0,1] op_sel_hi:[1,0,1]
  v_pk_fma_f32 v[160:161], v[160:161], v[246:247], v[246:247] op_sel:[0,0,1] op_sel_hi:[1,0,1]
  v_pk_fma_f32 v[162:163], v[162:163], v[246:247], v[246:247] op_sel:[0,0,1] op_sel_hi:[1,0,1]
  v_pk_fma_f32 v[164:165], v[164:165], v[246:247], v[246:247] op_sel:[0,0,1] op_sel_hi:[1,0,1]
  v_pk_fma_f32 v[166:167], v[166:167], v[246:247], v[246:247] op_sel:[0,0,1] op_sel_hi:[1,0,1]
  v_pk_fma_f32 v[168:169], v[168:169], v[246:247], v[246:247] op_sel:[0,0,1] op_sel_hi:[1,0,1]
  v_pk_fma_f32 v[170:171], v[170:171], v[246:247], v[246:247] op_sel:[0,0,1] op_sel_hi:[1,0,1]
  v_pk_fma_f32 v[172:173], v[172:173], v[246:247], v[246:247] op_sel:[0,0,1] op_sel_hi:[1,0,1]
  v_pk_fma_f32 v[174:175], v[174:175], v[246:247], v[246:247] op_sel:[0,0,1] op_sel_hi:[1,0,1]
  v_pk_fma_f32 v[176:177], v[176:177], v[246:247], v[246:247] op_sel:[0,0,1] op_sel_hi:[1,0,1]
  v_pk_fma_f32 v[178:179], v[178:179], v[246:247], v[246:247] op_sel:[0,0,1] op_sel_hi:[1,0,1]
  v_pk_fma_f32 v[180:181], v[180:181], v[246:247], v[246:247] op_sel:[0,0,1] op_sel_hi:[1,0,1]
  v_pk_fma_f32 v[182:183], v[182:183], v[246:247], v[246:247] op_sel:[0,0,1] op_sel_hi:[1,0,1]
  v_pk_fma_f32 v[184:185], v[184:185], v[246:247], v[246:247] op_sel:[0,0,1] op_sel_hi:[1,0,1]
  v_pk_fma_f32 v[186:187], v[186:187], v[246:247], v[246:247] op_sel:[0,0,1] op_sel_hi:[1,0,1]
  v_pk_fma_f32 v[188:189], v[188:189], v[246:247], v[246:247] op_sel:[0,0,1] op_sel_hi:[1,0,1]
  v_pk_fma_f32 v[190:191], v[190:191], v[246:247], v[246:247] op_sel:[0,0,1] op_sel_hi:[1,0,1]
  v_pk_fma_f32 v[192:193], v[192:193], v[246:247], v[246:247] op_sel:[0,0,1] op_sel_hi:[1,0,1]
  v_pk_fma_f32 v[194:195], v[194:195], v[246:247], v[246:247] op_sel:[0,0,1] op_sel_hi:[1,0,1]
  v_pk_fma_f32 v[196:197], v[196:197], v[246:247], v[246:247] op_sel:[0,0,1] op_sel_hi:[1,0,1]
  v_pk_fma_f32 v[198:199], v[198:199], v[246:247], v[246:247] op_sel:[0,0,1] op_sel_hi:[1,0,1]
  v_pk_fma_f32 v[200:201], v[200:201], v[248:249], v[248:249] op_sel:[0,0,1] op_sel_hi:[1,0,1]
  v_pk_fma_f32 v[202:203], v[202:203], v[248:249], v[248:249] op_sel:[0,0,1] op_sel_hi:[1,0,1]
  v_pk_fma_f32 v[204:205], v[204:205], v[248:249], v[248:249] op_sel:[0,0,1] op_sel_hi:[1,0,1]
  v_pk_fma_f32 v[206:207], v[206:207], v[248:249], v[248:249] op_sel:[0,0,1] op_sel_hi:[1,0,1]
  v_pk_fma_f32 v[208:209], v[208:209], v[248:249], v[248:249] op_sel:[0,0,1] op_sel_hi:[1,0,1]
  v_pk_fma_f32 v[210:211], v[210:211], v[248:249], v[248:249] op_sel:[0,0,1] op_sel_hi:[1,0,1]
  v_pk_fma_f32 v[212:213], v[212:213], v[248:249], v[248:249] op_sel:[0,0,1] op_sel_hi:[1,0,1]
  v_pk_fma_f32 v[214:215], v[214:215], v[248:249], v[248:249] op_sel:[0,0,1] op_sel_hi:[1,0,1]
  v_pk_fma_f32 v[216:217], v[216:217], v[248:249], v[248:249] op_sel:[0,0,1] op_sel_hi:[1,0,1]
  v_pk_fma_f32 v[218:219], v[218:219], v[248:249], v[248:249] op_sel:[0,0,1] op_sel_hi:[1,0,1]
  v_pk_fma_f32 v[220:221], v[220:221], v[248:249], v[248:249] op_sel:[0,0,1] op_sel_hi:[1,0,1]
  v_pk_fma_f32 v[222:223], v[222:223], v[248:249], v[248:249] op_sel:[0,0,1] op_sel_hi:[1,0,1]
  v_pk_fma_f32 v[224:225], v[224:225], v[248:249], v[248:249] op_sel:[0,0,1] op_sel_hi:[1,0,1]
  v_pk_fma_f32 v[226:227], v[226:227], v[248:249], v[248:249] op_sel:[0,0,1] op_sel_hi:[1,0,1]
  v_pk_fma_f32 v[228:229], v[228:229], v[248:249], v[248:249] op_sel:[0,0,1] op_sel_hi:[1,0,1]
  v_pk_fma_f32 v[230:231], v[230:231], v[248:249], v[248:249] op_sel:[0,0,1] op_sel_hi:[1,0,1]
  v_pk_fma_f32 v[232:233], v[232:233], v[248:249], v[248:249] op_sel:[0,0,1] op_sel_hi:[1,0,1]
  v_pk_fma_f32 v[234:235], v[234:235], v[248:249], v[248:249] op_sel:[0,0,1] op_sel_hi:[1,0,1]
  v_pk_fma_f32 v[236:237], v[236:237], v[248:249], v[248:249] op_sel:[0,0,1] op_sel_hi:[1,0,1]
  v_pk_fma_f32 v[238:239], v[238:239], v[248:249], v[248:249] op_sel:[0,0,1] op_sel_hi:[1,0,1]
  v_lshrrev_b32 v3, 2, v1
  v_lshlrev_b32 v3, 10, v3
  v_and_b32 v33, 3, v1
  v_lshl_add_u32 v3, v33, 8, v3
  v_and_b32 v33, 7, v1
  s_movk_i32 s52, 20480
  v_add_u32 v35, s79, v2
  s_bfe_u32 s3, s73, 0x40000
  v_lshl_add_u32 v36, s3, 2, v35
  v_and_b32 v37, 15, v36
  v_xor_b32 v37, v37, v33
  v_lshrrev_b32 v36, 4, v36
  v_mad_u32_u24 v36, v36, s52, v3
  v_lshl_add_u32 v250, v37, 4, v36
  s_bfe_u32 s3, s73, 0x40004
  v_lshl_add_u32 v36, s3, 2, v35
  v_and_b32 v37, 15, v36
  v_xor_b32 v37, v37, v33
  v_lshrrev_b32 v36, 4, v36
  v_mad_u32_u24 v36, v36, s52, v3
  v_lshl_add_u32 v251, v37, 4, v36
  s_bfe_u32 s3, s73, 0x40008
  v_lshl_add_u32 v36, s3, 2, v35
  v_and_b32 v37, 15, v36
  v_xor_b32 v37, v37, v33
  v_lshrrev_b32 v36, 4, v36
  v_mad_u32_u24 v36, v36, s52, v3
  v_lshl_add_u32 v252, v37, 4, v36
  s_bfe_u32 s3, s73, 0x4000c
  v_lshl_add_u32 v36, s3, 2, v35
  v_and_b32 v37, 15, v36
  v_xor_b32 v37, v37, v33
  v_lshrrev_b32 v36, 4, v36
  v_mad_u32_u24 v36, v36, s52, v3
  v_lshl_add_u32 v253, v37, 4, v36
  s_bfe_u32 s3, s73, 0x40010
  v_lshl_add_u32 v36, s3, 2, v35
  v_and_b32 v37, 15, v36
  v_xor_b32 v37, v37, v33
  v_lshrrev_b32 v36, 4, v36
  v_mad_u32_u24 v36, v36, s52, v3
  v_lshl_add_u32 v254, v37, 4, v36
  v_lshlrev_b32 v255, 5, v1
  v_add_u32 v255, 147456, v255
  s_mul_i32 s52, s21, 5
  s_add_u32 s53, s52, s22
  s_add_u32 s32, s53, 40
  s_add_u32 s33, s53, 80
  s_mov_b32 s35, s53
  s_lshl_b32 s54, s22, 3
  s_lshr_b32 s34, 0x04542c, s54
  s_and_b32 s34, s34, 0xff
  s_add_u32 s34, s34, s52
  s_mul_i32 s32, s32, 20480
  s_add_u32 s32, s32, 1048576
  s_mul_i32 s33, s33, 20480
  s_add_u32 s33, s33, 1048576
  s_mul_i32 s34, s34, 20480
  s_add_u32 s34, s34, 1048576
  s_mul_i32 s35, s35, 20480
  s_add_u32 s35, s35, 1048576
  s_mov_b64 s[12:13], s[4:5]
  s_cmp_eq_u32 s22, 3
  s_cselect_b32 s14, 0, s6
  s_mov_b32 s15, 0x20000
  s_waitcnt vmcnt(0)
JOIN:
  v_xor_b32 v29, s48, v8
  v_bitop3_b32 v29, v29, s48, v9 bitop3:0xf6
  v_bitop3_b32 v29, v29, s48, v10 bitop3:0xf6
  v_bitop3_b32 v29, v29, s48, v11 bitop3:0xf6
  v_bitop3_b32 v29, v29, s48, v12 bitop3:0xf6
  v_bitop3_b32 v29, v29, s48, v13 bitop3:0xf6
  v_bitop3_b32 v29, v29, s48, v14 bitop3:0xf6
  v_bitop3_b32 v29, v29, s48, v15 bitop3:0xf6
  v_bitop3_b32 v29, v29, s48, v16 bitop3:0xf6
  v_bitop3_b32 v29, v29, s48, v17 bitop3:0xf6
  v_bitop3_b32 v29, v29, s48, v18 bitop3:0xf6
  v_bitop3_b32 v29, v29, s48, v19 bitop3:0xf6
  v_bitop3_b32 v29, v29, s48, v20 bitop3:0xf6
  v_bitop3_b32 v29, v29, s48, v21 bitop3:0xf6
  v_bitop3_b32 v29, v29, s48, v22 bitop3:0xf6
  v_bitop3_b32 v29, v29, s48, v23 bitop3:0xf6
  v_bitop3_b32 v29, v29, s48, v24 bitop3:0xf6
  v_bitop3_b32 v29, v29, s48, v25 bitop3:0xf6
  v_bitop3_b32 v29, v29, s48, v26 bitop3:0xf6
  v_bitop3_b32 v29, v29, s48, v27 bitop3:0xf6
  v_lshlrev_b32 v29, 22, v29
  v_cmp_eq_u32 vcc, 0, v29
  s_nop 3
  s_cmp_eq_u64 vcc, -1
  s_cbranch_scc0 MSPIN
MDONE:
  v_and_b32 v8, 0xfffffc00, v8
  v_and_b32 v9, 0xfffffc00, v9
  v_and_b32 v10, 0xfffffc00, v10
  v_and_b32 v11, 0xfffffc00, v11
  v_and_b32 v12, 0xfffffc00, v12
  v_and_b32 v13, 0xfffffc00, v13
  v_and_b32 v14, 0xfffffc00, v14
  v_and_b32 v15, 0xfffffc00, v15
  v_and_b32 v16, 0xfffffc00, v16
  v_and_b32 v17, 0xfffffc00, v17
  v_and_b32 v18, 0xfffffc00, v18
  v_and_b32 v19, 0xfffffc00, v19
  v_and_b32 v20, 0xfffffc00, v20
  v_and_b32 v21, 0xfffffc00, v21
  v_and_b32 v22, 0xfffffc00, v22
  v_and_b32 v23, 0xfffffc00, v23
  v_and_b32 v24, 0xfffffc00, v24
  v_and_b32 v25, 0xfffffc00, v25
  v_and_b32 v26, 0xfffffc00, v26
  v_and_b32 v27, 0xfffffc00, v27
  v_pk_add_f32 v[8:9], v[8:9], v[10:11]
  v_pk_add_f32 v[12:13], v[12:13], v[14:15]
  v_pk_add_f32 v[16:17], v[16:17], v[18:19]
  v_pk_add_f32 v[20:21], v[20:21], v[22:23]
  v_pk_add_f32 v[24:25], v[24:25], v[26:27]
  v_add_f32 v8, v8, v9
  v_add_f32 v12, v12, v13
  v_add_f32 v16, v16, v17
  v_add_f32 v20, v20, v21
  v_add_f32 v24, v24, v25
  v_cvt_pk_bf16_f32 v8, 0, v8
  v_cvt_pk_bf16_f32 v12, 0, v12
  v_cvt_pk_bf16_f32 v16, 0, v16
  v_cvt_pk_bf16_f32 v20, 0, v20
  v_cvt_pk_bf16_f32 v24, 0, v24
  v_add_f32 v8, s51, v8
  v_add_f32 v12, s51, v12
  v_add_f32 v16, s51, v16
  v_add_f32 v20, s51, v20
  v_add_f32 v24, s51, v24
  v_cvt_pk_bf16_f32 v8, 0, v8
  v_cvt_pk_bf16_f32 v12, 0, v12
  v_cvt_pk_bf16_f32 v16, 0, v16
  v_cvt_pk_bf16_f32 v20, 0, v20
  v_cvt_pk_bf16_f32 v24, 0, v24
  v_cmp_eq_u32 vcc, s24, v28
  ds_write_b32 v30, v8 offset:0
  ds_write_b32 v30, v12 offset:256
  ds_write_b32 v30, v16 offset:512
  ds_write_b32 v30, v20 offset:768
  ds_write_b32 v30, v24 offset:1024
  s_cmp_eq_u64 vcc, -1
  s_cbranch_scc0 FASPIN
FADONE:
  s_mul_i32 s36, s21, 102400
  s_mul_i32 s3, s22, 5120
  s_add_u32 s36, s36, s3
  s_add_u32 s36, s36, 4194304
  s_waitcnt lgkmcnt(0)
  s_barrier
  ds_read_b128 v[8:11], v255 offset:0
  buffer_load_dwordx4 a[32:35], v4, s[4:7], s32 offen offset:2048 sc1
  ds_read_b128 v[16:19], v255 offset:2560
  ds_read_b128 v[12:15], v255 offset:16
  ds_read_b128 v[20:23], v255 offset:2576
  buffer_load_dwordx4 a[0:3], v4, s[4:7], s32 offen offset:0 sc1
  buffer_load_dwordx4 a[4:7], v4, s[4:7], s33 offen offset:0 sc1
  buffer_load_dwordx4 a[8:11], v4, s[12:15], s34 offen offset:0 sc1
  buffer_load_dwordx4 a[12:15], v4, s[4:7], s35 offen offset:0 sc1
  buffer_load_dwordx4 a[16:19], v4, s[4:7], s32 offen offset:1024 sc1
  buffer_load_dwordx4 a[20:23], v4, s[4:7], s33 offen offset:1024 sc1
  buffer_load_dwordx4 a[24:27], v4, s[12:15], s34 offen offset:1024 sc1
  buffer_load_dwordx4 a[28:31], v4, s[4:7], s35 offen offset:1024 sc1
  buffer_load_dwordx4 a[36:39], v4, s[4:7], s33 offen offset:2048 sc1
  ds_read_b128 v[24:27], v255 offset:512
  ds_read_b128 v[32:35], v255 offset:3072
  ds_read_b128 v[28:31], v255 offset:528
  ds_read_b128 v[36:39], v255 offset:3088
  s_waitcnt lgkmcnt(6)
  v_pk_fma_f32 v[40:41], v[40:41], v[16:17], v[8:9]
  v_pk_fma_f32 v[42:43], v[42:43], v[18:19], v[10:11]
  s_waitcnt lgkmcnt(4)
  v_pk_fma_f32 v[44:45], v[44:45], v[20:21], v[12:13]
  v_pk_fma_f32 v[46:47], v[46:47], v[22:23], v[14:15]
  v_cvt_pk_bf16_f32 v40, v40, v41
  v_cvt_pk_bf16_f32 v41, v42, v43
  v_cvt_pk_bf16_f32 v42, v44, v45
  v_cvt_pk_bf16_f32 v43, v46, v47
  buffer_load_dwordx4 a[40:43], v4, s[12:15], s34 offen offset:2048 sc1
  ds_write_b128 v250, v[40:43] offset:0
  v_pk_fma_f32 v[80:81], v[80:81], v[16:17], v[8:9]
  v_pk_fma_f32 v[82:83], v[82:83], v[18:19], v[10:11]
  v_pk_fma_f32 v[84:85], v[84:85], v[20:21], v[12:13]
  v_pk_fma_f32 v[86:87], v[86:87], v[22:23], v[14:15]
  v_cvt_pk_bf16_f32 v80, v80, v81
  v_cvt_pk_bf16_f32 v81, v82, v83
  v_cvt_pk_bf16_f32 v82, v84, v85
  v_cvt_pk_bf16_f32 v83, v86, v87
  ds_write_b128 v251, v[80:83] offset:0
  v_pk_fma_f32 v[120:121], v[120:121], v[16:17], v[8:9]
  buffer_load_dwordx4 a[44:47], v4, s[4:7], s35 offen offset:2048 sc1
  v_pk_fma_f32 v[122:123], v[122:123], v[18:19], v[10:11]
  v_pk_fma_f32 v[124:125], v[124:125], v[20:21], v[12:13]
  v_pk_fma_f32 v[126:127], v[126:127], v[22:23], v[14:15]
  v_cvt_pk_bf16_f32 v120, v120, v121
  v_cvt_pk_bf16_f32 v121, v122, v123
  v_cvt_pk_bf16_f32 v122, v124, v125
  v_cvt_pk_bf16_f32 v123, v126, v127
  ds_write_b128 v252, v[120:123] offset:0
  v_pk_fma_f32 v[160:161], v[160:161], v[16:17], v[8:9]
  v_pk_fma_f32 v[162:163], v[162:163], v[18:19], v[10:11]
  v_pk_fma_f32 v[164:165], v[164:165], v[20:21], v[12:13]
  v_pk_fma_f32 v[166:167], v[166:167], v[22:23], v[14:15]
  buffer_load_dwordx4 a[48:51], v4, s[4:7], s32 offen offset:3072 sc1
  v_cvt_pk_bf16_f32 v160, v160, v161
  v_cvt_pk_bf16_f32 v161, v162, v163
  v_cvt_pk_bf16_f32 v162, v164, v165
  v_cvt_pk_bf16_f32 v163, v166, v167
  ds_write_b128 v253, v[160:163] offset:0
  v_pk_fma_f32 v[200:201], v[200:201], v[16:17], v[8:9]
  v_pk_fma_f32 v[202:203], v[202:203], v[18:19], v[10:11]
  v_pk_fma_f32 v[204:205], v[204:205], v[20:21], v[12:13]
  v_pk_fma_f32 v[206:207], v[206:207], v[22:23], v[14:15]
  v_cvt_pk_bf16_f32 v200, v200, v201
  v_cvt_pk_bf16_f32 v201, v202, v203
  v_cvt_pk_bf16_f32 v202, v204, v205
  buffer_load_dwordx4 a[52:55], v4, s[4:7], s33 offen offset:3072 sc1
  v_cvt_pk_bf16_f32 v203, v206, v207
  ds_write_b128 v254, v[200:203] offset:0
  ds_read_b128 v[8:11], v255 offset:1024
  ds_read_b128 v[16:19], v255 offset:3584
  ds_read_b128 v[12:15], v255 offset:1040
  ds_read_b128 v[20:23], v255 offset:3600
  s_waitcnt lgkmcnt(11)
  v_pk_fma_f32 v[48:49], v[48:49], v[32:33], v[24:25]
  v_pk_fma_f32 v[50:51], v[50:51], v[34:35], v[26:27]
  s_waitcnt lgkmcnt(9)
  v_pk_fma_f32 v[52:53], v[52:53], v[36:37], v[28:29]
  v_pk_fma_f32 v[54:55], v[54:55], v[38:39], v[30:31]
  v_cvt_pk_bf16_f32 v48, v48, v49
  buffer_load_dwordx4 a[56:59], v4, s[12:15], s34 offen offset:3072 sc1
  v_cvt_pk_bf16_f32 v49, v50, v51
  v_cvt_pk_bf16_f32 v50, v52, v53
  v_cvt_pk_bf16_f32 v51, v54, v55
  ds_write_b128 v250, v[48:51] offset:4096
  v_pk_fma_f32 v[88:89], v[88:89], v[32:33], v[24:25]
  v_pk_fma_f32 v[90:91], v[90:91], v[34:35], v[26:27]
  v_pk_fma_f32 v[92:93], v[92:93], v[36:37], v[28:29]
  v_pk_fma_f32 v[94:95], v[94:95], v[38:39], v[30:31]
  v_cvt_pk_bf16_f32 v88, v88, v89
  v_cvt_pk_bf16_f32 v89, v90, v91
  v_cvt_pk_bf16_f32 v90, v92, v93
  v_cvt_pk_bf16_f32 v91, v94, v95
  buffer_load_dwordx4 a[60:63], v4, s[4:7], s35 offen offset:3072 sc1
  ds_write_b128 v251, v[88:91] offset:4096
  v_pk_fma_f32 v[128:129], v[128:129], v[32:33], v[24:25]
  v_pk_fma_f32 v[130:131], v[130:131], v[34:35], v[26:27]
  v_pk_fma_f32 v[132:133], v[132:133], v[36:37], v[28:29]
  v_pk_fma_f32 v[134:135], v[134:135], v[38:39], v[30:31]
  v_cvt_pk_bf16_f32 v128, v128, v129
  v_cvt_pk_bf16_f32 v129, v130, v131
  v_cvt_pk_bf16_f32 v130, v132, v133
  v_cvt_pk_bf16_f32 v131, v134, v135
  ds_write_b128 v252, v[128:131] offset:4096
  v_pk_fma_f32 v[168:169], v[168:169], v[32:33], v[24:25]
  v_pk_fma_f32 v[170:171], v[170:171], v[34:35], v[26:27]
  buffer_load_dwordx4 a[64:67], v5, s[4:7], s32 offen offset:0 sc1
  v_pk_fma_f32 v[172:173], v[172:173], v[36:37], v[28:29]
  v_pk_fma_f32 v[174:175], v[174:175], v[38:39], v[30:31]
  v_cvt_pk_bf16_f32 v168, v168, v169
  v_cvt_pk_bf16_f32 v169, v170, v171
  v_cvt_pk_bf16_f32 v170, v172, v173
  v_cvt_pk_bf16_f32 v171, v174, v175
  ds_write_b128 v253, v[168:171] offset:4096
  v_pk_fma_f32 v[208:209], v[208:209], v[32:33], v[24:25]
  v_pk_fma_f32 v[210:211], v[210:211], v[34:35], v[26:27]
  v_pk_fma_f32 v[212:213], v[212:213], v[36:37], v[28:29]
  v_pk_fma_f32 v[214:215], v[214:215], v[38:39], v[30:31]
  buffer_load_dwordx4 a[68:71], v5, s[4:7], s33 offen offset:0 sc1
  v_cvt_pk_bf16_f32 v208, v208, v209
  v_cvt_pk_bf16_f32 v209, v210, v211
  v_cvt_pk_bf16_f32 v210, v212, v213
  v_cvt_pk_bf16_f32 v211, v214, v215
  ds_write_b128 v254, v[208:211] offset:4096
  ds_read_b128 v[24:27], v255 offset:1536
  ds_read_b128 v[32:35], v255 offset:4096
  ds_read_b128 v[28:31], v255 offset:1552
  ds_read_b128 v[36:39], v255 offset:4112
  s_waitcnt lgkmcnt(11)
  v_pk_fma_f32 v[56:57], v[56:57], v[16:17], v[8:9]
  v_pk_fma_f32 v[58:59], v[58:59], v[18:19], v[10:11]
  s_waitcnt lgkmcnt(9)
  v_pk_fma_f32 v[60:61], v[60:61], v[20:21], v[12:13]
  buffer_load_dwordx4 a[72:75], v5, s[12:15], s34 offen offset:0 sc1
  v_pk_fma_f32 v[62:63], v[62:63], v[22:23], v[14:15]
  v_cvt_pk_bf16_f32 v56, v56, v57
  v_cvt_pk_bf16_f32 v57, v58, v59
  v_cvt_pk_bf16_f32 v58, v60, v61
  v_cvt_pk_bf16_f32 v59, v62, v63
  ds_write_b128 v250, v[56:59] offset:8192
  v_pk_fma_f32 v[96:97], v[96:97], v[16:17], v[8:9]
  v_pk_fma_f32 v[98:99], v[98:99], v[18:19], v[10:11]
  v_pk_fma_f32 v[100:101], v[100:101], v[20:21], v[12:13]
  v_pk_fma_f32 v[102:103], v[102:103], v[22:23], v[14:15]
  v_cvt_pk_bf16_f32 v96, v96, v97
  v_cvt_pk_bf16_f32 v97, v98, v99
  buffer_load_dwordx4 a[76:79], v5, s[4:7], s35 offen offset:0 sc1
  v_cvt_pk_bf16_f32 v98, v100, v101
  v_cvt_pk_bf16_f32 v99, v102, v103
  ds_write_b128 v251, v[96:99] offset:8192
  v_pk_fma_f32 v[136:137], v[136:137], v[16:17], v[8:9]
  v_pk_fma_f32 v[138:139], v[138:139], v[18:19], v[10:11]
  v_pk_fma_f32 v[140:141], v[140:141], v[20:21], v[12:13]
  v_pk_fma_f32 v[142:143], v[142:143], v[22:23], v[14:15]
  v_cvt_pk_bf16_f32 v136, v136, v137
  v_cvt_pk_bf16_f32 v137, v138, v139
  v_cvt_pk_bf16_f32 v138, v140, v141
  v_cvt_pk_bf16_f32 v139, v142, v143
  buffer_load_dwordx4 a[80:83], v5, s[4:7], s32 offen offset:1024 sc1
  ds_write_b128 v252, v[136:139] offset:8192
  v_pk_fma_f32 v[176:177], v[176:177], v[16:17], v[8:9]
  v_pk_fma_f32 v[178:179], v[178:179], v[18:19], v[10:11]
  v_pk_fma_f32 v[180:181], v[180:181], v[20:21], v[12:13]
  v_pk_fma_f32 v[182:183], v[182:183], v[22:23], v[14:15]
  v_cvt_pk_bf16_f32 v176, v176, v177
  v_cvt_pk_bf16_f32 v177, v178, v179
  v_cvt_pk_bf16_f32 v178, v180, v181
  v_cvt_pk_bf16_f32 v179, v182, v183
  ds_write_b128 v253, v[176:179] offset:8192
  v_pk_fma_f32 v[216:217], v[216:217], v[16:17], v[8:9]
  v_pk_fma_f32 v[218:219], v[218:219], v[18:19], v[10:11]
  buffer_load_dwordx4 a[84:87], v5, s[4:7], s33 offen offset:1024 sc1
  v_pk_fma_f32 v[220:221], v[220:221], v[20:21], v[12:13]
  v_pk_fma_f32 v[222:223], v[222:223], v[22:23], v[14:15]
  v_cvt_pk_bf16_f32 v216, v216, v217
  v_cvt_pk_bf16_f32 v217, v218, v219
  v_cvt_pk_bf16_f32 v218, v220, v221
  v_cvt_pk_bf16_f32 v219, v222, v223
  ds_write_b128 v254, v[216:219] offset:8192
  ds_read_b128 v[8:11], v255 offset:2048
  ds_read_b128 v[16:19], v255 offset:4608
  ds_read_b128 v[12:15], v255 offset:2064
  ds_read_b128 v[20:23], v255 offset:4624
  s_waitcnt lgkmcnt(11)
  v_pk_fma_f32 v[64:65], v[64:65], v[32:33], v[24:25]
  buffer_load_dwordx4 a[88:91], v5, s[12:15], s34 offen offset:1024 sc1
  v_pk_fma_f32 v[66:67], v[66:67], v[34:35], v[26:27]
  s_waitcnt lgkmcnt(9)
  v_pk_fma_f32 v[68:69], v[68:69], v[36:37], v[28:29]
  v_pk_fma_f32 v[70:71], v[70:71], v[38:39], v[30:31]
  v_cvt_pk_bf16_f32 v64, v64, v65
  v_cvt_pk_bf16_f32 v65, v66, v67
  v_cvt_pk_bf16_f32 v66, v68, v69
  v_cvt_pk_bf16_f32 v67, v70, v71
  ds_write_b128 v250, v[64:67] offset:12288
  v_pk_fma_f32 v[104:105], v[104:105], v[32:33], v[24:25]
  v_pk_fma_f32 v[106:107], v[106:107], v[34:35], v[26:27]
  v_pk_fma_f32 v[108:109], v[108:109], v[36:37], v[28:29]
  buffer_load_dwordx4 a[92:95], v5, s[4:7], s35 offen offset:1024 sc1
  v_pk_fma_f32 v[110:111], v[110:111], v[38:39], v[30:31]
  v_cvt_pk_bf16_f32 v104, v104, v105
  v_cvt_pk_bf16_f32 v105, v106, v107
  v_cvt_pk_bf16_f32 v106, v108, v109
  v_cvt_pk_bf16_f32 v107, v110, v111
  ds_write_b128 v251, v[104:107] offset:12288
  v_pk_fma_f32 v[144:145], v[144:145], v[32:33], v[24:25]
  v_pk_fma_f32 v[146:147], v[146:147], v[34:35], v[26:27]
  v_pk_fma_f32 v[148:149], v[148:149], v[36:37], v[28:29]
  v_pk_fma_f32 v[150:151], v[150:151], v[38:39], v[30:31]
  v_cvt_pk_bf16_f32 v144, v144, v145
  v_cvt_pk_bf16_f32 v145, v146, v147
  buffer_load_dwordx4 a[96:99], v5, s[4:7], s32 offen offset:2048 sc1
  v_cvt_pk_bf16_f32 v146, v148, v149
  v_cvt_pk_bf16_f32 v147, v150, v151
  ds_write_b128 v252, v[144:147] offset:12288
  v_pk_fma_f32 v[184:185], v[184:185], v[32:33], v[24:25]
  v_pk_fma_f32 v[186:187], v[186:187], v[34:35], v[26:27]
  v_pk_fma_f32 v[188:189], v[188:189], v[36:37], v[28:29]
  v_pk_fma_f32 v[190:191], v[190:191], v[38:39], v[30:31]
  v_cvt_pk_bf16_f32 v184, v184, v185
  v_cvt_pk_bf16_f32 v185, v186, v187
  v_cvt_pk_bf16_f32 v186, v188, v189
  v_cvt_pk_bf16_f32 v187, v190, v191
  ds_write_b128 v253, v[184:187] offset:12288
  buffer_load_dwordx4 a[100:103], v5, s[4:7], s33 offen offset:2048 sc1
  v_pk_fma_f32 v[224:225], v[224:225], v[32:33], v[24:25]
  v_pk_fma_f32 v[226:227], v[226:227], v[34:35], v[26:27]
  v_pk_fma_f32 v[228:229], v[228:229], v[36:37], v[28:29]
  v_pk_fma_f32 v[230:231], v[230:231], v[38:39], v[30:31]
  v_cvt_pk_bf16_f32 v224, v224, v225
  v_cvt_pk_bf16_f32 v225, v226, v227
  v_cvt_pk_bf16_f32 v226, v228, v229
  v_cvt_pk_bf16_f32 v227, v230, v231
  ds_write_b128 v254, v[224:227] offset:12288
  s_waitcnt lgkmcnt(7)
  v_pk_fma_f32 v[72:73], v[72:73], v[16:17], v[8:9]
  v_pk_fma_f32 v[74:75], v[74:75], v[18:19], v[10:11]
  buffer_load_dwordx4 a[104:107], v5, s[12:15], s34 offen offset:2048 sc1
  s_waitcnt lgkmcnt(5)
  v_pk_fma_f32 v[76:77], v[76:77], v[20:21], v[12:13]
  v_pk_fma_f32 v[78:79], v[78:79], v[22:23], v[14:15]
  v_cvt_pk_bf16_f32 v72, v72, v73
  v_cvt_pk_bf16_f32 v73, v74, v75
  v_cvt_pk_bf16_f32 v74, v76, v77
  v_cvt_pk_bf16_f32 v75, v78, v79
  ds_write_b128 v250, v[72:75] offset:16384
  v_pk_fma_f32 v[112:113], v[112:113], v[16:17], v[8:9]
  v_pk_fma_f32 v[114:115], v[114:115], v[18:19], v[10:11]
  v_pk_fma_f32 v[116:117], v[116:117], v[20:21], v[12:13]
  v_pk_fma_f32 v[118:119], v[118:119], v[22:23], v[14:15]
  v_cvt_pk_bf16_f32 v112, v112, v113
  buffer_load_dwordx4 a[108:111], v5, s[4:7], s35 offen offset:2048 sc1
  v_cvt_pk_bf16_f32 v113, v114, v115
  v_cvt_pk_bf16_f32 v114, v116, v117
  v_cvt_pk_bf16_f32 v115, v118, v119
  ds_write_b128 v251, v[112:115] offset:16384
  v_pk_fma_f32 v[152:153], v[152:153], v[16:17], v[8:9]
  v_pk_fma_f32 v[154:155], v[154:155], v[18:19], v[10:11]
  v_pk_fma_f32 v[156:157], v[156:157], v[20:21], v[12:13]
  v_pk_fma_f32 v[158:159], v[158:159], v[22:23], v[14:15]
  v_cvt_pk_bf16_f32 v152, v152, v153
  v_cvt_pk_bf16_f32 v153, v154, v155
  v_cvt_pk_bf16_f32 v154, v156, v157
  v_cvt_pk_bf16_f32 v155, v158, v159
  ds_write_b128 v252, v[152:155] offset:16384
  v_pk_fma_f32 v[192:193], v[192:193], v[16:17], v[8:9]
  v_pk_fma_f32 v[194:195], v[194:195], v[18:19], v[10:11]
  v_pk_fma_f32 v[196:197], v[196:197], v[20:21], v[12:13]
  v_pk_fma_f32 v[198:199], v[198:199], v[22:23], v[14:15]
  v_cvt_pk_bf16_f32 v192, v192, v193
  v_cvt_pk_bf16_f32 v193, v194, v195
  v_cvt_pk_bf16_f32 v194, v196, v197
  v_cvt_pk_bf16_f32 v195, v198, v199
  ds_write_b128 v253, v[192:195] offset:16384
  v_pk_fma_f32 v[232:233], v[232:233], v[16:17], v[8:9]
  v_pk_fma_f32 v[234:235], v[234:235], v[18:19], v[10:11]
  v_pk_fma_f32 v[236:237], v[236:237], v[20:21], v[12:13]
  v_pk_fma_f32 v[238:239], v[238:239], v[22:23], v[14:15]
  v_cvt_pk_bf16_f32 v232, v232, v233
  v_cvt_pk_bf16_f32 v233, v234, v235
  v_cvt_pk_bf16_f32 v234, v236, v237
  v_cvt_pk_bf16_f32 v235, v238, v239
  ds_write_b128 v254, v[232:235] offset:16384
  v_min_u32 v250, 19, v0
  s_mul_i32 s3, s22, 80
  s_add_u32 s3, s3, s50
  v_lshl_add_u32 v250, v250, 2, s3
  s_getreg_b32 s3, hwreg(HW_REG_XCC_ID)
  s_and_b32 s3, s3, 15
  s_add_u32 s25, s24, s3
  s_lshl3_add_u32 s50, s20, s21
  s_lshl2_add_u32 s50, s50, 303104
  s_cmp_eq_u32 s22, 0
  s_cselect_b32 s3, 0, 0x80000000
  v_mov_b32 v248, s25
  v_mov_b32 v249, s3
  v_add_u32 v8, 16384, v4
  v_and_b32 v9, 7, v0
  v_lshlrev_b32 v9, 2, v9
  v_xor_b32 v3, v1, v2
  v_lshlrev_b32 v20, 8, v2
  v_lshl_add_u32 v20, v3, 4, v20
  v_xor_b32 v21, 64, v20
  v_add_u32 v22, 61440, v20
  v_add_u32 v23, 61440, v21
  s_waitcnt lgkmcnt(0)
  s_barrier
  ds_read_b128 v[116:119], v20 offset:0
  ds_read_b128 v[120:123], v20 offset:20480
  ds_read_b128 v[124:127], v20 offset:40960
  ds_read_b128 v[128:131], v22 offset:0
  ds_read_b128 v[132:135], v22 offset:20480
  s_waitcnt vmcnt(26) lgkmcnt(4)
  v_mfma_f32_16x16x32_bf16 v[40:43], a[0:3], v[116:119], 0
  s_movk_i32 s55, 8192
  ds_read_b128 v[136:139], v21 offset:1024
  s_waitcnt vmcnt(25)
  v_mfma_f32_16x16x32_bf16 v[60:63], a[4:7], v[116:119], 0
  v_and_b32 v203, 3, v1
  s_waitcnt vmcnt(24)
  v_mfma_f32_16x16x32_bf16 v[80:83], a[8:11], v[116:119], 0
  ds_read_b128 v[140:143], v21 offset:21504
  s_waitcnt lgkmcnt(5)
  v_mfma_f32_16x16x32_bf16 v[44:47], a[0:3], v[120:123], 0
  v_lshlrev_b32 v203, 3, v203
  v_mad_u32_u24 v253, v2, s55, v203
  v_mfma_f32_16x16x32_bf16 v[64:67], a[4:7], v[120:123], 0
  ds_read_b128 v[144:147], v21 offset:41984
  v_mfma_f32_16x16x32_bf16 v[84:87], a[8:11], v[120:123], 0
  v_lshrrev_b32 v203, 2, v1
  s_waitcnt vmcnt(23)
  v_mfma_f32_16x16x32_bf16 v[100:103], a[12:15], v[120:123], 0
  v_lshl_add_u32 v253, v203, 7, v253
  ds_read_b128 v[148:151], v23 offset:1024
  s_waitcnt lgkmcnt(6)
  v_mfma_f32_16x16x32_bf16 v[48:51], a[0:3], v[124:127], 0
  s_lshl_b32 s55, s22, 5
  v_mfma_f32_16x16x32_bf16 v[68:71], a[4:7], v[124:127], 0
  ds_read_b128 v[152:155], v23 offset:21504
  v_mfma_f32_16x16x32_bf16 v[88:91], a[8:11], v[124:127], 0
  s_add_u32 s55, s55, 102400
  v_add_u32 v253, s55, v253
  v_mfma_f32_16x16x32_bf16 v[104:107], a[12:15], v[124:127], 0
  buffer_load_dwordx4 a[112:115], v5, s[4:7], s32 offen offset:3072 sc1
  s_waitcnt lgkmcnt(6)
  v_mfma_f32_16x16x32_bf16 v[52:55], a[0:3], v[128:131], 0
  s_movk_i32 s55, 2048
  v_mfma_f32_16x16x32_bf16 v[72:75], a[4:7], v[128:131], 0
  v_and_b32 v203, 3, v1
  buffer_load_dwordx4 a[116:119], v5, s[4:7], s33 offen offset:3072 sc1
  v_mfma_f32_16x16x32_bf16 v[92:95], a[8:11], v[128:131], 0
  v_lshlrev_b32 v203, 3, v203
  v_mfma_f32_16x16x32_bf16 v[108:111], a[12:15], v[128:131], 0
  buffer_load_dwordx4 a[120:123], v5, s[12:15], s34 offen offset:3072 sc1
  s_waitcnt lgkmcnt(5)
  v_mfma_f32_16x16x32_bf16 v[56:59], a[0:3], v[132:135], 0
  v_mad_u32_u24 v246, v2, s55, v203
  v_lshrrev_b32 v203, 2, v1
  v_mfma_f32_16x16x32_bf16 v[76:79], a[4:7], v[132:135], 0
  buffer_load_dwordx4 a[124:127], v5, s[4:7], s35 offen offset:3072 sc1
  v_mfma_f32_16x16x32_bf16 v[96:99], a[8:11], v[132:135], 0
  v_lshl_add_u32 v246, v203, 7, v246
  v_mfma_f32_16x16x32_bf16 v[112:115], a[12:15], v[132:135], 0
  s_waitcnt vmcnt(26) lgkmcnt(4)
  v_mfma_f32_16x16x32_bf16 v[40:43], a[16:19], v[136:139], v[40:43]
  s_lshl_b32 s55, s22, 5
  ds_read_b128 v[116:119], v20 offset:2048
  s_waitcnt vmcnt(25)
  v_mfma_f32_16x16x32_bf16 v[60:63], a[20:23], v[136:139], v[60:63]
  s_add_u32 s55, s55, 135168
  s_waitcnt vmcnt(24)
  v_mfma_f32_16x16x32_bf16 v[80:83], a[24:27], v[136:139], v[80:83]
  ds_read_b128 v[120:123], v20 offset:22528
  s_waitcnt lgkmcnt(5)
  v_mfma_f32_16x16x32_bf16 v[44:47], a[16:19], v[140:143], v[44:47]
  v_add_u32 v246, s55, v246
  s_cmp_lt_u32 s2, 160
  s_cselect_b32 s55, 0x80000000, 0
  v_mfma_f32_16x16x32_bf16 v[64:67], a[20:23], v[140:143], v[64:67]
  ds_read_b128 v[124:127], v20 offset:43008
  v_mfma_f32_16x16x32_bf16 v[84:87], a[24:27], v[140:143], v[84:87]
  v_or_b32 v245, s55, v4
  s_waitcnt vmcnt(23)
  v_mfma_f32_16x16x32_bf16 v[100:103], a[28:31], v[140:143], v[100:103]
  ds_read_b64_tr_b16 a[228:229], v246 offset:0
  ds_read_b128 v[128:131], v22 offset:2048
  s_waitcnt lgkmcnt(7)
  v_mfma_f32_16x16x32_bf16 v[48:51], a[16:19], v[144:147], v[48:51]
  ds_read_b64_tr_b16 a[230:231], v246 offset:512
  v_mfma_f32_16x16x32_bf16 v[68:71], a[20:23], v[144:147], v[68:71]
  ds_read_b128 v[132:135], v22 offset:22528
  v_mfma_f32_16x16x32_bf16 v[88:91], a[24:27], v[144:147], v[88:91]
  ds_read_b64_tr_b16 a[232:233], v246 offset:1024
  ds_read_b64_tr_b16 a[234:235], v246 offset:1536
  v_mfma_f32_16x16x32_bf16 v[104:107], a[28:31], v[144:147], v[104:107]
  buffer_load_dwordx4 a[128:131], v6, s[4:7], s32 offen offset:0 sc1
  s_waitcnt lgkmcnt(10)
  v_mfma_f32_16x16x32_bf16 v[52:55], a[16:19], v[148:151], v[52:55]
  ds_read_b64_tr_b16 a[204:205], v253 offset:0
  v_mfma_f32_16x16x32_bf16 v[72:75], a[20:23], v[148:151], v[72:75]
  ds_read_b64_tr_b16 a[206:207], v253 offset:512
  buffer_load_dwordx4 a[132:135], v6, s[4:7], s33 offen offset:0 sc1
  v_mfma_f32_16x16x32_bf16 v[92:95], a[24:27], v[148:151], v[92:95]
  ds_read_b64_tr_b16 a[208:209], v253 offset:1024
  v_mfma_f32_16x16x32_bf16 v[108:111], a[28:31], v[148:151], v[108:111]
  buffer_load_dwordx4 a[136:139], v6, s[12:15], s34 offen offset:0 sc1
  s_waitcnt lgkmcnt(12)
  v_mfma_f32_16x16x32_bf16 v[56:59], a[16:19], v[152:155], v[56:59]
  ds_read_b64_tr_b16 a[210:211], v253 offset:1536
  ds_read_b64_tr_b16 a[212:213], v253 offset:2048
  v_mfma_f32_16x16x32_bf16 v[76:79], a[20:23], v[152:155], v[76:79]
  buffer_load_dwordx4 a[140:143], v6, s[4:7], s35 offen offset:0 sc1
  v_mfma_f32_16x16x32_bf16 v[96:99], a[24:27], v[152:155], v[96:99]
  ds_read_b64_tr_b16 a[214:215], v253 offset:2560
  v_mfma_f32_16x16x32_bf16 v[112:115], a[28:31], v[152:155], v[112:115]
  s_waitcnt lgkmcnt(14)
  v_mfma_f32_16x16x32_bf16 v[40:43], a[32:35], v[116:119], v[40:43]
  ds_read_b64_tr_b16 a[216:217], v253 offset:3072
  ds_read_b128 v[136:139], v21 offset:3072
  ds_read_b64_tr_b16 a[218:219], v253 offset:3584
  s_waitcnt vmcnt(26)
  v_mfma_f32_16x16x32_bf16 v[60:63], a[36:39], v[116:119], v[60:63]
  ds_read_b64_tr_b16 a[220:221], v253 offset:4096
  ds_read_b64_tr_b16 a[222:223], v253 offset:4608
  s_waitcnt vmcnt(25)
  v_mfma_f32_16x16x32_bf16 v[80:83], a[40:43], v[116:119], v[80:83]
  ds_read_b64_tr_b16 a[224:225], v253 offset:5120
  ds_read_b128 v[140:143], v21 offset:23552
  ds_read_b64_tr_b16 a[226:227], v253 offset:5632
  s_waitcnt lgkmcnt(15)
  v_mfma_f32_16x16x32_bf16 v[44:47], a[32:35], v[120:123], v[44:47]
  buffer_store_dwordx4 a[228:231], v4, s[4:7], s63 offen sc1
  s_add_u32 s63, s63, 196608
  s_waitcnt lgkmcnt(14)
  buffer_store_dwordx4 a[232:235], v4, s[4:7], s63 offen sc1
  v_mfma_f32_16x16x32_bf16 v[64:67], a[36:39], v[120:123], v[64:67]
  s_waitcnt lgkmcnt(12)
  buffer_store_dwordx4 a[204:207], v245, s[4:7], s62 offen sc1
  ds_read_b128 v[144:147], v21 offset:44032
  s_add_u32 s62, s62, 81920
  s_waitcnt lgkmcnt(11)
  buffer_store_dwordx4 a[208:211], v245, s[4:7], s62 offen sc1
  v_mfma_f32_16x16x32_bf16 v[84:87], a[40:43], v[120:123], v[84:87]
  s_add_u32 s62, s62, 81920
  s_waitcnt lgkmcnt(9)
  buffer_store_dwordx4 a[212:215], v245, s[4:7], s62 offen sc1
  s_add_u32 s62, s62, 81920
  s_waitcnt lgkmcnt(6)
  buffer_store_dwordx4 a[216:219], v245, s[4:7], s62 offen sc1
  s_waitcnt vmcnt(30)
  v_mfma_f32_16x16x32_bf16 v[100:103], a[44:47], v[120:123], v[100:103]
  s_add_u32 s62, s62, 81920
  s_waitcnt lgkmcnt(4)
  buffer_store_dwordx4 a[220:223], v245, s[4:7], s62 offen sc1
  ds_read_b128 v[148:151], v23 offset:3072
  s_add_u32 s62, s62, 81920
  s_waitcnt lgkmcnt(2)
  buffer_store_dwordx4 a[224:227], v245, s[4:7], s62 offen sc1
  v_mfma_f32_16x16x32_bf16 v[48:51], a[32:35], v[124:127], v[48:51]
  v_accvgpr_read_b32 v196, a196
  v_mfma_f32_16x16x32_bf16 v[68:71], a[36:39], v[124:127], v[68:71]
  v_accvgpr_read_b32 v197, a197
  ds_read_b128 v[152:155], v23 offset:23552
  v_accvgpr_read_b32 v198, a198
  v_mfma_f32_16x16x32_bf16 v[88:91], a[40:43], v[124:127], v[88:91]
  v_accvgpr_read_b32 v199, a199
  v_accvgpr_read_b32 v200, a200
  v_mfma_f32_16x16x32_bf16 v[104:107], a[44:47], v[124:127], v[104:107]
  v_accvgpr_read_b32 v176, a176
  buffer_load_dwordx4 a[0:3], v6, s[4:7], s32 offen offset:1024 sc1
  v_accvgpr_read_b32 v177, a177
  v_mfma_f32_16x16x32_bf16 v[52:55], a[32:35], v[128:131], v[52:55]
  v_accvgpr_read_b32 v178, a178
  v_accvgpr_read_b32 v179, a179
  v_mfma_f32_16x16x32_bf16 v[72:75], a[36:39], v[128:131], v[72:75]
  v_accvgpr_read_b32 v180, a180
  buffer_load_dwordx4 a[4:7], v6, s[4:7], s33 offen offset:1024 sc1
  v_accvgpr_read_b32 v181, a181
  v_mfma_f32_16x16x32_bf16 v[92:95], a[40:43], v[128:131], v[92:95]
  v_accvgpr_read_b32 v182, a182
  v_accvgpr_read_b32 v183, a183
  v_mfma_f32_16x16x32_bf16 v[108:111], a[44:47], v[128:131], v[108:111]
  v_accvgpr_read_b32 v184, a184
  buffer_load_dwordx4 a[8:11], v6, s[12:15], s34 offen offset:1024 sc1
  v_accvgpr_read_b32 v185, a185
  v_mfma_f32_16x16x32_bf16 v[56:59], a[32:35], v[132:135], v[56:59]
  v_accvgpr_read_b32 v186, a186
  v_accvgpr_read_b32 v187, a187
  v_mfma_f32_16x16x32_bf16 v[76:79], a[36:39], v[132:135], v[76:79]
  v_accvgpr_read_b32 v188, a188
  buffer_load_dwordx4 a[12:15], v6, s[4:7], s35 offen offset:1024 sc1
  v_accvgpr_read_b32 v189, a189
  v_mfma_f32_16x16x32_bf16 v[96:99], a[40:43], v[132:135], v[96:99]
  v_accvgpr_read_b32 v190, a190
  v_accvgpr_read_b32 v191, a191
  v_mfma_f32_16x16x32_bf16 v[112:115], a[44:47], v[132:135], v[112:115]
  s_waitcnt vmcnt(35)
  v_mfma_f32_16x16x32_bf16 v[40:43], a[48:51], v[136:139], v[40:43]
  buffer_store_dwordx4 v[4:7], v4, s[4:7], s61 offen offset:0 sc1
  ds_read_b128 v[116:119], v20 offset:4096
  s_waitcnt vmcnt(35)
  v_mfma_f32_16x16x32_bf16 v[60:63], a[52:55], v[136:139], v[60:63]
  buffer_store_dwordx4 v[4:7], v4, s[4:7], s61 offen offset:1024 sc1
  buffer_store_dwordx4 v[4:7], v4, s[4:7], s61 offen offset:2048 sc1
  s_waitcnt vmcnt(36)
  v_mfma_f32_16x16x32_bf16 v[80:83], a[56:59], v[136:139], v[80:83]
  ds_read_b128 v[120:123], v20 offset:24576
  v_accvgpr_read_b32 v192, a192
  v_mfma_f32_16x16x32_bf16 v[44:47], a[48:51], v[140:143], v[44:47]
  v_accvgpr_read_b32 v193, a193
  v_accvgpr_read_b32 v194, a194
  v_mfma_f32_16x16x32_bf16 v[64:67], a[52:55], v[140:143], v[64:67]
  ds_read_b128 v[124:127], v20 offset:45056
  v_accvgpr_read_b32 v195, a195
  v_mfma_f32_16x16x32_bf16 v[84:87], a[56:59], v[140:143], v[84:87]
  v_lshlrev_b32 v196, 16, v196
  v_lshlrev_b32 v197, 16, v197
  s_waitcnt vmcnt(35)
  v_mfma_f32_16x16x32_bf16 v[100:103], a[60:63], v[140:143], v[100:103]
  ds_read_b128 v[128:131], v22 offset:4096
  v_lshlrev_b32 v198, 16, v198
  s_waitcnt lgkmcnt(6)
  v_mfma_f32_16x16x32_bf16 v[48:51], a[48:51], v[144:147], v[48:51]
  v_lshlrev_b32 v199, 16, v199
  v_lshlrev_b32 v200, 16, v200
  v_mfma_f32_16x16x32_bf16 v[68:71], a[52:55], v[144:147], v[68:71]
  ds_read_b128 v[132:135], v22 offset:24576
  v_mfma_f32_16x16x32_bf16 v[88:91], a[56:59], v[144:147], v[88:91]
  v_mul_f32 v208, 0xbfb8aa3b, v196
  v_mul_f32 v209, 0xbfb8aa3b, v197
  v_mfma_f32_16x16x32_bf16 v[104:107], a[60:63], v[144:147], v[104:107]
  buffer_load_dwordx4 a[16:19], v6, s[4:7], s32 offen offset:2048 sc1
  v_mul_f32 v210, 0xbfb8aa3b, v198
  s_waitcnt lgkmcnt(6)
  v_mfma_f32_16x16x32_bf16 v[52:55], a[48:51], v[148:151], v[52:55]
  v_mul_f32 v211, 0xbfb8aa3b, v199
  v_mul_f32 v212, 0xbfb8aa3b, v200
  v_mfma_f32_16x16x32_bf16 v[72:75], a[52:55], v[148:151], v[72:75]
  buffer_load_dwordx4 a[20:23], v6, s[4:7], s33 offen offset:2048 sc1
  v_exp_f32 v208, v208
  v_mfma_f32_16x16x32_bf16 v[92:95], a[56:59], v[148:151], v[92:95]
  v_exp_f32 v209, v209
  v_exp_f32 v210, v210
  v_mfma_f32_16x16x32_bf16 v[108:111], a[60:63], v[148:151], v[108:111]
  buffer_load_dwordx4 a[24:27], v6, s[12:15], s34 offen offset:2048 sc1
  v_exp_f32 v211, v211
  s_waitcnt lgkmcnt(5)
  v_mfma_f32_16x16x32_bf16 v[56:59], a[48:51], v[152:155], v[56:59]
  v_exp_f32 v212, v212
  v_add_f32 v208, 1.0, v208
  v_mfma_f32_16x16x32_bf16 v[76:79], a[52:55], v[152:155], v[76:79]
  buffer_load_dwordx4 a[28:31], v6, s[4:7], s35 offen offset:2048 sc1
  v_add_f32 v209, 1.0, v209
  v_mfma_f32_16x16x32_bf16 v[96:99], a[56:59], v[152:155], v[96:99]
  buffer_load_dword v247, v250, s[4:7], 0 offen offset:2048 sc1 sc0
  v_mfma_f32_16x16x32_bf16 v[112:115], a[60:63], v[152:155], v[112:115]
  s_waitcnt vmcnt(39) lgkmcnt(4)
  v_mfma_f32_16x16x32_bf16 v[40:43], a[64:67], v[116:119], v[40:43]
  buffer_store_dwordx4 v[4:7], v4, s[4:7], s61 offen offset:3072 sc1
  ds_read_b128 v[136:139], v21 offset:5120
  s_waitcnt vmcnt(39)
  v_mfma_f32_16x16x32_bf16 v[60:63], a[68:71], v[116:119], v[60:63]
  buffer_store_dwordx4 v[4:7], v5, s[4:7], s61 offen offset:0 sc1
  buffer_store_dwordx4 v[4:7], v5, s[4:7], s61 offen offset:1024 sc1
  s_waitcnt vmcnt(40)
  v_mfma_f32_16x16x32_bf16 v[80:83], a[72:75], v[116:119], v[80:83]
  ds_read_b128 v[140:143], v21 offset:25600
  v_add_f32 v210, 1.0, v210
  s_waitcnt lgkmcnt(5)
  v_mfma_f32_16x16x32_bf16 v[44:47], a[64:67], v[120:123], v[44:47]
  v_add_f32 v211, 1.0, v211
  v_add_f32 v212, 1.0, v212
  v_mfma_f32_16x16x32_bf16 v[64:67], a[68:71], v[120:123], v[64:67]
  ds_read_b128 v[144:147], v21 offset:46080
  v_rcp_f32 v208, v208
  v_mfma_f32_16x16x32_bf16 v[84:87], a[72:75], v[120:123], v[84:87]
  v_rcp_f32 v209, v209
  s_waitcnt vmcnt(39)
  v_mfma_f32_16x16x32_bf16 v[100:103], a[76:79], v[120:123], v[100:103]
  v_rcp_f32 v210, v210
  ds_read_b128 v[148:151], v23 offset:5120
  s_waitcnt lgkmcnt(6)
  v_mfma_f32_16x16x32_bf16 v[48:51], a[64:67], v[124:127], v[48:51]
  v_rcp_f32 v211, v211
  v_rcp_f32 v212, v212
  v_mfma_f32_16x16x32_bf16 v[68:71], a[68:71], v[124:127], v[68:71]
  ds_read_b128 v[152:155], v23 offset:25600
  v_mul_f32 v196, v196, v208
  v_mfma_f32_16x16x32_bf16 v[88:91], a[72:75], v[124:127], v[88:91]
  v_mul_f32 v197, v197, v209
  v_mul_f32 v198, v198, v210
  v_mfma_f32_16x16x32_bf16 v[104:107], a[76:79], v[124:127], v[104:107]
  buffer_load_dwordx4 a[32:35], v6, s[4:7], s32 offen offset:3072 sc1
  v_mul_f32 v199, v199, v211
  s_waitcnt lgkmcnt(6)
  v_mfma_f32_16x16x32_bf16 v[52:55], a[64:67], v[128:131], v[52:55]
  v_mul_f32 v200, v200, v212
  v_mfma_f32_16x16x32_bf16 v[72:75], a[68:71], v[128:131], v[72:75]
  v_cvt_pk_bf16_f32 v196, v196, 0
  buffer_load_dwordx4 a[36:39], v6, s[4:7], s33 offen offset:3072 sc1
  v_mfma_f32_16x16x32_bf16 v[92:95], a[72:75], v[128:131], v[92:95]
  v_cvt_pk_bf16_f32 v197, v197, 0
  v_cvt_pk_bf16_f32 v198, v198, 0
  v_mfma_f32_16x16x32_bf16 v[108:111], a[76:79], v[128:131], v[108:111]
  buffer_load_dwordx4 a[40:43], v6, s[12:15], s34 offen offset:3072 sc1
  v_cvt_pk_bf16_f32 v199, v199, 0
  s_waitcnt lgkmcnt(5)
  v_mfma_f32_16x16x32_bf16 v[56:59], a[64:67], v[132:135], v[56:59]
  v_cvt_pk_bf16_f32 v200, v200, 0
  v_lshlrev_b32 v201, 16, v196
  v_mfma_f32_16x16x32_bf16 v[76:79], a[68:71], v[132:135], v[76:79]
  buffer_load_dwordx4 a[44:47], v6, s[4:7], s35 offen offset:3072 sc1
  v_lshlrev_b32 v202, 16, v176
  v_mfma_f32_16x16x32_bf16 v[96:99], a[72:75], v[132:135], v[96:99]
  v_and_b32 v176, 0xffff0000, v176
  v_mfma_f32_16x16x32_bf16 v[112:115], a[76:79], v[132:135], v[112:115]
  s_waitcnt vmcnt(42) lgkmcnt(4)
  v_mfma_f32_16x16x32_bf16 v[40:43], a[80:83], v[136:139], v[40:43]
  ds_read_b128 v[116:119], v20 offset:6144
  s_waitcnt vmcnt(41)
  v_mfma_f32_16x16x32_bf16 v[60:63], a[84:87], v[136:139], v[60:63]
  v_mul_f32 v208, v202, v201
  v_mul_f32 v209, v176, v201
  s_waitcnt vmcnt(40)
  v_mfma_f32_16x16x32_bf16 v[80:83], a[88:91], v[136:139], v[80:83]
  ds_read_b128 v[120:123], v20 offset:26624
  v_lshlrev_b32 v202, 16, v177
  s_waitcnt lgkmcnt(5)
  v_mfma_f32_16x16x32_bf16 v[44:47], a[80:83], v[140:143], v[44:47]
  v_and_b32 v177, 0xffff0000, v177
  v_mfma_f32_16x16x32_bf16 v[64:67], a[84:87], v[140:143], v[64:67]
  ds_read_b128 v[124:127], v20 offset:47104
  v_mul_f32 v210, v202, v201
  v_mfma_f32_16x16x32_bf16 v[84:87], a[88:91], v[140:143], v[84:87]
  v_mul_f32 v211, v177, v201
  v_lshlrev_b32 v202, 16, v178
  s_waitcnt vmcnt(39)
  v_mfma_f32_16x16x32_bf16 v[100:103], a[92:95], v[140:143], v[100:103]
  ds_read_b128 v[128:131], v22 offset:6144
  v_and_b32 v178, 0xffff0000, v178
  s_waitcnt lgkmcnt(6)
  v_mfma_f32_16x16x32_bf16 v[48:51], a[80:83], v[144:147], v[48:51]
  v_mul_f32 v212, v202, v201
  v_mfma_f32_16x16x32_bf16 v[68:71], a[84:87], v[144:147], v[68:71]
  ds_read_b128 v[132:135], v22 offset:26624
  v_mul_f32 v213, v178, v201
  v_mfma_f32_16x16x32_bf16 v[88:91], a[88:91], v[144:147], v[88:91]
  v_lshlrev_b32 v202, 16, v179
  v_and_b32 v179, 0xffff0000, v179
  v_mfma_f32_16x16x32_bf16 v[104:107], a[92:95], v[144:147], v[104:107]
  buffer_load_dwordx4 a[48:51], v7, s[4:7], s32 offen offset:0 sc1
  s_waitcnt lgkmcnt(6)
  v_mfma_f32_16x16x32_bf16 v[52:55], a[80:83], v[148:151], v[52:55]
  v_mul_f32 v214, v202, v201
  v_mul_f32 v215, v179, v201
  v_mfma_f32_16x16x32_bf16 v[72:75], a[84:87], v[148:151], v[72:75]
  buffer_load_dwordx4 a[52:55], v7, s[4:7], s33 offen offset:0 sc1
  v_lshlrev_b32 v201, 16, v197
  v_mfma_f32_16x16x32_bf16 v[92:95], a[88:91], v[148:151], v[92:95]
  v_lshlrev_b32 v202, 16, v180
  v_and_b32 v180, 0xffff0000, v180
  v_mfma_f32_16x16x32_bf16 v[108:111], a[92:95], v[148:151], v[108:111]
  buffer_load_dwordx4 a[56:59], v7, s[12:15], s34 offen offset:0 sc1
  s_waitcnt lgkmcnt(5)
  v_mfma_f32_16x16x32_bf16 v[56:59], a[80:83], v[152:155], v[56:59]
  v_fmac_f32 v208, v202, v201
  v_fmac_f32 v209, v180, v201
  v_mfma_f32_16x16x32_bf16 v[76:79], a[84:87], v[152:155], v[76:79]
  buffer_load_dwordx4 a[60:63], v7, s[4:7], s35 offen offset:0 sc1
  v_lshlrev_b32 v202, 16, v181
  v_mfma_f32_16x16x32_bf16 v[96:99], a[88:91], v[152:155], v[96:99]
  v_and_b32 v181, 0xffff0000, v181
  v_mfma_f32_16x16x32_bf16 v[112:115], a[92:95], v[152:155], v[112:115]
  s_waitcnt vmcnt(42) lgkmcnt(4)
  v_mfma_f32_16x16x32_bf16 v[40:43], a[96:99], v[116:119], v[40:43]
  v_fmac_f32 v210, v202, v201
  ds_read_b128 v[136:139], v21 offset:7168
  s_waitcnt vmcnt(41)
  v_mfma_f32_16x16x32_bf16 v[60:63], a[100:103], v[116:119], v[60:63]
  v_fmac_f32 v211, v181, v201
  v_lshlrev_b32 v202, 16, v182
  s_waitcnt vmcnt(40)
  v_mfma_f32_16x16x32_bf16 v[80:83], a[104:107], v[116:119], v[80:83]
  ds_read_b128 v[140:143], v21 offset:27648
  s_waitcnt lgkmcnt(5)
  v_mfma_f32_16x16x32_bf16 v[44:47], a[96:99], v[120:123], v[44:47]
  v_and_b32 v182, 0xffff0000, v182
  v_fmac_f32 v212, v202, v201
  v_mfma_f32_16x16x32_bf16 v[64:67], a[100:103], v[120:123], v[64:67]
  ds_read_b128 v[144:147], v21 offset:48128
  v_fmac_f32 v213, v182, v201
  v_mfma_f32_16x16x32_bf16 v[84:87], a[104:107], v[120:123], v[84:87]
  v_lshlrev_b32 v202, 16, v183
  s_waitcnt vmcnt(39)
  v_mfma_f32_16x16x32_bf16 v[100:103], a[108:111], v[120:123], v[100:103]
  v_and_b32 v183, 0xffff0000, v183
  ds_read_b128 v[148:151], v23 offset:7168
  s_waitcnt lgkmcnt(6)
  v_mfma_f32_16x16x32_bf16 v[48:51], a[96:99], v[124:127], v[48:51]
  v_fmac_f32 v214, v202, v201
  v_fmac_f32 v215, v183, v201
  v_mfma_f32_16x16x32_bf16 v[68:71], a[100:103], v[124:127], v[68:71]
  ds_read_b128 v[152:155], v23 offset:27648
  v_mfma_f32_16x16x32_bf16 v[88:91], a[104:107], v[124:127], v[88:91]
  v_lshlrev_b32 v201, 16, v198
  v_lshlrev_b32 v202, 16, v184
  v_mfma_f32_16x16x32_bf16 v[104:107], a[108:111], v[124:127], v[104:107]
  buffer_load_dwordx4 a[64:67], v7, s[4:7], s32 offen offset:1024 sc1
  v_and_b32 v184, 0xffff0000, v184
  s_waitcnt lgkmcnt(6)
  v_mfma_f32_16x16x32_bf16 v[52:55], a[96:99], v[128:131], v[52:55]
  v_fmac_f32 v208, v202, v201
  v_mfma_f32_16x16x32_bf16 v[72:75], a[100:103], v[128:131], v[72:75]
  v_fmac_f32 v209, v184, v201
  buffer_load_dwordx4 a[68:71], v7, s[4:7], s33 offen offset:1024 sc1
  v_mfma_f32_16x16x32_bf16 v[92:95], a[104:107], v[128:131], v[92:95]
  v_lshlrev_b32 v202, 16, v185
  v_and_b32 v185, 0xffff0000, v185
  v_mfma_f32_16x16x32_bf16 v[108:111], a[108:111], v[128:131], v[108:111]
  buffer_load_dwordx4 a[72:75], v7, s[12:15], s34 offen offset:1024 sc1
  s_waitcnt lgkmcnt(5)
  v_mfma_f32_16x16x32_bf16 v[56:59], a[96:99], v[132:135], v[56:59]
  v_fmac_f32 v210, v202, v201
  v_fmac_f32 v211, v185, v201
  v_mfma_f32_16x16x32_bf16 v[76:79], a[100:103], v[132:135], v[76:79]
  buffer_load_dwordx4 a[76:79], v7, s[4:7], s35 offen offset:1024 sc1
  v_lshlrev_b32 v202, 16, v186
  v_mfma_f32_16x16x32_bf16 v[96:99], a[104:107], v[132:135], v[96:99]
  v_and_b32 v186, 0xffff0000, v186
  v_mfma_f32_16x16x32_bf16 v[112:115], a[108:111], v[132:135], v[112:115]
  s_waitcnt vmcnt(42) lgkmcnt(4)
  v_mfma_f32_16x16x32_bf16 v[40:43], a[112:115], v[136:139], v[40:43]
  v_fmac_f32 v212, v202, v201
  ds_read_b128 v[116:119], v20 offset:8192
  s_waitcnt vmcnt(41)
  v_mfma_f32_16x16x32_bf16 v[60:63], a[116:119], v[136:139], v[60:63]
  v_fmac_f32 v213, v186, v201
  v_lshlrev_b32 v202, 16, v187
  s_waitcnt vmcnt(40)
  v_mfma_f32_16x16x32_bf16 v[80:83], a[120:123], v[136:139], v[80:83]
  ds_read_b128 v[120:123], v20 offset:28672
  s_waitcnt lgkmcnt(5)
  v_mfma_f32_16x16x32_bf16 v[44:47], a[112:115], v[140:143], v[44:47]
  v_and_b32 v187, 0xffff0000, v187
  v_fmac_f32 v214, v202, v201
  v_mfma_f32_16x16x32_bf16 v[64:67], a[116:119], v[140:143], v[64:67]
  ds_read_b128 v[124:127], v20 offset:49152
  v_fmac_f32 v215, v187, v201
  v_mfma_f32_16x16x32_bf16 v[84:87], a[120:123], v[140:143], v[84:87]
  v_lshlrev_b32 v201, 16, v199
  s_waitcnt vmcnt(39)
  v_mfma_f32_16x16x32_bf16 v[100:103], a[124:127], v[140:143], v[100:103]
  v_lshlrev_b32 v202, 16, v188
  ds_read_b128 v[128:131], v22 offset:8192
  s_waitcnt lgkmcnt(6)
  v_mfma_f32_16x16x32_bf16 v[48:51], a[112:115], v[144:147], v[48:51]
  v_and_b32 v188, 0xffff0000, v188
  v_fmac_f32 v208, v202, v201
  v_mfma_f32_16x16x32_bf16 v[68:71], a[116:119], v[144:147], v[68:71]
  ds_read_b128 v[132:135], v22 offset:28672
  v_mfma_f32_16x16x32_bf16 v[88:91], a[120:123], v[144:147], v[88:91]
  v_fmac_f32 v209, v188, v201
  v_lshlrev_b32 v202, 16, v189
  v_mfma_f32_16x16x32_bf16 v[104:107], a[124:127], v[144:147], v[104:107]
  buffer_load_dwordx4 a[80:83], v7, s[4:7], s32 offen offset:2048 sc1
  v_and_b32 v189, 0xffff0000, v189
  s_waitcnt lgkmcnt(6)
  v_mfma_f32_16x16x32_bf16 v[52:55], a[112:115], v[148:151], v[52:55]
  v_fmac_f32 v210, v202, v201
  v_mfma_f32_16x16x32_bf16 v[72:75], a[116:119], v[148:151], v[72:75]
  v_fmac_f32 v211, v189, v201
  buffer_load_dwordx4 a[84:87], v7, s[4:7], s33 offen offset:2048 sc1
  v_mfma_f32_16x16x32_bf16 v[92:95], a[120:123], v[148:151], v[92:95]
  v_lshlrev_b32 v202, 16, v190
  v_and_b32 v190, 0xffff0000, v190
  v_mfma_f32_16x16x32_bf16 v[108:111], a[124:127], v[148:151], v[108:111]
  buffer_load_dwordx4 a[88:91], v7, s[12:15], s34 offen offset:2048 sc1
  s_waitcnt lgkmcnt(5)
  v_mfma_f32_16x16x32_bf16 v[56:59], a[112:115], v[152:155], v[56:59]
  v_fmac_f32 v212, v202, v201
  v_fmac_f32 v213, v190, v201
  v_mfma_f32_16x16x32_bf16 v[76:79], a[116:119], v[152:155], v[76:79]
  buffer_load_dwordx4 a[92:95], v7, s[4:7], s35 offen offset:2048 sc1
  v_lshlrev_b32 v202, 16, v191
  v_mfma_f32_16x16x32_bf16 v[96:99], a[120:123], v[152:155], v[96:99]
  v_and_b32 v191, 0xffff0000, v191
  v_mfma_f32_16x16x32_bf16 v[112:115], a[124:127], v[152:155], v[112:115]
  s_waitcnt vmcnt(42) lgkmcnt(4)
  v_mfma_f32_16x16x32_bf16 v[40:43], a[128:131], v[116:119], v[40:43]
  v_fmac_f32 v214, v202, v201
  ds_read_b128 v[136:139], v21 offset:9216
  v_fmac_f32 v215, v191, v201
  s_waitcnt vmcnt(41)
  v_mfma_f32_16x16x32_bf16 v[60:63], a[132:135], v[116:119], v[60:63]
  v_lshlrev_b32 v201, 16, v200
  v_lshlrev_b32 v202, 16, v192
  s_waitcnt vmcnt(40)
  v_mfma_f32_16x16x32_bf16 v[80:83], a[136:139], v[116:119], v[80:83]
  ds_read_b128 v[140:143], v21 offset:29696
  v_and_b32 v192, 0xffff0000, v192
  s_waitcnt lgkmcnt(5)
  v_mfma_f32_16x16x32_bf16 v[44:47], a[128:131], v[120:123], v[44:47]
  v_fmac_f32 v208, v202, v201
  v_fmac_f32 v209, v192, v201
  v_mfma_f32_16x16x32_bf16 v[64:67], a[132:135], v[120:123], v[64:67]
  ds_read_b128 v[144:147], v21 offset:50176
  v_lshlrev_b32 v202, 16, v193
  v_mfma_f32_16x16x32_bf16 v[84:87], a[136:139], v[120:123], v[84:87]
  v_and_b32 v193, 0xffff0000, v193
  v_fmac_f32 v210, v202, v201
  s_waitcnt vmcnt(39)
  v_mfma_f32_16x16x32_bf16 v[100:103], a[140:143], v[120:123], v[100:103]
  ds_read_b128 v[148:151], v23 offset:9216
  v_fmac_f32 v211, v193, v201
  s_waitcnt lgkmcnt(6)
  v_mfma_f32_16x16x32_bf16 v[48:51], a[128:131], v[124:127], v[48:51]
  v_lshlrev_b32 v202, 16, v194
  v_and_b32 v194, 0xffff0000, v194
  v_mfma_f32_16x16x32_bf16 v[68:71], a[132:135], v[124:127], v[68:71]
  ds_read_b128 v[152:155], v23 offset:29696
  v_fmac_f32 v212, v202, v201
  v_mfma_f32_16x16x32_bf16 v[88:91], a[136:139], v[124:127], v[88:91]
  v_fmac_f32 v213, v194, v201
  v_lshlrev_b32 v202, 16, v195
  v_mfma_f32_16x16x32_bf16 v[104:107], a[140:143], v[124:127], v[104:107]
  buffer_load_dwordx4 a[96:99], v7, s[4:7], s32 offen offset:3072 sc1
  v_and_b32 v195, 0xffff0000, v195
  s_waitcnt lgkmcnt(6)
  v_mfma_f32_16x16x32_bf16 v[52:55], a[128:131], v[128:131], v[52:55]
  v_fmac_f32 v214, v202, v201
  v_fmac_f32 v215, v195, v201
  v_mfma_f32_16x16x32_bf16 v[72:75], a[132:135], v[128:131], v[72:75]
  buffer_load_dwordx4 a[100:103], v7, s[4:7], s33 offen offset:3072 sc1
  v_and_b32 v201, 7, v0
  v_mfma_f32_16x16x32_bf16 v[92:95], a[136:139], v[128:131], v[92:95]
  v_lshlrev_b32 v201, 5, v201
  s_add_u32 s37, s36, 20480
  v_mfma_f32_16x16x32_bf16 v[108:111], a[140:143], v[128:131], v[108:111]
  buffer_load_dwordx4 a[104:107], v7, s[12:15], s34 offen offset:3072 sc1
  s_add_u32 s38, s37, 20480
  s_waitcnt lgkmcnt(5)
  v_mfma_f32_16x16x32_bf16 v[56:59], a[128:131], v[132:135], v[56:59]
  s_add_u32 s39, s38, 20480
  s_add_u32 s40, s39, 20480
  v_mfma_f32_16x16x32_bf16 v[76:79], a[132:135], v[132:135], v[76:79]
  buffer_load_dwordx4 a[108:111], v7, s[4:7], s35 offen offset:3072 sc1
  s_lshl2_add_u32 s41, s21, s22
  v_mfma_f32_16x16x32_bf16 v[96:99], a[136:139], v[132:135], v[96:99]
  s_mul_i32 s41, s41, 61440
  s_add_u32 s41, s41, 5242880
  v_mfma_f32_16x16x32_bf16 v[112:115], a[140:143], v[132:135], v[112:115]
  s_waitcnt vmcnt(34) lgkmcnt(4)
  v_mfma_f32_16x16x32_bf16 v[40:43], a[0:3], v[136:139], v[40:43]
  v_lshl_add_u32 v201, v2, 3, v201
  ds_read_b128 v[116:119], v20 offset:10240
  v_permlane32_swap_b32 v208, v212
  s_waitcnt vmcnt(33)
  v_mfma_f32_16x16x32_bf16 v[60:63], a[4:7], v[136:139], v[60:63]
  v_permlane32_swap_b32 v209, v213
  v_permlane32_swap_b32 v210, v214
  v_permlane32_swap_b32 v211, v215
  s_waitcnt vmcnt(32)
  v_mfma_f32_16x16x32_bf16 v[80:83], a[8:11], v[136:139], v[80:83]
  ds_read_b128 v[120:123], v20 offset:30720
  v_add_f32 v208, v208, v212
  s_waitcnt lgkmcnt(5)
  v_mfma_f32_16x16x32_bf16 v[44:47], a[0:3], v[140:143], v[44:47]
  v_add_f32 v209, v209, v213
  v_add_f32 v210, v210, v214
  v_add_f32 v211, v211, v215
  v_mfma_f32_16x16x32_bf16 v[64:67], a[4:7], v[140:143], v[64:67]
  ds_read_b128 v[124:127], v20 offset:51200
  s_lshl_b32 s29, s22, 8
  v_mfma_f32_16x16x32_bf16 v[84:87], a[8:11], v[140:143], v[84:87]
  s_add_u32 s29, s29, 143360
  v_permlane16_swap_b32 v208, v210
  v_permlane16_swap_b32 v209, v211
  s_waitcnt vmcnt(31)
  v_mfma_f32_16x16x32_bf16 v[100:103], a[12:15], v[140:143], v[100:103]
  ds_read_b128 v[128:131], v22 offset:10240
  v_add_f32 v208, v208, v210
  s_waitcnt lgkmcnt(6)
  v_mfma_f32_16x16x32_bf16 v[48:51], a[0:3], v[144:147], v[48:51]
  v_add_f32 v209, v209, v211
  v_add_u32 v201, s29, v201
  v_lshlrev_b32 v214, 2, v0
  v_mfma_f32_16x16x32_bf16 v[68:71], a[4:7], v[144:147], v[68:71]
  ds_read_b128 v[132:135], v22 offset:30720
  v_add_f32_dpp v208, v208, v208 row_ror:8 row_mask:0xf bank_mask:0xf
  v_mfma_f32_16x16x32_bf16 v[88:91], a[8:11], v[144:147], v[88:91]
  v_add_f32_dpp v209, v209, v209 row_ror:8 row_mask:0xf bank_mask:0xf
  v_add_u32 v214, 143360, v214
  ds_write_b64 v201, v[208:209]
  v_mfma_f32_16x16x32_bf16 v[104:107], a[12:15], v[144:147], v[104:107]
  buffer_load_dwordx4 a[112:115], v8, s[4:7], s32 offen offset:0 sc1
  s_lshl2_add_u32 s49, s20, s22
  s_mul_i32 s49, s49, 20480
  s_waitcnt lgkmcnt(7)
  v_mfma_f32_16x16x32_bf16 v[52:55], a[0:3], v[148:151], v[52:55]
  s_mul_i32 s61, s21, 160
  s_add_u32 s49, s49, s61
  v_mfma_f32_16x16x32_bf16 v[72:75], a[4:7], v[148:151], v[72:75]
  buffer_load_dwordx4 a[116:119], v8, s[4:7], s33 offen offset:0 sc1
  v_add_u32 v205, 0, v0
  v_mul_u32_u24 v216, 6554, v205
  v_mfma_f32_16x16x32_bf16 v[92:95], a[8:11], v[148:151], v[92:95]
  v_lshrrev_b32 v216, 16, v216
  v_lshlrev_b32 v205, 4, v205
  v_mfma_f32_16x16x32_bf16 v[108:111], a[12:15], v[148:151], v[108:111]
  buffer_load_dwordx4 a[120:123], v8, s[12:15], s34 offen offset:0 sc1
  v_mul_u32_u24 v216, 1120, v216
  s_add_u32 s42, s41, 20480
  s_waitcnt lgkmcnt(6)
  v_mfma_f32_16x16x32_bf16 v[56:59], a[0:3], v[152:155], v[56:59]
  s_add_u32 s43, s42, 20480
  s_mul_i32 s44, s21, 245760
  v_mfma_f32_16x16x32_bf16 v[76:79], a[4:7], v[152:155], v[76:79]
  buffer_load_dwordx4 a[124:127], v8, s[4:7], s35 offen offset:0 sc1
  s_mul_i32 s3, s22, 12288
  s_add_u32 s44, s44, s3
  v_mfma_f32_16x16x32_bf16 v[96:99], a[8:11], v[152:155], v[96:99]
  s_add_u32 s44, s44, 7340032
  s_add_u32 s45, s44, 49152
  v_mfma_f32_16x16x32_bf16 v[112:115], a[12:15], v[152:155], v[112:115]
  s_waitcnt vmcnt(31) lgkmcnt(5)
  v_mfma_f32_16x16x32_bf16 v[40:43], a[16:19], v[116:119], v[40:43]
  s_waitcnt vmcnt(27)
  v_cmp_eq_u32 vcc, s24, v247
  s_waitcnt vmcnt(20)
  s_waitcnt lgkmcnt(0)
  s_nop 2
  s_cmp_eq_u64 vcc, -1
  s_cbranch_scc0 WOSPIN
WODONE:
  s_barrier
  buffer_store_dword v248, v249, s[4:7], s50 offen sc1
  v_add_u32 v205, v216, v205
  ds_read_b128 v[136:139], v21 offset:11264
  v_mfma_f32_16x16x32_bf16 v[60:63], a[20:23], v[116:119], v[60:63]
  v_add_u32 v206, 64, v0
  v_mul_u32_u24 v216, 6554, v206
  v_mfma_f32_16x16x32_bf16 v[80:83], a[24:27], v[116:119], v[80:83]
  v_lshrrev_b32 v216, 16, v216
  ds_read_b128 v[140:143], v21 offset:31744
  v_mfma_f32_16x16x32_bf16 v[44:47], a[16:19], v[120:123], v[44:47]
  v_lshlrev_b32 v206, 4, v206
  v_mul_u32_u24 v216, 1120, v216
  v_mfma_f32_16x16x32_bf16 v[64:67], a[20:23], v[120:123], v[64:67]
  v_add_u32 v206, v216, v206
  ds_read_b128 v[144:147], v21 offset:52224
  v_mfma_f32_16x16x32_bf16 v[84:87], a[24:27], v[120:123], v[84:87]
  v_add_u32 v207, 128, v0
  v_mul_u32_u24 v216, 6554, v207
  v_mfma_f32_16x16x32_bf16 v[100:103], a[28:31], v[120:123], v[100:103]
  ds_read2st64_b32 v[208:209], v214 offset0:0 offset1:1
  ds_read_b128 v[148:151], v23 offset:11264
  ds_read2st64_b32 v[210:211], v214 offset0:2 offset1:3
  v_mfma_f32_16x16x32_bf16 v[48:51], a[16:19], v[124:127], v[48:51]
  s_cmp_eq_u32 s22, 0
  s_cselect_b32 s29, 0, 0x80000000
  s_cmp_lt_u32 s2, 160
  s_cselect_b32 s29, s29, 0x80000000
  v_or_b32 v215, s29, v4
  v_mfma_f32_16x16x32_bf16 v[68:71], a[20:23], v[124:127], v[68:71]
  ds_read_b128 v[152:155], v23 offset:31744
  s_bfe_u32 s29, s24, 0xa0000
  v_mfma_f32_16x16x32_bf16 v[88:91], a[24:27], v[124:127], v[88:91]
  s_movk_i32 s31, 0xfc00
  s_waitcnt lgkmcnt(3)
  v_add_f32 v208, v208, v209
  v_mfma_f32_16x16x32_bf16 v[104:107], a[28:31], v[124:127], v[104:107]
  s_waitcnt lgkmcnt(1)
  v_add_f32 v210, v210, v211
  buffer_load_dwordx4 a[128:131], v8, s[4:7], s32 offen offset:1024 sc1
  v_mfma_f32_16x16x32_bf16 v[52:55], a[16:19], v[128:131], v[52:55]
  v_mov_b32 v213, s29
  v_add_f32 v208, v208, v210
  v_mfma_f32_16x16x32_bf16 v[72:75], a[20:23], v[128:131], v[72:75]
  v_add_u32 v208, 0x200, v208
  buffer_load_dwordx4 a[132:135], v8, s[4:7], s33 offen offset:1024 sc1
  v_and_or_b32 v208, v208, s31, v213
  v_mfma_f32_16x16x32_bf16 v[92:95], a[24:27], v[128:131], v[92:95]
  buffer_store_dword v208, v215, s[4:7], s30 offen sc1
  s_add_u32 s46, s45, 49152
  v_mfma_f32_16x16x32_bf16 v[108:111], a[28:31], v[128:131], v[108:111]
  buffer_load_dwordx4 a[136:139], v8, s[12:15], s34 offen offset:1024 sc1
  s_add_u32 s47, s46, 49152
  v_mfma_f32_16x16x32_bf16 v[56:59], a[16:19], v[132:135], v[56:59]
  s_add_u32 s48, s47, 49152
  s_lshl_b32 s27, s20, 9
  v_mfma_f32_16x16x32_bf16 v[76:79], a[20:23], v[132:135], v[76:79]
  buffer_load_dwordx4 a[140:143], v8, s[4:7], s35 offen offset:1024 sc1
  s_add_u32 s27, s27, 262144
  v_mfma_f32_16x16x32_bf16 v[96:99], a[24:27], v[132:135], v[96:99]
  s_lshr_b32 s3, s21, 1
  s_lshl_b32 s3, s3, 7
  v_mfma_f32_16x16x32_bf16 v[112:115], a[28:31], v[132:135], v[112:115]
  v_mfma_f32_16x16x32_bf16 v[40:43], a[32:35], v[136:139], v[40:43]
  v_lshrrev_b32 v216, 16, v216
  ds_read_b128 v[116:119], v20 offset:12288
  v_mfma_f32_16x16x32_bf16 v[60:63], a[36:39], v[136:139], v[60:63]
  v_lshlrev_b32 v207, 4, v207
  v_mfma_f32_16x16x32_bf16 v[80:83], a[40:43], v[136:139], v[80:83]
  ds_read_b128 v[120:123], v20 offset:32768
  v_mfma_f32_16x16x32_bf16 v[44:47], a[32:35], v[140:143], v[44:47]
  v_mul_u32_u24 v216, 1120, v216
  v_add_u32 v207, v216, v207
  v_mfma_f32_16x16x32_bf16 v[64:67], a[36:39], v[140:143], v[64:67]
  ds_read_b128 v[124:127], v20 offset:53248
  v_mfma_f32_16x16x32_bf16 v[84:87], a[40:43], v[140:143], v[84:87]
  v_lshlrev_b32 v216, 26, v0
  v_mfma_f32_16x16x32_bf16 v[100:103], a[44:47], v[140:143], v[100:103]
  v_and_b32 v216, 0x80000000, v216
  ds_read_b128 v[128:131], v22 offset:12288
  v_mfma_f32_16x16x32_bf16 v[48:51], a[32:35], v[144:147], v[48:51]
  v_or_b32 v207, v216, v207
  v_mfma_f32_16x16x32_bf16 v[68:71], a[36:39], v[144:147], v[68:71]
  ds_read_b128 v[132:135], v22 offset:32768
  v_mfma_f32_16x16x32_bf16 v[88:91], a[40:43], v[144:147], v[88:91]
  s_mul_i32 s60, s22, 3072
  s_add_u32 s60, s60, 147456
  v_mfma_f32_16x16x32_bf16 v[104:107], a[44:47], v[144:147], v[104:107]
  buffer_load_dwordx4 a[0:3], v8, s[4:7], s32 offen offset:2048 sc1
  v_mfma_f32_16x16x32_bf16 v[52:55], a[32:35], v[148:151], v[52:55]
  s_add_u32 s26, s27, s3
  v_mfma_f32_16x16x32_bf16 v[72:75], a[36:39], v[148:151], v[72:75]
  s_and_b32 s3, s21, 1
  buffer_load_dwordx4 a[4:7], v8, s[4:7], s33 offen offset:2048 sc1
  v_mfma_f32_16x16x32_bf16 v[92:95], a[40:43], v[148:151], v[92:95]
  s_lshl2_add_u32 s3, s3, s22
  v_mfma_f32_16x16x32_bf16 v[108:111], a[44:47], v[148:151], v[108:111]
  buffer_load_dwordx4 a[8:11], v8, s[12:15], s34 offen offset:2048 sc1
  s_waitcnt lgkmcnt(5)
  v_mfma_f32_16x16x32_bf16 v[56:59], a[32:35], v[152:155], v[56:59]
  s_lshl2_add_u32 s26, s3, s26
  s_lshl_b32 s3, s22, 7
  v_mfma_f32_16x16x32_bf16 v[76:79], a[36:39], v[152:155], v[76:79]
  buffer_load_dwordx4 a[12:15], v8, s[4:7], s35 offen offset:2048 sc1
  v_mfma_f32_16x16x32_bf16 v[96:99], a[40:43], v[152:155], v[96:99]
  s_add_u32 s27, s27, s3
  v_mfma_f32_16x16x32_bf16 v[112:115], a[44:47], v[152:155], v[112:115]
  s_waitcnt vmcnt(29) lgkmcnt(4)
  v_mfma_f32_16x16x32_bf16 v[40:43], a[48:51], v[116:119], v[40:43]
  ds_read_b128 v[136:139], v21 offset:13312
  s_waitcnt vmcnt(28)
  v_mfma_f32_16x16x32_bf16 v[60:63], a[52:55], v[116:119], v[60:63]
  buffer_load_dword v156, v9, s[4:7], s27 offen sc1
  s_waitcnt vmcnt(28)
  v_mfma_f32_16x16x32_bf16 v[80:83], a[56:59], v[116:119], v[80:83]
  ds_read_b128 v[140:143], v21 offset:33792
  s_waitcnt lgkmcnt(5)
  v_mfma_f32_16x16x32_bf16 v[44:47], a[48:51], v[120:123], v[44:47]
  s_add_u32 m0, s60, 0
  s_nop 0
  buffer_load_dwordx4 v205, s[8:11], s49 offen lds
  v_mfma_f32_16x16x32_bf16 v[64:67], a[52:55], v[120:123], v[64:67]
  ds_read_b128 v[144:147], v21 offset:54272
  v_mfma_f32_16x16x32_bf16 v[84:87], a[56:59], v[120:123], v[84:87]
  s_add_u32 m0, s60, 1024
  s_nop 0
  buffer_load_dwordx4 v206, s[8:11], s49 offen lds
  s_waitcnt vmcnt(29)
  v_mfma_f32_16x16x32_bf16 v[100:103], a[60:63], v[120:123], v[100:103]
  ds_read_b128 v[148:151], v23 offset:13312
  s_waitcnt lgkmcnt(6)
  v_mfma_f32_16x16x32_bf16 v[48:51], a[48:51], v[124:127], v[48:51]
  s_add_u32 m0, s60, 2048
  s_nop 0
  buffer_load_dwordx4 v207, s[8:11], s49 offen lds
  v_mfma_f32_16x16x32_bf16 v[68:71], a[52:55], v[124:127], v[68:71]
  v_mfma_f32_16x16x32_bf16 v[88:91], a[56:59], v[124:127], v[88:91]
  ds_read_b128 v[152:155], v23 offset:33792
  v_mfma_f32_16x16x32_bf16 v[104:107], a[60:63], v[124:127], v[104:107]
  buffer_load_dwordx4 a[16:19], v8, s[4:7], s32 offen offset:3072 sc1
  s_waitcnt lgkmcnt(6)
  v_mfma_f32_16x16x32_bf16 v[52:55], a[48:51], v[128:131], v[52:55]
  v_mul_u32_u24 v39, 160, v1
  v_mfma_f32_16x16x32_bf16 v[72:75], a[52:55], v[128:131], v[72:75]
  buffer_load_dwordx4 a[20:23], v8, s[4:7], s33 offen offset:3072 sc1
  v_mfma_f32_16x16x32_bf16 v[92:95], a[56:59], v[128:131], v[92:95]
  v_lshl_add_u32 v39, v2, 3, v39
  v_mfma_f32_16x16x32_bf16 v[108:111], a[60:63], v[128:131], v[108:111]
  buffer_load_dwordx4 a[24:27], v8, s[12:15], s34 offen offset:3072 sc1
  s_waitcnt lgkmcnt(5)
  v_mfma_f32_16x16x32_bf16 v[56:59], a[48:51], v[132:135], v[56:59]
  v_add_u32 v39, s60, v39
  v_mfma_f32_16x16x32_bf16 v[76:79], a[52:55], v[132:135], v[76:79]
  buffer_load_dwordx4 a[28:31], v8, s[4:7], s35 offen offset:3072 sc1
  v_mfma_f32_16x16x32_bf16 v[96:99], a[56:59], v[132:135], v[96:99]
  v_mfma_f32_16x16x32_bf16 v[112:115], a[60:63], v[132:135], v[112:115]
  s_waitcnt vmcnt(33) lgkmcnt(4)
  v_mfma_f32_16x16x32_bf16 v[40:43], a[64:67], v[136:139], v[40:43]
  s_mov_b32 s56, 0x3acccccd
  ds_read_b128 v[116:119], v20 offset:14336
  s_waitcnt vmcnt(32)
  v_mfma_f32_16x16x32_bf16 v[60:63], a[68:71], v[136:139], v[60:63]
  s_lshl_b32 s55, s22, 4
  s_waitcnt vmcnt(31)
  v_mfma_f32_16x16x32_bf16 v[80:83], a[72:75], v[136:139], v[80:83]
  ds_read_b128 v[120:123], v20 offset:34816
  v_add_u32 v38, s55, v1
  s_waitcnt lgkmcnt(5)
  v_mfma_f32_16x16x32_bf16 v[44:47], a[64:67], v[140:143], v[44:47]
  s_mul_i32 s55, s22, 60
  v_mfma_f32_16x16x32_bf16 v[64:67], a[68:71], v[140:143], v[64:67]
  ds_read_b128 v[124:127], v20 offset:55296
  v_min_u32 v252, 59, v0
  v_mfma_f32_16x16x32_bf16 v[84:87], a[72:75], v[140:143], v[84:87]
  v_add_u32 v252, s55, v252
  s_waitcnt vmcnt(30)
  v_mfma_f32_16x16x32_bf16 v[100:103], a[76:79], v[140:143], v[100:103]
  ds_read_b128 v[128:131], v22 offset:14336
  v_lshlrev_b32 v249, 2, v252
  s_waitcnt lgkmcnt(6)
  v_mfma_f32_16x16x32_bf16 v[48:51], a[64:67], v[144:147], v[48:51]
  v_add_u32 v249, 162304, v249
  v_mfma_f32_16x16x32_bf16 v[68:71], a[68:71], v[144:147], v[68:71]
  ds_read_b128 v[132:135], v22 offset:34816
  v_mfma_f32_16x16x32_bf16 v[88:91], a[72:75], v[144:147], v[88:91]
  v_mul_u32_u24 v203, 820, v252
  v_lshrrev_b32 v203, 16, v203
  v_mfma_f32_16x16x32_bf16 v[104:107], a[76:79], v[144:147], v[104:107]
  buffer_load_dwordx4 a[156:159], v4, s[4:7], s36 offen offset:0 sc1
  s_waitcnt lgkmcnt(6)
  v_mfma_f32_16x16x32_bf16 v[52:55], a[64:67], v[148:151], v[52:55]
  v_cmp_eq_u32 vcc, 1, v203
  s_nop 1
  v_cndmask_b32 v251, 0, 1.0, vcc
  v_min_u32 v202, 1, v203
  v_mfma_f32_16x16x32_bf16 v[72:75], a[68:71], v[148:151], v[72:75]
  buffer_load_dwordx4 a[160:163], v4, s[4:7], s37 offen offset:0 sc1
  v_mfma_f32_16x16x32_bf16 v[92:95], a[72:75], v[148:151], v[92:95]
  v_add_u32 v202, v202, v203
  v_mul_u32_u24 v202, 640, v202
  v_mfma_f32_16x16x32_bf16 v[108:111], a[76:79], v[148:151], v[108:111]
  buffer_load_dwordx4 a[164:167], v4, s[4:7], s38 offen offset:0 sc1
  s_waitcnt lgkmcnt(5)
  v_mfma_f32_16x16x32_bf16 v[56:59], a[64:67], v[152:155], v[56:59]
  v_mul_u32_u24 v203, 80, v203
  v_sub_u32 v252, v252, v203
  v_mfma_f32_16x16x32_bf16 v[76:79], a[68:71], v[152:155], v[76:79]
  buffer_load_dwordx4 a[168:171], v4, s[4:7], s39 offen offset:0 sc1
  v_mfma_f32_16x16x32_bf16 v[96:99], a[72:75], v[152:155], v[96:99]
  v_add_u32 v252, v252, v202
  v_mfma_f32_16x16x32_bf16 v[112:115], a[76:79], v[152:155], v[112:115]
  s_waitcnt vmcnt(33) lgkmcnt(4)
  v_mfma_f32_16x16x32_bf16 v[40:43], a[80:83], v[116:119], v[40:43]
  s_mul_i32 s55, s21, 80
  ds_read_b128 v[136:139], v21 offset:15360
  s_waitcnt vmcnt(32)
  v_mfma_f32_16x16x32_bf16 v[60:63], a[84:87], v[116:119], v[60:63]
  v_add_lshl_u32 v252, v252, s55, 4
  s_waitcnt vmcnt(31)
  v_mfma_f32_16x16x32_bf16 v[80:83], a[88:91], v[116:119], v[80:83]
  ds_read_b128 v[140:143], v21 offset:35840
  s_mov_b32 s63, 36864
  s_waitcnt lgkmcnt(5)
  v_mfma_f32_16x16x32_bf16 v[44:47], a[80:83], v[120:123], v[44:47]
  v_lshrrev_b32 v203, 5, v0
  v_mfma_f32_16x16x32_bf16 v[64:67], a[84:87], v[120:123], v[64:67]
  ds_read_b128 v[144:147], v21 offset:56320
  v_and_b32 v202, 1, v2
  v_mfma_f32_16x16x32_bf16 v[84:87], a[88:91], v[120:123], v[84:87]
  v_mul_u32_u24 v254, 160, v203
  s_waitcnt vmcnt(30)
  v_mfma_f32_16x16x32_bf16 v[100:103], a[92:95], v[120:123], v[100:103]
  ds_read_b128 v[148:151], v23 offset:15360
  v_add_u32 v254, v254, v1
  s_waitcnt lgkmcnt(6)
  v_mfma_f32_16x16x32_bf16 v[48:51], a[80:83], v[124:127], v[48:51]
  s_mul_i32 s55, s22, 320
  v_mfma_f32_16x16x32_bf16 v[68:71], a[84:87], v[124:127], v[68:71]
  ds_read_b128 v[152:155], v23 offset:35840
  v_mfma_f32_16x16x32_bf16 v[88:91], a[88:91], v[124:127], v[88:91]
  s_add_u32 s55, s55, 640
  v_add_u32 v254, s55, v254
  v_mfma_f32_16x16x32_bf16 v[104:107], a[92:95], v[124:127], v[104:107]
  buffer_load_dwordx4 a[172:175], v4, s[4:7], s40 offen offset:0 sc1
  s_waitcnt lgkmcnt(6)
  v_mfma_f32_16x16x32_bf16 v[52:55], a[80:83], v[128:131], v[52:55]
  v_mul_u32_u24 v255, 80, v202
  v_add_lshl_u32 v255, v255, v254, 4
  v_mfma_f32_16x16x32_bf16 v[72:75], a[84:87], v[128:131], v[72:75]
  buffer_load_dwordx4 a[176:179], v4, s[4:7], s36 offen offset:1024 sc1
  v_mfma_f32_16x16x32_bf16 v[92:95], a[88:91], v[128:131], v[92:95]
  v_lshl_add_u32 v254, v202, 4, v254
  v_lshlrev_b32 v254, 4, v254
  v_mfma_f32_16x16x32_bf16 v[108:111], a[92:95], v[128:131], v[108:111]
  buffer_load_dwordx4 a[180:183], v4, s[4:7], s37 offen offset:1024 sc1
  s_waitcnt lgkmcnt(5)
  v_mfma_f32_16x16x32_bf16 v[56:59], a[80:83], v[132:135], v[56:59]
  s_and_b32 s55, s22, 1
  s_mul_i32 s55, s55, 1280
  v_mfma_f32_16x16x32_bf16 v[76:79], a[84:87], v[132:135], v[76:79]
  buffer_load_dwordx4 a[184:187], v4, s[4:7], s38 offen offset:1024 sc1
  v_mfma_f32_16x16x32_bf16 v[96:99], a[88:91], v[132:135], v[96:99]
  s_cmp_ge_u32 s22, 2
  s_cselect_b32 s49, 0, 64
  v_mfma_f32_16x16x32_bf16 v[112:115], a[92:95], v[132:135], v[112:115]
  s_waitcnt vmcnt(33) lgkmcnt(4)
  v_mfma_f32_16x16x32_bf16 v[40:43], a[96:99], v[136:139], v[40:43]
  s_add_u32 s49, s49, s55
  ds_read_b128 v[116:119], v20 offset:16384
  s_waitcnt vmcnt(32)
  v_mfma_f32_16x16x32_bf16 v[60:63], a[100:103], v[136:139], v[60:63]
  s_add_u32 s49, s49, 159744
  s_waitcnt vmcnt(31)
  v_mfma_f32_16x16x32_bf16 v[80:83], a[104:107], v[136:139], v[80:83]
  ds_read_b128 v[120:123], v20 offset:36864
  v_mul_u32_u24 v250, 640, v203
  s_waitcnt lgkmcnt(5)
  v_mfma_f32_16x16x32_bf16 v[44:47], a[96:99], v[140:143], v[44:47]
  v_lshl_add_u32 v250, v202, 3, v250
  v_mfma_f32_16x16x32_bf16 v[64:67], a[100:103], v[140:143], v[64:67]
  ds_read_b128 v[124:127], v20 offset:57344
  v_lshrrev_b32 v203, 2, v1
  v_mfma_f32_16x16x32_bf16 v[84:87], a[104:107], v[140:143], v[84:87]
  v_lshl_add_u32 v250, v203, 4, v250
  s_waitcnt vmcnt(30)
  v_mfma_f32_16x16x32_bf16 v[100:103], a[108:111], v[140:143], v[100:103]
  ds_read_b128 v[128:131], v22 offset:16384
  v_and_b32 v203, 3, v1
  s_waitcnt lgkmcnt(6)
  v_mfma_f32_16x16x32_bf16 v[48:51], a[96:99], v[144:147], v[48:51]
  v_lshl_add_u32 v250, v203, 1, v250
  v_mfma_f32_16x16x32_bf16 v[68:71], a[100:103], v[144:147], v[68:71]
  ds_read_b128 v[132:135], v22 offset:36864
  v_mfma_f32_16x16x32_bf16 v[88:91], a[104:107], v[144:147], v[88:91]
  v_add_u32 v250, s49, v250
  v_lshrrev_b32 v3, 2, v1
  v_mfma_f32_16x16x32_bf16 v[104:107], a[108:111], v[144:147], v[104:107]
  buffer_load_dwordx4 a[188:191], v4, s[4:7], s39 offen offset:1024 sc1
  s_waitcnt lgkmcnt(6)
  v_mfma_f32_16x16x32_bf16 v[52:55], a[96:99], v[148:151], v[52:55]
  v_xor_b32 v3, v3, v2
  v_lshlrev_b32 v3, 3, v3
  v_mfma_f32_16x16x32_bf16 v[72:75], a[100:103], v[148:151], v[72:75]
  buffer_load_dwordx4 a[192:195], v4, s[4:7], s40 offen offset:1024 sc1
  v_mfma_f32_16x16x32_bf16 v[92:95], a[104:107], v[148:151], v[92:95]
  v_lshl_add_u32 v3, v1, 5, v3
  s_add_u32 s57, s22, 5
  v_mfma_f32_16x16x32_bf16 v[108:111], a[108:111], v[148:151], v[108:111]
  buffer_load_dwordx4 a[196:199], v4, s[4:7], s36 offen offset:2048 sc1
  s_waitcnt lgkmcnt(5)
  v_mfma_f32_16x16x32_bf16 v[56:59], a[96:99], v[152:155], v[56:59]
  s_add_u32 s58, s22, 10
  s_mov_b32 s60, s22
  v_mfma_f32_16x16x32_bf16 v[76:79], a[100:103], v[152:155], v[76:79]
  buffer_load_dwordx4 a[200:203], v4, s[4:7], s37 offen offset:2048 sc1
  v_mfma_f32_16x16x32_bf16 v[96:99], a[104:107], v[152:155], v[96:99]
  s_lshr_b32 s59, 0x0f040e09, s54
  v_mfma_f32_16x16x32_bf16 v[112:115], a[108:111], v[152:155], v[112:115]
  s_waitcnt vmcnt(33) lgkmcnt(4)
  v_mfma_f32_16x16x32_bf16 v[40:43], a[112:115], v[116:119], v[40:43]
  s_and_b32 s59, s59, 0xff
  ds_read_b128 v[136:139], v21 offset:17408
  s_waitcnt vmcnt(32)
  v_mfma_f32_16x16x32_bf16 v[60:63], a[116:119], v[116:119], v[60:63]
  s_mul_i32 s57, s57, 2560
  s_waitcnt vmcnt(31)
  v_mfma_f32_16x16x32_bf16 v[80:83], a[120:123], v[116:119], v[80:83]
  ds_read_b128 v[140:143], v21 offset:37888
  s_add_u32 s57, s57, 102400
  s_waitcnt lgkmcnt(5)
  v_mfma_f32_16x16x32_bf16 v[44:47], a[112:115], v[120:123], v[44:47]
  v_add_u32 v24, s57, v3
  v_mfma_f32_16x16x32_bf16 v[64:67], a[116:119], v[120:123], v[64:67]
  ds_read_b128 v[144:147], v21 offset:58368
  s_mul_i32 s58, s58, 2560
  v_mfma_f32_16x16x32_bf16 v[84:87], a[120:123], v[120:123], v[84:87]
  s_add_u32 s58, s58, 102400
  s_waitcnt vmcnt(30)
  v_mfma_f32_16x16x32_bf16 v[100:103], a[124:127], v[120:123], v[100:103]
  ds_read_b128 v[148:151], v23 offset:17408
  v_add_u32 v25, s58, v3
  s_waitcnt lgkmcnt(6)
  v_mfma_f32_16x16x32_bf16 v[48:51], a[112:115], v[124:127], v[48:51]
  s_mul_i32 s59, s59, 2560
  v_mfma_f32_16x16x32_bf16 v[68:71], a[116:119], v[124:127], v[68:71]
  ds_read_b128 v[152:155], v23 offset:37888
  v_mfma_f32_16x16x32_bf16 v[88:91], a[120:123], v[124:127], v[88:91]
  s_add_u32 s59, s59, 102400
  v_add_u32 v26, s59, v3
  v_mfma_f32_16x16x32_bf16 v[104:107], a[124:127], v[124:127], v[104:107]
  buffer_load_dwordx4 a[204:207], v4, s[4:7], s38 offen offset:2048 sc1
  s_waitcnt lgkmcnt(6)
  v_mfma_f32_16x16x32_bf16 v[52:55], a[112:115], v[128:131], v[52:55]
  s_mul_i32 s60, s60, 2560
  s_add_u32 s60, s60, 102400
  v_mfma_f32_16x16x32_bf16 v[72:75], a[116:119], v[128:131], v[72:75]
  buffer_load_dwordx4 a[208:211], v4, s[4:7], s39 offen offset:2048 sc1
  v_mfma_f32_16x16x32_bf16 v[92:95], a[120:123], v[128:131], v[92:95]
  v_add_u32 v27, s60, v3
  s_lshl_b32 s57, s22, 9
  v_mfma_f32_16x16x32_bf16 v[108:111], a[124:127], v[128:131], v[108:111]
  buffer_load_dwordx4 a[212:215], v4, s[4:7], s40 offen offset:2048 sc1
  s_waitcnt lgkmcnt(5)
  v_mfma_f32_16x16x32_bf16 v[56:59], a[112:115], v[132:135], v[56:59]
  s_add_u32 s57, s57, 102400
  v_add_u32 v28, s57, v3
  v_mfma_f32_16x16x32_bf16 v[76:79], a[116:119], v[132:135], v[76:79]
  buffer_load_dwordx4 a[216:219], v4, s[4:7], s36 offen offset:3072 sc1
  v_mfma_f32_16x16x32_bf16 v[96:99], a[120:123], v[132:135], v[96:99]
  v_and_b32 v3, 3, v1
  v_mfma_f32_16x16x32_bf16 v[112:115], a[124:127], v[132:135], v[112:115]
  s_waitcnt vmcnt(32) lgkmcnt(4)
  v_mfma_f32_16x16x32_bf16 v[40:43], a[128:131], v[136:139], v[40:43]
  v_xor_b32 v3, v3, v2
  ds_read_b128 v[116:119], v20 offset:18432
  s_waitcnt vmcnt(31)
  v_mfma_f32_16x16x32_bf16 v[60:63], a[132:135], v[136:139], v[60:63]
  v_lshlrev_b32 v3, 3, v3
  s_waitcnt vmcnt(29)
  v_mfma_f32_16x16x32_bf16 v[80:83], a[136:139], v[136:139], v[80:83]
  v_and_b32 v10, 60, v0
  ds_read_b128 v[120:123], v20 offset:38912
  s_waitcnt lgkmcnt(5)
  v_mfma_f32_16x16x32_bf16 v[44:47], a[128:131], v[140:143], v[44:47]
  v_lshl_add_u32 v3, v10, 3, v3
  v_mfma_f32_16x16x32_bf16 v[64:67], a[132:135], v[140:143], v[64:67]
  v_add_u32 v29, s57, v3
  ds_read_b128 v[124:127], v20 offset:59392
  v_mfma_f32_16x16x32_bf16 v[84:87], a[136:139], v[140:143], v[84:87]
  v_and_b32 v3, 1, v1
  s_waitcnt vmcnt(28)
  v_mfma_f32_16x16x32_bf16 v[100:103], a[140:143], v[140:143], v[100:103]
  v_cmp_eq_u32 s[74:75], 1, v3
  ds_read_b128 v[128:131], v22 offset:18432
  s_waitcnt lgkmcnt(6)
  v_mfma_f32_16x16x32_bf16 v[48:51], a[128:131], v[144:147], v[48:51]
  v_lshl_add_u32 v10, v2, 2, v3
  v_mfma_f32_16x16x32_bf16 v[68:71], a[132:135], v[144:147], v[68:71]
  v_cmp_le_u32 s[76:77], v10, v1
  ds_read_b128 v[132:135], v22 offset:38912
  v_mfma_f32_16x16x32_bf16 v[88:91], a[136:139], v[144:147], v[88:91]
  v_add_u32 v10, 2, v10
  v_mfma_f32_16x16x32_bf16 v[104:107], a[140:143], v[144:147], v[104:107]
  v_cmp_le_u32 s[78:79], v10, v1
  buffer_load_dwordx4 a[220:223], v4, s[4:7], s37 offen offset:3072 sc1
  s_waitcnt lgkmcnt(6)
  v_mfma_f32_16x16x32_bf16 v[52:55], a[128:131], v[148:151], v[52:55]
  v_mov_b32 v10, 0x0c0c0100
  v_mfma_f32_16x16x32_bf16 v[72:75], a[132:135], v[148:151], v[72:75]
  v_mov_b32 v11, 0x01000c0c
  buffer_load_dwordx4 a[224:227], v4, s[4:7], s38 offen offset:3072 sc1
  v_mfma_f32_16x16x32_bf16 v[92:95], a[136:139], v[148:151], v[92:95]
  v_cndmask_b32 v10, v10, v11, s[74:75]
  v_mfma_f32_16x16x32_bf16 v[108:111], a[140:143], v[148:151], v[108:111]
  v_mov_b32 v11, 0x0c0c0302
  buffer_load_dwordx4 a[228:231], v4, s[4:7], s39 offen offset:3072 sc1
  s_waitcnt lgkmcnt(5)
  v_mfma_f32_16x16x32_bf16 v[56:59], a[128:131], v[152:155], v[56:59]
  v_mov_b32 v12, 0x03020c0c
  v_mfma_f32_16x16x32_bf16 v[76:79], a[132:135], v[152:155], v[76:79]
  v_cndmask_b32 v11, v11, v12, s[74:75]
  buffer_load_dwordx4 a[232:235], v4, s[4:7], s40 offen offset:3072 sc1
  v_mfma_f32_16x16x32_bf16 v[96:99], a[136:139], v[152:155], v[96:99]
  s_lshl_b32 s51, s22, 8
  s_add_u32 s51, s51, 303104
  v_lshlrev_b32 v233, 2, v0
  buffer_load_dword v232, v233, s[4:7], s51 offen sc1 sc0
  v_mfma_f32_16x16x32_bf16 v[112:115], a[140:143], v[152:155], v[112:115]
  s_waitcnt vmcnt(32) lgkmcnt(4)
  v_mfma_f32_16x16x32_bf16 v[40:43], a[0:3], v[116:119], v[40:43]
  v_mov_b32 v12, 0x0c0c0c0c
  ds_read_b128 v[136:139], v21 offset:19456
  s_waitcnt vmcnt(31)
  v_mfma_f32_16x16x32_bf16 v[60:63], a[4:7], v[116:119], v[60:63]
  v_cndmask_b32 v30, v10, v12, s[76:77]
  s_waitcnt vmcnt(30)
  v_mfma_f32_16x16x32_bf16 v[80:83], a[8:11], v[116:119], v[80:83]
  ds_read_b128 v[140:143], v21 offset:39936
  v_cndmask_b32 v31, v11, v12, s[78:79]
  s_waitcnt lgkmcnt(5)
  v_mfma_f32_16x16x32_bf16 v[44:47], a[0:3], v[120:123], v[44:47]
  v_cndmask_b32 v32, v12, v10, s[76:77]
  v_mfma_f32_16x16x32_bf16 v[64:67], a[4:7], v[120:123], v[64:67]
  ds_read_b128 v[144:147], v21 offset:60416
  v_cndmask_b32 v33, v12, v11, s[78:79]
  v_mfma_f32_16x16x32_bf16 v[84:87], a[8:11], v[120:123], v[84:87]
  s_or_b32 s57, s20, s22
  s_waitcnt vmcnt(29)
  v_mfma_f32_16x16x32_bf16 v[100:103], a[12:15], v[120:123], v[100:103]
  ds_read_b128 v[148:151], v23 offset:19456
  s_cmp_eq_u32 s57, 0
  s_waitcnt lgkmcnt(6)
  v_mfma_f32_16x16x32_bf16 v[48:51], a[0:3], v[124:127], v[48:51]
  s_cselect_b32 s57, 0xf149f2ca, 0
  v_mfma_f32_16x16x32_bf16 v[68:71], a[4:7], v[124:127], v[68:71]
  ds_read_b128 v[152:155], v23 offset:39936
  v_mfma_f32_16x16x32_bf16 v[88:91], a[8:11], v[124:127], v[88:91]
  v_mov_b32 v34, s57
  v_mov_b32 v35, s57
  v_mfma_f32_16x16x32_bf16 v[104:107], a[12:15], v[124:127], v[104:107]
  buffer_load_dwordx4 a[236:239], v5, s[4:7], s36 offen offset:0 sc1
  s_waitcnt lgkmcnt(6)
  v_mfma_f32_16x16x32_bf16 v[52:55], a[0:3], v[128:131], v[52:55]
  v_mov_b32 v36, s57
  v_mov_b32 v37, s57
  v_mfma_f32_16x16x32_bf16 v[72:75], a[4:7], v[128:131], v[72:75]
  buffer_load_dwordx4 a[240:243], v5, s[4:7], s37 offen offset:0 sc1
  v_mfma_f32_16x16x32_bf16 v[92:95], a[8:11], v[128:131], v[92:95]
  v_mov_b32 v160, 0
  v_mov_b32 v161, 0
  v_mfma_f32_16x16x32_bf16 v[108:111], a[12:15], v[128:131], v[108:111]
  buffer_load_dwordx4 a[244:247], v5, s[4:7], s38 offen offset:0 sc1
  s_waitcnt lgkmcnt(5)
  v_mfma_f32_16x16x32_bf16 v[56:59], a[0:3], v[132:135], v[56:59]
  v_mov_b32 v162, 0
  v_mov_b32 v163, 0
  v_mfma_f32_16x16x32_bf16 v[76:79], a[4:7], v[132:135], v[76:79]
  buffer_load_dwordx4 a[248:251], v5, s[4:7], s39 offen offset:0 sc1
  v_mfma_f32_16x16x32_bf16 v[96:99], a[8:11], v[132:135], v[96:99]
  v_mov_b32 v164, 0
  v_mfma_f32_16x16x32_bf16 v[112:115], a[12:15], v[132:135], v[112:115]
  s_waitcnt vmcnt(28) lgkmcnt(4)
  v_mfma_f32_16x16x32_bf16 v[40:43], a[16:19], v[136:139], v[40:43]
  v_mov_b32 v165, 0
  s_waitcnt vmcnt(27)
  v_mfma_f32_16x16x32_bf16 v[60:63], a[20:23], v[136:139], v[60:63]
  buffer_load_dwordx4 a[252:255], v5, s[4:7], s40 offen offset:0 sc1
  s_waitcnt vmcnt(27)
  v_mfma_f32_16x16x32_bf16 v[80:83], a[24:27], v[136:139], v[80:83]
  v_mov_b32 v166, 0
  s_waitcnt lgkmcnt(3)
  v_mfma_f32_16x16x32_bf16 v[44:47], a[16:19], v[140:143], v[44:47]
  v_mov_b32 v167, 0
  v_mfma_f32_16x16x32_bf16 v[64:67], a[20:23], v[140:143], v[64:67]
  v_mov_b32 v168, 0
  v_mfma_f32_16x16x32_bf16 v[84:87], a[24:27], v[140:143], v[84:87]
  v_mov_b32 v169, 0
  s_waitcnt vmcnt(26)
  v_mfma_f32_16x16x32_bf16 v[100:103], a[28:31], v[140:143], v[100:103]
  v_mov_b32 v170, 0
  s_waitcnt lgkmcnt(2)
  v_mfma_f32_16x16x32_bf16 v[48:51], a[16:19], v[144:147], v[48:51]
  v_mov_b32 v171, 0
  v_mfma_f32_16x16x32_bf16 v[68:71], a[20:23], v[144:147], v[68:71]
  v_mov_b32 v172, 0
  v_mfma_f32_16x16x32_bf16 v[88:91], a[24:27], v[144:147], v[88:91]
  v_mov_b32 v173, 0
  v_mfma_f32_16x16x32_bf16 v[104:107], a[28:31], v[144:147], v[104:107]
  v_mov_b32 v174, 0
  s_waitcnt lgkmcnt(1)
  v_mfma_f32_16x16x32_bf16 v[52:55], a[16:19], v[148:151], v[52:55]
  v_mov_b32 v175, 0
  v_mfma_f32_16x16x32_bf16 v[72:75], a[20:23], v[148:151], v[72:75]
  buffer_load_dwordx4 v[228:231], v252, s[4:7], s63 offen sc1
  v_mfma_f32_16x16x32_bf16 v[92:95], a[24:27], v[148:151], v[92:95]
  buffer_load_dwordx4 v[208:211], v254, s[4:7], s63 offen offset:0 sc1
  v_mfma_f32_16x16x32_bf16 v[108:111], a[28:31], v[148:151], v[108:111]
  buffer_load_dwordx4 v[212:215], v254, s[4:7], s63 offen offset:512 sc1
  s_waitcnt lgkmcnt(0)
  v_mfma_f32_16x16x32_bf16 v[56:59], a[16:19], v[152:155], v[56:59]
  buffer_load_dwordx4 v[216:219], v254, s[4:7], s63 offen offset:1280 sc1
  v_mfma_f32_16x16x32_bf16 v[76:79], a[20:23], v[152:155], v[76:79]
  buffer_load_dwordx4 v[220:223], v254, s[4:7], s63 offen offset:1792 sc1
  v_mfma_f32_16x16x32_bf16 v[96:99], a[24:27], v[152:155], v[96:99]
  buffer_load_dwordx4 v[224:227], v255, s[4:7], s63 offen offset:1024 sc1
  v_mfma_f32_16x16x32_bf16 v[112:115], a[28:31], v[152:155], v[112:115]
  v_cvt_pk_bf16_f32 v40, v40, v41
  v_cvt_pk_bf16_f32 v41, v42, v43
  ds_write_b64 v24, v[40:41] offset:0
  v_cvt_pk_bf16_f32 v44, v44, v45
  v_cvt_pk_bf16_f32 v45, v46, v47
  ds_write_b64 v24, v[44:45] offset:512
  v_cvt_pk_bf16_f32 v48, v48, v49
  v_cvt_pk_bf16_f32 v49, v50, v51
  ds_write_b64 v24, v[48:49] offset:1024
  v_cvt_pk_bf16_f32 v52, v52, v53
  v_cvt_pk_bf16_f32 v53, v54, v55
  ds_write_b64 v24, v[52:53] offset:1536
  v_cvt_pk_bf16_f32 v56, v56, v57
  v_cvt_pk_bf16_f32 v57, v58, v59
  ds_write_b64 v24, v[56:57] offset:2048
  v_cvt_pk_bf16_f32 v60, v60, v61
  v_cvt_pk_bf16_f32 v61, v62, v63
  ds_write_b64 v25, v[60:61] offset:0
  v_cvt_pk_bf16_f32 v64, v64, v65
  v_cvt_pk_bf16_f32 v65, v66, v67
  ds_write_b64 v25, v[64:65] offset:512
  v_cvt_pk_bf16_f32 v68, v68, v69
  v_cvt_pk_bf16_f32 v69, v70, v71
  ds_write_b64 v25, v[68:69] offset:1024
  v_cvt_pk_bf16_f32 v72, v72, v73
  v_cvt_pk_bf16_f32 v73, v74, v75
  ds_write_b64 v25, v[72:73] offset:1536
  v_cvt_pk_bf16_f32 v76, v76, v77
  v_cvt_pk_bf16_f32 v77, v78, v79
  ds_write_b64 v25, v[76:77] offset:2048
  v_cvt_pk_bf16_f32 v80, v80, v81
  v_cvt_pk_bf16_f32 v81, v82, v83
  ds_write_b64 v26, v[80:81] offset:0
  v_cvt_pk_bf16_f32 v84, v84, v85
  v_cvt_pk_bf16_f32 v85, v86, v87
  ds_write_b64 v26, v[84:85] offset:512
  v_cvt_pk_bf16_f32 v88, v88, v89
  v_cvt_pk_bf16_f32 v89, v90, v91
  ds_write_b64 v26, v[88:89] offset:1024
  v_cvt_pk_bf16_f32 v92, v92, v93
  v_cvt_pk_bf16_f32 v93, v94, v95
  ds_write_b64 v26, v[92:93] offset:1536
  v_cvt_pk_bf16_f32 v96, v96, v97
  v_cvt_pk_bf16_f32 v97, v98, v99
  ds_write_b64 v26, v[96:97] offset:2048
  v_cvt_pk_bf16_f32 v100, v100, v101
  v_cvt_pk_bf16_f32 v101, v102, v103
  ds_write_b64 v27, v[100:101] offset:512
  v_cvt_pk_bf16_f32 v104, v104, v105
  v_cvt_pk_bf16_f32 v105, v106, v107
  ds_write_b64 v27, v[104:105] offset:1024
  v_cvt_pk_bf16_f32 v108, v108, v109
  v_cvt_pk_bf16_f32 v109, v110, v111
  ds_write_b64 v27, v[108:109] offset:1536
  v_cvt_pk_bf16_f32 v112, v112, v113
  v_cvt_pk_bf16_f32 v113, v114, v115
  ds_write_b64 v27, v[112:113] offset:2048
  s_waitcnt vmcnt(11)
  v_subrev_u32 v232, s24, v232
  v_cmp_gt_u32 vcc, 16, v232
  s_or_b32 s49, s2, s22
  s_cmp_eq_u32 s49, 0
  s_cselect_b32 s3, 0, 0x80000000
  s_nop 0
  s_cmp_eq_u64 vcc, -1
  s_cbranch_scc0 FBSPIN
FBDONE:
  s_and_b32 s51, s50, -32
  v_mov_b32 v236, s24
  v_mov_b32 v237, s3
  s_mov_b32 s3, 294912
  s_waitcnt lgkmcnt(0)
  s_barrier
  buffer_load_dword v232, v9, s[4:7], s51 offen sc1 sc0
  buffer_store_dword v236, v237, s[4:7], s3 offen sc1
  buffer_load_dwordx4 a[0:3], v4, s[4:7], s41 offen offset:0 sc1
  buffer_load_dwordx4 a[4:7], v4, s[4:7], s42 offen offset:0 sc1
  buffer_load_dwordx4 a[8:11], v4, s[4:7], s43 offen offset:0 sc1
  buffer_load_dwordx4 a[12:15], v4, s[4:7], s41 offen offset:1024 sc1
  buffer_load_dwordx4 a[16:19], v4, s[4:7], s42 offen offset:1024 sc1
  buffer_load_dwordx4 a[20:23], v4, s[4:7], s43 offen offset:1024 sc1
  ds_read_b64 v[120:121], v28 offset:12800
  ds_read_b64 v[130:131], v28 offset:13312
  ds_read_b64 v[122:123], v28 offset:15360
  ds_read_b64 v[132:133], v28 offset:15872
  ds_read_b64 v[124:125], v28 offset:17920
  ds_read_b64 v[134:135], v28 offset:18432
  ds_read_b64 v[126:127], v28 offset:20480
  ds_read_b64 v[136:137], v28 offset:20992
  ds_read_b64 v[128:129], v28 offset:23040
  ds_read_b64 v[138:139], v28 offset:23552
  s_mov_b32 exec_lo, 0xffffffff
  s_mov_b32 exec_hi, 0xffffffff
  ds_read_b64 v[160:161], v28 offset:512
  s_mov_b32 exec_lo, 0xffff
  s_mov_b32 exec_hi, 0x0
  ds_read_b64 v[162:163], v28 offset:3072
  s_mov_b32 exec_lo, 0xffff0000
  s_mov_b32 exec_hi, 0xffffffff
  ds_read_b64 v[164:165], v28 offset:3072
  s_mov_b32 exec_lo, 0xffffffff
  s_mov_b32 exec_hi, 0x0
  ds_read_b64 v[166:167], v28 offset:5632
  s_mov_b32 exec_lo, 0x0
  s_mov_b32 exec_hi, 0xffffffff
  ds_read_b64 v[168:169], v28 offset:5632
  s_mov_b32 exec_lo, 0xffffffff
  s_mov_b32 exec_hi, 0xffff
  ds_read_b64 v[170:171], v28 offset:8192
  s_mov_b32 exec_lo, 0x0
  s_mov_b32 exec_hi, 0xffff0000
  ds_read_b64 v[172:173], v28 offset:8192
  s_mov_b32 exec_lo, 0xffffffff
  s_mov_b32 exec_hi, 0xffffffff
  ds_read_b64 v[174:175], v28 offset:10752
  ds_read_b64_tr_b16 v[140:141], v29 offset:25600
  ds_read_b64_tr_b16 v[142:143], v29 offset:26112
  ds_read_b64_tr_b16 v[144:145], v29 offset:28160
  ds_read_b64_tr_b16 v[146:147], v29 offset:28672
  ds_read_b64_tr_b16 v[148:149], v29 offset:30720
  ds_read_b64_tr_b16 v[150:151], v29 offset:31232
  ds_read_b64_tr_b16 v[152:153], v29 offset:33280
  ds_read_b64_tr_b16 v[154:155], v29 offset:33792
  ds_read_b64_tr_b16 v[156:157], v29 offset:35840
  ds_read_b64_tr_b16 v[158:159], v29 offset:36352
  s_waitcnt lgkmcnt(15)
  v_mfma_f32_16x16x32_bf16 v[176:179], v[120:123], v[160:163], v[34:37]
  v_mfma_f32_16x16x32_bf16 v[180:183], v[130:133], v[160:163], 0
  s_waitcnt lgkmcnt(14)
  v_mfma_f32_16x16x32_bf16 v[184:187], v[122:125], v[164:167], v[34:37]
  v_mfma_f32_16x16x32_bf16 v[188:191], v[132:135], v[164:167], 0
  s_waitcnt lgkmcnt(12)
  v_mfma_f32_16x16x32_bf16 v[192:195], v[124:127], v[168:171], v[34:37]
  v_mfma_f32_16x16x32_bf16 v[196:199], v[134:137], v[168:171], 0
  s_waitcnt lgkmcnt(10)
  v_mfma_f32_16x16x32_bf16 v[200:203], v[126:129], v[172:175], v[34:37]
  v_mfma_f32_16x16x32_bf16 v[204:207], v[136:139], v[172:175], 0
  v_cndmask_b32 v176, v176, v177, s[74:75]
  buffer_load_dwordx4 a[24:27], v4, s[4:7], s41 offen offset:2048 sc1
  v_cndmask_b32 v178, v178, v179, s[74:75]
  v_cndmask_b32 v180, v180, v181, s[74:75]
  v_cndmask_b32 v182, v182, v183, s[74:75]
  v_cndmask_b32 v176, v176, v180, s[76:77]
  buffer_load_dwordx4 a[28:31], v4, s[4:7], s42 offen offset:2048 sc1
  v_cndmask_b32 v177, v178, v182, s[78:79]
  v_cndmask_b32 v184, v184, v185, s[74:75]
  v_cndmask_b32 v186, v186, v187, s[74:75]
  v_cndmask_b32 v188, v188, v189, s[74:75]
  v_cndmask_b32 v190, v190, v191, s[74:75]
  buffer_load_dwordx4 a[32:35], v4, s[4:7], s43 offen offset:2048 sc1
  v_cndmask_b32 v184, v184, v188, s[76:77]
  v_cndmask_b32 v185, v186, v190, s[78:79]
  v_cndmask_b32 v192, v192, v193, s[74:75]
  v_cndmask_b32 v194, v194, v195, s[74:75]
  buffer_load_dwordx4 a[36:39], v4, s[4:7], s41 offen offset:3072 sc1
  v_cndmask_b32 v196, v196, v197, s[74:75]
  v_cndmask_b32 v198, v198, v199, s[74:75]
  v_cndmask_b32 v192, v192, v196, s[76:77]
  v_cndmask_b32 v193, v194, v198, s[78:79]
  v_cndmask_b32 v200, v200, v201, s[74:75]
  buffer_load_dwordx4 a[40:43], v4, s[4:7], s42 offen offset:3072 sc1
  v_cndmask_b32 v202, v202, v203, s[74:75]
  v_cndmask_b32 v204, v204, v205, s[74:75]
  v_cndmask_b32 v206, v206, v207, s[74:75]
  v_cndmask_b32 v200, v200, v204, s[76:77]
  v_cndmask_b32 v201, v202, v206, s[78:79]
  buffer_load_dwordx4 a[44:47], v4, s[4:7], s43 offen offset:3072 sc1
  v_max_f32 v178, v176, v177
  v_max_f32 v186, v184, v185
  v_max_f32 v194, v192, v193
  v_max_f32 v202, v200, v201
  buffer_load_dwordx4 a[48:51], v5, s[4:7], s41 offen offset:0 sc1
  v_mov_b32 v179, v178
  v_mov_b32 v187, v186
  v_mov_b32 v195, v194
  v_mov_b32 v203, v202
  v_permlane16_swap_b32 v178, v179
  buffer_load_dwordx4 a[52:55], v5, s[4:7], s42 offen offset:0 sc1
  v_permlane16_swap_b32 v186, v187
  v_permlane16_swap_b32 v194, v195
  v_permlane16_swap_b32 v202, v203
  v_max_f32 v178, v178, v179
  v_max_f32 v186, v186, v187
  buffer_load_dwordx4 a[56:59], v5, s[4:7], s43 offen offset:0 sc1
  v_max_f32 v194, v194, v195
  v_max_f32 v202, v202, v203
  v_mov_b32 v179, v178
  v_mov_b32 v187, v186
  buffer_load_dwordx4 a[60:63], v5, s[4:7], s41 offen offset:1024 sc1
  v_mov_b32 v195, v194
  v_mov_b32 v203, v202
  v_permlane32_swap_b32 v178, v179
  v_permlane32_swap_b32 v186, v187
  v_permlane32_swap_b32 v194, v195
  buffer_load_dwordx4 a[64:67], v5, s[4:7], s42 offen offset:1024 sc1
  v_permlane32_swap_b32 v202, v203
  v_max_f32 v178, v178, v179
  v_max_f32 v186, v186, v187
  v_max_f32 v194, v194, v195
  v_max_f32 v202, v202, v203
  buffer_load_dwordx4 a[68:71], v5, s[4:7], s43 offen offset:1024 sc1
  s_mov_b32 s57, 0x3ea52b5c
  v_mul_f32 v178, 0xbea52b5c, v178
  v_mul_f32 v186, 0xbea52b5c, v186
  v_mul_f32 v194, 0xbea52b5c, v194
  buffer_load_dwordx4 a[72:75], v5, s[4:7], s41 offen offset:2048 sc1
  v_mul_f32 v202, 0xbea52b5c, v202
  v_fma_f32 v176, v176, s57, v178
  v_fma_f32 v177, v177, s57, v178
  v_fma_f32 v184, v184, s57, v186
  v_fma_f32 v185, v185, s57, v186
  buffer_load_dwordx4 a[76:79], v5, s[4:7], s42 offen offset:2048 sc1
  v_fma_f32 v192, v192, s57, v194
  v_fma_f32 v193, v193, s57, v194
  v_fma_f32 v200, v200, s57, v202
  v_fma_f32 v201, v201, s57, v202
  buffer_load_dwordx4 a[80:83], v5, s[4:7], s43 offen offset:2048 sc1
  v_exp_f32 v176, v176
  v_exp_f32 v177, v177
  v_exp_f32 v184, v184
  v_exp_f32 v185, v185
  v_exp_f32 v192, v192
  buffer_load_dwordx4 a[84:87], v5, s[4:7], s41 offen offset:3072 sc1
  v_exp_f32 v193, v193
  v_exp_f32 v200, v200
  v_exp_f32 v201, v201
  v_add_f32 v178, v176, v177
  v_add_f32 v186, v184, v185
  buffer_load_dwordx4 a[88:91], v5, s[4:7], s42 offen offset:3072 sc1
  v_add_f32 v194, v192, v193
  v_add_f32 v202, v200, v201
  v_mov_b32 v179, v178
  v_mov_b32 v187, v186
  buffer_load_dwordx4 a[92:95], v5, s[4:7], s43 offen offset:3072 sc1
  v_mov_b32 v195, v194
  v_mov_b32 v203, v202
  v_permlane16_swap_b32 v178, v179
  v_permlane16_swap_b32 v186, v187
  v_permlane16_swap_b32 v194, v195
  buffer_load_dwordx4 a[96:99], v6, s[4:7], s41 offen offset:0 sc1
  v_permlane16_swap_b32 v202, v203
  v_add_f32 v178, v178, v179
  v_add_f32 v186, v186, v187
  v_add_f32 v194, v194, v195
  v_add_f32 v202, v202, v203
  buffer_load_dwordx4 a[100:103], v6, s[4:7], s42 offen offset:0 sc1
  v_mov_b32 v179, v178
  v_mov_b32 v187, v186
  v_mov_b32 v195, v194
  v_mov_b32 v203, v202
  buffer_load_dwordx4 a[104:107], v6, s[4:7], s43 offen offset:0 sc1
  v_permlane32_swap_b32 v178, v179
  v_permlane32_swap_b32 v186, v187
  v_permlane32_swap_b32 v194, v195
  v_permlane32_swap_b32 v202, v203
  v_add_f32 v178, v178, v179
  buffer_load_dwordx4 a[108:111], v6, s[4:7], s41 offen offset:1024 sc1
  v_add_f32 v186, v186, v187
  v_add_f32 v194, v194, v195
  v_add_f32 v202, v202, v203
  v_rcp_f32 v178, v178
  v_rcp_f32 v186, v186
  v_rcp_f32 v194, v194
  v_rcp_f32 v202, v202
  v_mul_f32 v176, v176, v178
  v_mul_f32 v177, v177, v178
  v_mul_f32 v184, v184, v186
  v_mul_f32 v185, v185, v186
  v_mul_f32 v192, v192, v194
  v_mul_f32 v193, v193, v194
  v_mul_f32 v200, v200, v202
  v_mul_f32 v201, v201, v202
  v_cvt_pk_bf16_f32 v176, v176, v177
  v_cvt_pk_bf16_f32 v184, v184, v185
  v_cvt_pk_bf16_f32 v192, v192, v193
  v_cvt_pk_bf16_f32 v200, v200, v201
  v_perm_b32 v180, v176, v176, v30
  v_perm_b32 v181, v176, v176, v31
  v_perm_b32 v182, v176, v176, v32
  v_perm_b32 v183, v176, v176, v33
  v_perm_b32 v188, v184, v184, v30
  v_perm_b32 v189, v184, v184, v31
  v_perm_b32 v190, v184, v184, v32
  v_perm_b32 v191, v184, v184, v33
  v_perm_b32 v196, v192, v192, v30
  v_perm_b32 v197, v192, v192, v31
  v_perm_b32 v198, v192, v192, v32
  v_perm_b32 v199, v192, v192, v33
  v_perm_b32 v204, v200, v200, v30
  v_perm_b32 v205, v200, v200, v31
  v_perm_b32 v206, v200, v200, v32
  v_perm_b32 v207, v200, v200, v33
  s_waitcnt lgkmcnt(8)
  v_mfma_f32_16x16x32_bf16 v[40:43], v[140:143], v[180:183], 0
  s_waitcnt lgkmcnt(6)
  v_mfma_f32_16x16x32_bf16 v[44:47], v[144:147], v[180:183], 0
  v_mfma_f32_16x16x32_bf16 v[48:51], v[144:147], v[188:191], 0
  s_waitcnt lgkmcnt(4)
  v_mfma_f32_16x16x32_bf16 v[52:55], v[148:151], v[188:191], 0
  v_mfma_f32_16x16x32_bf16 v[56:59], v[148:151], v[196:199], 0
  s_waitcnt lgkmcnt(2)
  v_mfma_f32_16x16x32_bf16 v[60:63], v[152:155], v[196:199], 0
  v_mfma_f32_16x16x32_bf16 v[64:67], v[152:155], v[204:207], 0
  s_waitcnt lgkmcnt(0)
  v_mfma_f32_16x16x32_bf16 v[68:71], v[156:159], v[204:207], 0
  s_mul_i32 s28, s20, 98304
  s_add_u32 s28, s28, 9437184
  s_mul_i32 s57, s22, 20480
  s_add_u32 s57, s57, s28
  s_lshr_b32 s3, s21, 1
  s_mul_i32 s3, s3, 5120
  s_add_u32 s57, s57, s3
  s_and_b32 s3, s21, 1
  s_lshl3_add_u32 s58, s3, s57
  s_add_u32 s58, s58, 4096
  s_lshl_b32 s3, s3, 11
  s_add_u32 s57, s57, s3
  v_cvt_pk_bf16_f32 v80, v40, v41
  v_cvt_pk_bf16_f32 v81, v42, v43
  v_cvt_pk_bf16_f32 v82, v44, v45
  v_cvt_pk_bf16_f32 v83, v46, v47
  v_cvt_pk_bf16_f32 v84, v52, v53
  v_cvt_pk_bf16_f32 v85, v54, v55
  v_cvt_pk_bf16_f32 v86, v60, v61
  v_cvt_pk_bf16_f32 v87, v62, v63
  v_cvt_pk_bf16_f32 v88, v68, v69
  v_cvt_pk_bf16_f32 v89, v70, v71
  s_mov_b32 exec_lo, 0xffff0000
  s_mov_b32 exec_hi, 0xffffffff
  v_cvt_pk_bf16_f32 v82, v48, v49
  v_cvt_pk_bf16_f32 v83, v50, v51
  s_mov_b32 exec_lo, 0x0
  s_mov_b32 exec_hi, 0xffffffff
  v_cvt_pk_bf16_f32 v84, v56, v57
  v_cvt_pk_bf16_f32 v85, v58, v59
  s_mov_b32 exec_lo, 0x0
  s_mov_b32 exec_hi, 0xffff0000
  v_cvt_pk_bf16_f32 v86, v64, v65
  v_cvt_pk_bf16_f32 v87, v66, v67
  s_mov_b64 exec, -1
  s_waitcnt vmcnt(29)
  v_cmp_eq_u32 vcc, s25, v232
  s_nop 3
  s_cmp_eq_u64 vcc, -1
  s_cselect_b32 s23, 1, 0
  s_cmp_eq_u32 s23, 0
  s_cbranch_scc1 SLOW1
  buffer_store_dwordx4 v[80:83], v4, s[4:7], s57 offen
  buffer_store_dwordx4 v[84:87], v4, s[4:7], s57 offen offset:1024
  buffer_store_dwordx2 v[88:89], v4, s[4:7], s58 offen
RET1:
  s_mul_i32 s3, s22, 5120
  s_add_u32 s57, s28, s3
  s_add_u32 s3, s22, 1
  s_and_b32 s3, s3, 3
  s_mul_i32 s58, s3, 20480
  s_add_u32 s32, s58, s57
  s_mul_i32 s58, s3, 15360
  s_add_u32 s58, s58, 0
  v_add_u32 v20, s58, v4
  s_add_u32 s3, s22, 2
  s_and_b32 s3, s3, 3
  s_mul_i32 s58, s3, 20480
  s_add_u32 s33, s58, s57
  s_mul_i32 s58, s3, 15360
  s_add_u32 s58, s58, 5120
  v_add_u32 v21, s58, v4
  s_add_u32 s3, s22, 3
  s_and_b32 s3, s3, 3
  s_mul_i32 s58, s3, 20480
  s_add_u32 s34, s58, s57
  s_mul_i32 s58, s3, 15360
  s_add_u32 s58, s58, 10240
  v_add_u32 v22, s58, v4
  s_add_u32 s3, s22, 4
  s_and_b32 s3, s3, 3
  s_mul_i32 s58, s3, 20480
  s_add_u32 s35, s58, s57
  s_mul_i32 s58, s22, 15360
  v_add_u32 v23, s58, v4
  v_lshlrev_b32 v24, 4, v2
  v_add_u32 v24, 162304, v24
  s_mov_b32 s3, s24
  v_xor_b32 v232, s3, v208
  v_bitop3_b32 v232, v232, s3, v209 bitop3:0xf6
  v_bitop3_b32 v232, v232, s3, v210 bitop3:0xf6
  v_bitop3_b32 v232, v232, s3, v211 bitop3:0xf6
  v_bitop3_b32 v232, v232, s3, v212 bitop3:0xf6
  v_bitop3_b32 v232, v232, s3, v213 bitop3:0xf6
  v_bitop3_b32 v232, v232, s3, v214 bitop3:0xf6
  v_bitop3_b32 v232, v232, s3, v215 bitop3:0xf6
  v_bitop3_b32 v232, v232, s3, v216 bitop3:0xf6
  v_bitop3_b32 v232, v232, s3, v217 bitop3:0xf6
  v_bitop3_b32 v232, v232, s3, v218 bitop3:0xf6
  v_bitop3_b32 v232, v232, s3, v219 bitop3:0xf6
  v_bitop3_b32 v232, v232, s3, v220 bitop3:0xf6
  v_bitop3_b32 v232, v232, s3, v221 bitop3:0xf6
  v_bitop3_b32 v232, v232, s3, v222 bitop3:0xf6
  v_bitop3_b32 v232, v232, s3, v223 bitop3:0xf6
  v_bitop3_b32 v232, v232, s3, v224 bitop3:0xf6
  v_bitop3_b32 v232, v232, s3, v225 bitop3:0xf6
  v_bitop3_b32 v232, v232, s3, v226 bitop3:0xf6
  v_bitop3_b32 v232, v232, s3, v227 bitop3:0xf6
  v_bitop3_b32 v232, v232, s3, v228 bitop3:0xf6
  v_bitop3_b32 v232, v232, s3, v229 bitop3:0xf6
  v_bitop3_b32 v232, v232, s3, v230 bitop3:0xf6
  v_bitop3_b32 v232, v232, s3, v231 bitop3:0xf6
  v_lshlrev_b32 v232, 22, v232
  v_cmp_eq_u32 vcc, 0, v232
  s_cmp_ge_u32 s22, 2
  s_cselect_b32 s58, 1.0, 0
  s_nop 1
  s_cmp_eq_u64 vcc, -1
  s_cbranch_scc0 M2SPIN
M2DONE:
  v_and_b32 v208, 0xfffffc00, v208
  v_and_b32 v209, 0xfffffc00, v209
  v_and_b32 v210, 0xfffffc00, v210
  v_and_b32 v211, 0xfffffc00, v211
  v_and_b32 v212, 0xfffffc00, v212
  v_and_b32 v213, 0xfffffc00, v213
  v_and_b32 v214, 0xfffffc00, v214
  v_and_b32 v215, 0xfffffc00, v215
  v_and_b32 v216, 0xfffffc00, v216
  v_and_b32 v217, 0xfffffc00, v217
  v_and_b32 v218, 0xfffffc00, v218
  v_and_b32 v219, 0xfffffc00, v219
  v_and_b32 v220, 0xfffffc00, v220
  v_and_b32 v221, 0xfffffc00, v221
  v_and_b32 v222, 0xfffffc00, v222
  v_and_b32 v223, 0xfffffc00, v223
  v_and_b32 v224, 0xfffffc00, v224
  v_and_b32 v225, 0xfffffc00, v225
  v_and_b32 v226, 0xfffffc00, v226
  v_and_b32 v227, 0xfffffc00, v227
  v_and_b32 v228, 0xfffffc00, v228
  v_and_b32 v229, 0xfffffc00, v229
  v_and_b32 v230, 0xfffffc00, v230
  v_and_b32 v231, 0xfffffc00, v231
  v_pk_add_f32 v[208:209], v[208:209], v[210:211]
  v_pk_add_f32 v[212:213], v[212:213], v[214:215]
  v_pk_add_f32 v[216:217], v[216:217], v[218:219]
  v_pk_add_f32 v[220:221], v[220:221], v[222:223]
  v_pk_add_f32 v[224:225], v[224:225], v[226:227]
  v_pk_add_f32 v[228:229], v[228:229], v[230:231]
  v_add_f32 v208, v208, v209
  v_add_f32 v212, v212, v213
  v_add_f32 v216, v216, v217
  v_add_f32 v220, v220, v221
  v_add_f32 v224, v224, v225
  v_add_f32 v228, v228, v229
  v_cvt_pk_bf16_f32 v208, 0, v208
  v_cvt_pk_bf16_f32 v212, 0, v212
  v_cvt_pk_bf16_f32 v216, 0, v216
  v_cvt_pk_bf16_f32 v220, 0, v220
  v_cvt_pk_bf16_f32 v224, 0, v224
  v_cvt_pk_bf16_f32 v228, 0, v228
  v_add_f32 v208, s58, v208
  v_add_f32 v212, s58, v212
  v_add_f32 v216, s58, v216
  v_add_f32 v220, s58, v220
  v_add_f32 v224, s58, v224
  v_add_f32 v228, v251, v228
  v_cvt_pk_bf16_f32 v208, v208, 0
  v_cvt_pk_bf16_f32 v212, v212, 0
  v_cvt_pk_bf16_f32 v216, v216, 0
  v_cvt_pk_bf16_f32 v220, v220, 0
  v_cvt_pk_bf16_f32 v224, v224, 0
  v_cvt_pk_bf16_f32 v228, 0, v228
  ds_write_b16 v250, v208 offset:0
  ds_write_b16 v250, v212 offset:128
  ds_write_b16 v250, v216 offset:256
  ds_write_b16 v250, v220 offset:384
  ds_write_b16 v250, v224 offset:512
  ds_write_b32 v249, v228
  ds_read_b64 v[10:11], v39 offset:0
  ds_read_b64 v[12:13], v39 offset:32
  ds_read_b64 v[14:15], v39 offset:64
  ds_read_b64 v[16:17], v39 offset:96
  ds_read_b64 v[18:19], v39 offset:128
  s_add_u32 s72, s24, 1
  v_mov_b32 v3, s72
  s_waitcnt vmcnt(0)
  s_cmp_eq_u32 s23, 0
  s_cbranch_scc1 SLOW2
  buffer_store_dword v3, off, s[4:7], s26
RET2:
  s_waitcnt lgkmcnt(0)
  s_branch SPIN3
PDONE3:
  s_waitcnt lgkmcnt(0)
  buffer_load_dwordx4 v[92:95], v4, s[4:7], s32 offen offset:0 sc1
  buffer_load_dwordx4 v[96:99], v4, s[4:7], s32 offen offset:1024 sc1
  buffer_load_dwordx4 v[100:103], v4, s[4:7], s32 offen offset:2048 sc1
  buffer_load_dwordx4 v[104:107], v4, s[4:7], s32 offen offset:3072 sc1
  buffer_load_dwordx4 v[108:111], v5, s[4:7], s32 offen offset:0 sc1
  buffer_load_dwordx4 v[112:115], v4, s[4:7], s33 offen offset:0 sc1
  buffer_load_dwordx4 v[116:119], v4, s[4:7], s33 offen offset:1024 sc1
  buffer_load_dwordx4 v[120:123], v4, s[4:7], s33 offen offset:2048 sc1
  buffer_load_dwordx4 v[124:127], v4, s[4:7], s33 offen offset:3072 sc1
  buffer_load_dwordx4 v[128:131], v5, s[4:7], s33 offen offset:0 sc1
  buffer_load_dwordx4 v[132:135], v4, s[4:7], s34 offen offset:0 sc1
  buffer_load_dwordx4 v[136:139], v4, s[4:7], s34 offen offset:1024 sc1
  buffer_load_dwordx4 v[140:143], v4, s[4:7], s34 offen offset:2048 sc1
  buffer_load_dwordx4 v[144:147], v4, s[4:7], s34 offen offset:3072 sc1
  buffer_load_dwordx4 v[148:151], v5, s[4:7], s34 offen offset:0 sc1
  buffer_load_dwordx4 v[152:155], v4, s[4:7], s35 offen offset:0 sc1
  buffer_load_dwordx4 v[156:159], v4, s[4:7], s35 offen offset:1024 sc1
  buffer_load_dwordx4 v[160:163], v4, s[4:7], s35 offen offset:2048 sc1
  buffer_load_dwordx4 v[164:167], v4, s[4:7], s35 offen offset:3072 sc1
  buffer_load_dwordx4 v[168:171], v5, s[4:7], s35 offen offset:0 sc1
  s_waitcnt vmcnt(19)
  v_mfma_f32_16x16x32_bf16 v[40:43], a[156:159], v[92:95], 0
  v_mfma_f32_16x16x32_bf16 v[44:47], a[160:163], v[92:95], 0
  v_mfma_f32_16x16x32_bf16 v[48:51], a[164:167], v[92:95], 0
  v_mfma_f32_16x16x32_bf16 v[52:55], a[168:171], v[92:95], 0
  v_mfma_f32_16x16x32_bf16 v[56:59], a[172:175], v[92:95], 0
  s_waitcnt vmcnt(18)
  v_mfma_f32_16x16x32_bf16 v[40:43], a[176:179], v[96:99], v[40:43]
  v_mfma_f32_16x16x32_bf16 v[44:47], a[180:183], v[96:99], v[44:47]
  v_mfma_f32_16x16x32_bf16 v[48:51], a[184:187], v[96:99], v[48:51]
  v_mfma_f32_16x16x32_bf16 v[52:55], a[188:191], v[96:99], v[52:55]
  v_mfma_f32_16x16x32_bf16 v[56:59], a[192:195], v[96:99], v[56:59]
  s_waitcnt vmcnt(17)
  v_mfma_f32_16x16x32_bf16 v[40:43], a[196:199], v[100:103], v[40:43]
  v_mfma_f32_16x16x32_bf16 v[44:47], a[200:203], v[100:103], v[44:47]
  v_mfma_f32_16x16x32_bf16 v[48:51], a[204:207], v[100:103], v[48:51]
  v_mfma_f32_16x16x32_bf16 v[52:55], a[208:211], v[100:103], v[52:55]
  v_mfma_f32_16x16x32_bf16 v[56:59], a[212:215], v[100:103], v[56:59]
  s_waitcnt vmcnt(16)
  v_mfma_f32_16x16x32_bf16 v[40:43], a[216:219], v[104:107], v[40:43]
  v_mfma_f32_16x16x32_bf16 v[44:47], a[220:223], v[104:107], v[44:47]
  v_mfma_f32_16x16x32_bf16 v[48:51], a[224:227], v[104:107], v[48:51]
  v_mfma_f32_16x16x32_bf16 v[52:55], a[228:231], v[104:107], v[52:55]
  v_mfma_f32_16x16x32_bf16 v[56:59], a[232:235], v[104:107], v[56:59]
  s_waitcnt vmcnt(15)
  v_mfma_f32_16x16x32_bf16 v[40:43], a[236:239], v[108:111], v[40:43]
  v_mfma_f32_16x16x32_bf16 v[44:47], a[240:243], v[108:111], v[44:47]
  v_mfma_f32_16x16x32_bf16 v[48:51], a[244:247], v[108:111], v[48:51]
  v_mfma_f32_16x16x32_bf16 v[52:55], a[248:251], v[108:111], v[52:55]
  v_mfma_f32_16x16x32_bf16 v[56:59], a[252:255], v[108:111], v[56:59]
  s_waitcnt vmcnt(14)
  v_mfma_f32_16x16x32_bf16 v[60:63], a[156:159], v[112:115], 0
  v_mfma_f32_16x16x32_bf16 v[64:67], a[160:163], v[112:115], 0
  v_mfma_f32_16x16x32_bf16 v[68:71], a[164:167], v[112:115], 0
  v_mfma_f32_16x16x32_bf16 v[72:75], a[168:171], v[112:115], 0
  v_mfma_f32_16x16x32_bf16 v[76:79], a[172:175], v[112:115], 0
  ds_write_b128 v20, v[40:43] offset:0
  s_waitcnt vmcnt(13)
  v_mfma_f32_16x16x32_bf16 v[60:63], a[176:179], v[116:119], v[60:63]
  ds_write_b128 v20, v[44:47] offset:1024
  v_mfma_f32_16x16x32_bf16 v[64:67], a[180:183], v[116:119], v[64:67]
  ds_write_b128 v20, v[48:51] offset:2048
  v_mfma_f32_16x16x32_bf16 v[68:71], a[184:187], v[116:119], v[68:71]
  v_mfma_f32_16x16x32_bf16 v[72:75], a[188:191], v[116:119], v[72:75]
  ds_write_b128 v20, v[52:55] offset:3072
  v_mfma_f32_16x16x32_bf16 v[76:79], a[192:195], v[116:119], v[76:79]
  ds_write_b128 v20, v[56:59] offset:4096
  s_waitcnt vmcnt(12)
  v_mfma_f32_16x16x32_bf16 v[60:63], a[196:199], v[120:123], v[60:63]
  buffer_load_dwordx4 a[112:115], v6, s[4:7], s42 offen offset:1024 sc1
  v_mfma_f32_16x16x32_bf16 v[64:67], a[200:203], v[120:123], v[64:67]
  v_mfma_f32_16x16x32_bf16 v[68:71], a[204:207], v[120:123], v[68:71]
  buffer_load_dwordx4 a[116:119], v6, s[4:7], s43 offen offset:1024 sc1
  v_mfma_f32_16x16x32_bf16 v[72:75], a[208:211], v[120:123], v[72:75]
  buffer_load_dwordx4 a[120:123], v6, s[4:7], s41 offen offset:2048 sc1
  v_mfma_f32_16x16x32_bf16 v[76:79], a[212:215], v[120:123], v[76:79]
  s_waitcnt vmcnt(14)
  v_mfma_f32_16x16x32_bf16 v[60:63], a[216:219], v[124:127], v[60:63]
  buffer_load_dwordx4 a[124:127], v6, s[4:7], s42 offen offset:2048 sc1
  v_mfma_f32_16x16x32_bf16 v[64:67], a[220:223], v[124:127], v[64:67]
  buffer_load_dwordx4 a[128:131], v6, s[4:7], s43 offen offset:2048 sc1
  v_mfma_f32_16x16x32_bf16 v[68:71], a[224:227], v[124:127], v[68:71]
  buffer_load_dwordx4 a[132:135], v6, s[4:7], s41 offen offset:3072 sc1
  v_mfma_f32_16x16x32_bf16 v[72:75], a[228:231], v[124:127], v[72:75]
  v_mfma_f32_16x16x32_bf16 v[76:79], a[232:235], v[124:127], v[76:79]
  buffer_load_dwordx4 a[136:139], v6, s[4:7], s42 offen offset:3072 sc1
  s_waitcnt vmcnt(17)
  v_mfma_f32_16x16x32_bf16 v[60:63], a[236:239], v[128:131], v[60:63]
  buffer_load_dwordx4 a[140:143], v6, s[4:7], s43 offen offset:3072 sc1
  v_mfma_f32_16x16x32_bf16 v[64:67], a[240:243], v[128:131], v[64:67]
  v_mfma_f32_16x16x32_bf16 v[68:71], a[244:247], v[128:131], v[68:71]
  v_mfma_f32_16x16x32_bf16 v[72:75], a[248:251], v[128:131], v[72:75]
  v_mfma_f32_16x16x32_bf16 v[76:79], a[252:255], v[128:131], v[76:79]
  s_waitcnt vmcnt(17)
  v_mfma_f32_16x16x32_bf16 v[40:43], a[156:159], v[132:135], 0
  v_mfma_f32_16x16x32_bf16 v[44:47], a[160:163], v[132:135], 0
  v_mfma_f32_16x16x32_bf16 v[48:51], a[164:167], v[132:135], 0
  v_mfma_f32_16x16x32_bf16 v[52:55], a[168:171], v[132:135], 0
  v_mfma_f32_16x16x32_bf16 v[56:59], a[172:175], v[132:135], 0
  ds_write_b128 v21, v[60:63] offset:0
  s_waitcnt vmcnt(16)
  v_mfma_f32_16x16x32_bf16 v[40:43], a[176:179], v[136:139], v[40:43]
  ds_write_b128 v21, v[64:67] offset:1024
  v_mfma_f32_16x16x32_bf16 v[44:47], a[180:183], v[136:139], v[44:47]
  ds_write_b128 v21, v[68:71] offset:2048
  v_mfma_f32_16x16x32_bf16 v[48:51], a[184:187], v[136:139], v[48:51]
  v_mfma_f32_16x16x32_bf16 v[52:55], a[188:191], v[136:139], v[52:55]
  ds_write_b128 v21, v[72:75] offset:3072
  v_mfma_f32_16x16x32_bf16 v[56:59], a[192:195], v[136:139], v[56:59]
  ds_write_b128 v21, v[76:79] offset:4096
  s_waitcnt vmcnt(15)
  v_mfma_f32_16x16x32_bf16 v[40:43], a[196:199], v[140:143], v[40:43]
  buffer_load_dwordx4 a[144:147], v7, s[4:7], s41 offen offset:0 sc1
  v_mfma_f32_16x16x32_bf16 v[44:47], a[200:203], v[140:143], v[44:47]
  v_mfma_f32_16x16x32_bf16 v[48:51], a[204:207], v[140:143], v[48:51]
  buffer_load_dwordx4 a[148:151], v7, s[4:7], s42 offen offset:0 sc1
  v_mfma_f32_16x16x32_bf16 v[52:55], a[208:211], v[140:143], v[52:55]
  buffer_load_dwordx4 a[152:155], v7, s[4:7], s43 offen offset:0 sc1
  v_mfma_f32_16x16x32_bf16 v[56:59], a[212:215], v[140:143], v[56:59]
  s_waitcnt vmcnt(17)
  v_mfma_f32_16x16x32_bf16 v[40:43], a[216:219], v[144:147], v[40:43]
  buffer_load_dwordx4 v[172:175], v7, s[4:7], s41 offen offset:1024 sc1
  v_mfma_f32_16x16x32_bf16 v[44:47], a[220:223], v[144:147], v[44:47]
  buffer_load_dwordx4 v[176:179], v7, s[4:7], s42 offen offset:1024 sc1
  v_mfma_f32_16x16x32_bf16 v[48:51], a[224:227], v[144:147], v[48:51]
  buffer_load_dwordx4 v[180:183], v7, s[4:7], s43 offen offset:1024 sc1
  v_mfma_f32_16x16x32_bf16 v[52:55], a[228:231], v[144:147], v[52:55]
  v_mfma_f32_16x16x32_bf16 v[56:59], a[232:235], v[144:147], v[56:59]
  buffer_load_dwordx4 v[184:187], v7, s[4:7], s41 offen offset:2048 sc1
  s_waitcnt vmcnt(20)
  v_mfma_f32_16x16x32_bf16 v[40:43], a[236:239], v[148:151], v[40:43]
  buffer_load_dwordx4 v[188:191], v7, s[4:7], s42 offen offset:2048 sc1
  v_mfma_f32_16x16x32_bf16 v[44:47], a[240:243], v[148:151], v[44:47]
  v_mfma_f32_16x16x32_bf16 v[48:51], a[244:247], v[148:151], v[48:51]
  v_mfma_f32_16x16x32_bf16 v[52:55], a[248:251], v[148:151], v[52:55]
  v_mfma_f32_16x16x32_bf16 v[56:59], a[252:255], v[148:151], v[56:59]
  s_waitcnt vmcnt(20)
  v_mfma_f32_16x16x32_bf16 v[60:63], a[156:159], v[152:155], 0
  v_mfma_f32_16x16x32_bf16 v[64:67], a[160:163], v[152:155], 0
  v_mfma_f32_16x16x32_bf16 v[68:71], a[164:167], v[152:155], 0
  v_mfma_f32_16x16x32_bf16 v[72:75], a[168:171], v[152:155], 0
  v_mfma_f32_16x16x32_bf16 v[76:79], a[172:175], v[152:155], 0
  ds_write_b128 v22, v[40:43] offset:0
  s_waitcnt vmcnt(19)
  v_mfma_f32_16x16x32_bf16 v[60:63], a[176:179], v[156:159], v[60:63]
  ds_write_b128 v22, v[44:47] offset:1024
  v_mfma_f32_16x16x32_bf16 v[64:67], a[180:183], v[156:159], v[64:67]
  ds_write_b128 v22, v[48:51] offset:2048
  v_mfma_f32_16x16x32_bf16 v[68:71], a[184:187], v[156:159], v[68:71]
  v_mfma_f32_16x16x32_bf16 v[72:75], a[188:191], v[156:159], v[72:75]
  ds_write_b128 v22, v[52:55] offset:3072
  v_mfma_f32_16x16x32_bf16 v[76:79], a[192:195], v[156:159], v[76:79]
  ds_write_b128 v22, v[56:59] offset:4096
  s_waitcnt vmcnt(18)
  v_mfma_f32_16x16x32_bf16 v[60:63], a[196:199], v[160:163], v[60:63]
  buffer_load_dwordx4 v[192:195], v7, s[4:7], s43 offen offset:2048 sc1
  v_mfma_f32_16x16x32_bf16 v[64:67], a[200:203], v[160:163], v[64:67]
  v_mfma_f32_16x16x32_bf16 v[68:71], a[204:207], v[160:163], v[68:71]
  buffer_load_dwordx4 v[196:199], v7, s[4:7], s41 offen offset:3072 sc1
  v_mfma_f32_16x16x32_bf16 v[72:75], a[208:211], v[160:163], v[72:75]
  buffer_load_dwordx4 v[200:203], v7, s[4:7], s42 offen offset:3072 sc1
  v_mfma_f32_16x16x32_bf16 v[76:79], a[212:215], v[160:163], v[76:79]
  s_waitcnt vmcnt(20)
  v_mfma_f32_16x16x32_bf16 v[60:63], a[216:219], v[164:167], v[60:63]
  buffer_load_dwordx4 v[204:207], v7, s[4:7], s43 offen offset:3072 sc1
  v_mfma_f32_16x16x32_bf16 v[64:67], a[220:223], v[164:167], v[64:67]
  buffer_load_dwordx4 v[208:211], v8, s[4:7], s41 offen offset:0 sc1
  v_mfma_f32_16x16x32_bf16 v[68:71], a[224:227], v[164:167], v[68:71]
  buffer_load_dwordx4 v[212:215], v8, s[4:7], s42 offen offset:0 sc1
  v_mfma_f32_16x16x32_bf16 v[72:75], a[228:231], v[164:167], v[72:75]
  v_mfma_f32_16x16x32_bf16 v[76:79], a[232:235], v[164:167], v[76:79]
  buffer_load_dwordx4 v[216:219], v8, s[4:7], s43 offen offset:0 sc1
  s_waitcnt vmcnt(23)
  v_mfma_f32_16x16x32_bf16 v[60:63], a[236:239], v[168:171], v[60:63]
  buffer_load_dwordx4 v[220:223], v8, s[4:7], s41 offen offset:1024 sc1
  v_mfma_f32_16x16x32_bf16 v[64:67], a[240:243], v[168:171], v[64:67]
  v_mfma_f32_16x16x32_bf16 v[68:71], a[244:247], v[168:171], v[68:71]
  v_mfma_f32_16x16x32_bf16 v[72:75], a[248:251], v[168:171], v[72:75]
  v_mfma_f32_16x16x32_bf16 v[76:79], a[252:255], v[168:171], v[76:79]
  s_add_u32 s31, s28, 3145728
  s_mul_i32 s57, s22, 20480
  s_add_u32 s57, s57, s31
  s_lshr_b32 s3, s21, 1
  s_mul_i32 s3, s3, 5120
  s_add_u32 s57, s57, s3
  s_and_b32 s3, s21, 1
  s_lshl3_add_u32 s58, s3, s57
  s_add_u32 s58, s58, 4096
  s_lshl_b32 s3, s3, 11
  s_add_u32 s57, s57, s3
  v_lshlrev_b32 v38, 6, v38
  s_lshl3_add_u32 s59, s21, s31
  s_add_u32 s59, s59, 81920
  s_waitcnt lgkmcnt(0)
  s_barrier
  ds_read_b128 v[92:95], v23 offset:0
  ds_read_b128 v[96:99], v23 offset:1024
  ds_read_b128 v[100:103], v23 offset:2048
  ds_read_b128 v[104:107], v23 offset:3072
  ds_read_b128 v[108:111], v23 offset:4096
  ds_read_b128 v[112:115], v23 offset:5120
  ds_read_b128 v[116:119], v23 offset:6144
  ds_read_b128 v[120:123], v23 offset:7168
  ds_read_b128 v[124:127], v23 offset:8192
  ds_read_b128 v[128:131], v23 offset:9216
  ds_read_b128 v[132:135], v23 offset:10240
  ds_read_b128 v[136:139], v23 offset:11264
  ds_read_b128 v[140:143], v23 offset:12288
  ds_read_b128 v[144:147], v23 offset:13312
  ds_read_b128 v[148:151], v23 offset:14336
  ds_read_b128 v[152:155], v24 offset:0
  ds_read_b128 v[156:159], v24 offset:64
  ds_read_b128 v[160:163], v24 offset:128
  ds_read_b128 v[164:167], v24 offset:192
  ds_read_b128 v[168:171], v24 offset:256
  ds_read_b128 v[40:43], v24 offset:320
  ds_read_b128 v[44:47], v24 offset:384
  ds_read_b128 v[48:51], v24 offset:448
  ds_read_b128 v[52:55], v24 offset:512
  ds_read_b128 v[56:59], v24 offset:576
  s_waitcnt lgkmcnt(15)
  v_pk_add_f32 v[60:61], v[60:61], v[92:93]
  buffer_load_dwordx4 v[224:227], v8, s[4:7], s42 offen offset:1024 sc1
  v_pk_add_f32 v[62:63], v[62:63], v[94:95]
  v_pk_add_f32 v[64:65], v[64:65], v[96:97]
  v_pk_add_f32 v[66:67], v[66:67], v[98:99]
  v_pk_add_f32 v[68:69], v[68:69], v[100:101]
  v_pk_add_f32 v[70:71], v[70:71], v[102:103]
  v_pk_add_f32 v[72:73], v[72:73], v[104:105]
  v_pk_add_f32 v[74:75], v[74:75], v[106:107]
  buffer_load_dwordx4 v[228:231], v8, s[4:7], s43 offen offset:1024 sc1
  v_pk_add_f32 v[76:77], v[76:77], v[108:109]
  v_pk_add_f32 v[78:79], v[78:79], v[110:111]
  v_lshlrev_b32 v92, 16, v10
  v_and_b32 v93, 0xffff0000, v10
  v_lshlrev_b32 v94, 16, v11
  v_and_b32 v95, 0xffff0000, v11
  v_lshlrev_b32 v96, 16, v12
  v_and_b32 v97, 0xffff0000, v12
  buffer_load_dwordx4 v[232:235], v8, s[4:7], s41 offen offset:2048 sc1
  v_lshlrev_b32 v98, 16, v13
  v_and_b32 v99, 0xffff0000, v13
  v_lshlrev_b32 v100, 16, v14
  v_and_b32 v101, 0xffff0000, v14
  v_lshlrev_b32 v102, 16, v15
  v_and_b32 v103, 0xffff0000, v15
  v_lshlrev_b32 v104, 16, v16
  buffer_load_dwordx4 v[236:239], v8, s[4:7], s42 offen offset:2048 sc1
  v_and_b32 v105, 0xffff0000, v16
  v_lshlrev_b32 v106, 16, v17
  v_and_b32 v107, 0xffff0000, v17
  v_lshlrev_b32 v108, 16, v18
  v_and_b32 v109, 0xffff0000, v18
  v_lshlrev_b32 v110, 16, v19
  v_and_b32 v111, 0xffff0000, v19
  v_pk_add_f32 v[60:61], v[60:61], v[112:113]
  buffer_load_dwordx4 v[240:243], v8, s[4:7], s43 offen offset:2048 sc1
  v_pk_add_f32 v[62:63], v[62:63], v[114:115]
  v_pk_add_f32 v[64:65], v[64:65], v[116:117]
  v_pk_add_f32 v[66:67], v[66:67], v[118:119]
  v_pk_add_f32 v[68:69], v[68:69], v[120:121]
  v_pk_add_f32 v[70:71], v[70:71], v[122:123]
  v_pk_add_f32 v[72:73], v[72:73], v[124:125]
  v_pk_add_f32 v[74:75], v[74:75], v[126:127]
  buffer_load_dwordx4 v[244:247], v8, s[4:7], s41 offen offset:3072 sc1
  v_pk_add_f32 v[76:77], v[76:77], v[128:129]
  v_pk_add_f32 v[78:79], v[78:79], v[130:131]
  s_waitcnt lgkmcnt(14)
  v_pk_add_f32 v[60:61], v[60:61], v[132:133]
  v_pk_add_f32 v[62:63], v[62:63], v[134:135]
  s_waitcnt lgkmcnt(13)
  v_pk_add_f32 v[64:65], v[64:65], v[136:137]
  v_pk_add_f32 v[66:67], v[66:67], v[138:139]
  s_waitcnt lgkmcnt(12)
  v_pk_add_f32 v[68:69], v[68:69], v[140:141]
  v_pk_add_f32 v[70:71], v[70:71], v[142:143]
  buffer_load_dwordx4 v[248:251], v8, s[4:7], s42 offen offset:3072 sc1
  s_waitcnt lgkmcnt(11)
  v_pk_add_f32 v[72:73], v[72:73], v[144:145]
  v_pk_add_f32 v[74:75], v[74:75], v[146:147]
  s_waitcnt lgkmcnt(10)
  v_pk_add_f32 v[76:77], v[76:77], v[148:149]
  v_pk_add_f32 v[78:79], v[78:79], v[150:151]
  s_waitcnt lgkmcnt(9)
  v_pk_fma_f32 v[92:93], v[60:61], v[152:153], v[92:93]
  v_pk_fma_f32 v[94:95], v[62:63], v[154:155], v[94:95]
  s_waitcnt lgkmcnt(8)
  v_pk_fma_f32 v[96:97], v[64:65], v[156:157], v[96:97]
  buffer_load_dwordx4 v[252:255], v8, s[4:7], s43 offen offset:3072 sc1
  v_pk_fma_f32 v[98:99], v[66:67], v[158:159], v[98:99]
  s_waitcnt lgkmcnt(7)
  v_pk_fma_f32 v[100:101], v[68:69], v[160:161], v[100:101]
  v_pk_fma_f32 v[102:103], v[70:71], v[162:163], v[102:103]
  s_waitcnt lgkmcnt(6)
  v_pk_fma_f32 v[104:105], v[72:73], v[164:165], v[104:105]
  v_pk_fma_f32 v[106:107], v[74:75], v[166:167], v[106:107]
  s_waitcnt lgkmcnt(5)
  v_pk_fma_f32 v[108:109], v[76:77], v[168:169], v[108:109]
  v_pk_fma_f32 v[110:111], v[78:79], v[170:171], v[110:111]
  v_cvt_pk_bf16_f32 v10, v92, v93
  v_cvt_pk_bf16_f32 v11, v94, v95
  v_cvt_pk_bf16_f32 v12, v96, v97
  v_cvt_pk_bf16_f32 v13, v98, v99
  v_cvt_pk_bf16_f32 v14, v100, v101
  v_cvt_pk_bf16_f32 v15, v102, v103
  v_cvt_pk_bf16_f32 v16, v104, v105
  v_cvt_pk_bf16_f32 v17, v106, v107
  v_cvt_pk_bf16_f32 v18, v108, v109
  v_cvt_pk_bf16_f32 v19, v110, v111
  v_lshlrev_b32 v92, 16, v10
  v_and_b32 v93, 0xffff0000, v10
  v_lshlrev_b32 v94, 16, v11
  v_and_b32 v95, 0xffff0000, v11
  v_lshlrev_b32 v96, 16, v12
  v_and_b32 v97, 0xffff0000, v12
  v_lshlrev_b32 v98, 16, v13
  v_and_b32 v99, 0xffff0000, v13
  v_lshlrev_b32 v100, 16, v14
  v_and_b32 v101, 0xffff0000, v14
  v_lshlrev_b32 v102, 16, v15
  v_and_b32 v103, 0xffff0000, v15
  v_lshlrev_b32 v104, 16, v16
  v_and_b32 v105, 0xffff0000, v16
  v_lshlrev_b32 v106, 16, v17
  v_and_b32 v107, 0xffff0000, v17
  v_lshlrev_b32 v108, 16, v18
  v_and_b32 v109, 0xffff0000, v18
  v_lshlrev_b32 v110, 16, v19
  v_and_b32 v111, 0xffff0000, v19
  s_waitcnt lgkmcnt(4)
  v_pk_mul_f32 v[60:61], v[92:93], v[40:41]
  v_pk_mul_f32 v[62:63], v[94:95], v[42:43]
  s_waitcnt lgkmcnt(3)
  v_pk_mul_f32 v[64:65], v[96:97], v[44:45]
  v_pk_mul_f32 v[66:67], v[98:99], v[46:47]
  s_waitcnt lgkmcnt(2)
  v_pk_mul_f32 v[68:69], v[100:101], v[48:49]
  v_pk_mul_f32 v[70:71], v[102:103], v[50:51]
  s_waitcnt lgkmcnt(1)
  v_pk_mul_f32 v[72:73], v[104:105], v[52:53]
  v_pk_mul_f32 v[74:75], v[106:107], v[54:55]
  s_waitcnt lgkmcnt(0)
  v_pk_mul_f32 v[76:77], v[108:109], v[56:57]
  v_pk_mul_f32 v[78:79], v[110:111], v[58:59]
  v_cvt_pk_bf16_f32 v80, v60, v61
  v_cvt_pk_bf16_f32 v81, v62, v63
  v_cvt_pk_bf16_f32 v82, v64, v65
  v_cvt_pk_bf16_f32 v83, v66, v67
  v_cvt_pk_bf16_f32 v84, v68, v69
  v_cvt_pk_bf16_f32 v85, v70, v71
  v_cvt_pk_bf16_f32 v86, v72, v73
  v_cvt_pk_bf16_f32 v87, v74, v75
  v_cvt_pk_bf16_f32 v88, v76, v77
  v_cvt_pk_bf16_f32 v89, v78, v79
  s_cmp_eq_u32 s23, 0
  s_cbranch_scc1 SLOW4
  buffer_store_dwordx4 v[80:83], v4, s[4:7], s57 offen
  buffer_store_dwordx4 v[84:87], v4, s[4:7], s57 offen offset:1024
  buffer_store_dwordx2 v[88:89], v4, s[4:7], s58 offen
RET4:
  v_pk_add_f32 v[24:25], v[92:93], v[94:95]
  v_pk_mul_f32 v[26:27], v[92:93], v[92:93]
  v_pk_fma_f32 v[26:27], v[94:95], v[94:95], v[26:27]
  v_pk_add_f32 v[24:25], v[24:25], v[96:97]
  v_pk_fma_f32 v[26:27], v[96:97], v[96:97], v[26:27]
  v_pk_add_f32 v[24:25], v[24:25], v[98:99]
  v_pk_fma_f32 v[26:27], v[98:99], v[98:99], v[26:27]
  v_pk_add_f32 v[24:25], v[24:25], v[100:101]
  v_pk_fma_f32 v[26:27], v[100:101], v[100:101], v[26:27]
  v_pk_add_f32 v[24:25], v[24:25], v[102:103]
  v_pk_fma_f32 v[26:27], v[102:103], v[102:103], v[26:27]
  v_pk_add_f32 v[24:25], v[24:25], v[104:105]
  v_pk_fma_f32 v[26:27], v[104:105], v[104:105], v[26:27]
  v_pk_add_f32 v[24:25], v[24:25], v[106:107]
  v_pk_fma_f32 v[26:27], v[106:107], v[106:107], v[26:27]
  v_pk_add_f32 v[24:25], v[24:25], v[108:109]
  v_pk_fma_f32 v[26:27], v[108:109], v[108:109], v[26:27]
  v_pk_add_f32 v[24:25], v[24:25], v[110:111]
  v_pk_fma_f32 v[26:27], v[110:111], v[110:111], v[26:27]
  v_add_f32 v24, v24, v25
  v_add_f32 v25, v26, v27
  v_mov_b32 v26, v24
  v_mov_b32 v27, v25
  s_nop 0
  v_permlane16_swap_b32 v24, v26
  v_permlane16_swap_b32 v25, v27
  v_add_f32 v24, v24, v26
  v_add_f32 v25, v25, v27
  v_mov_b32 v26, v24
  v_mov_b32 v27, v25
  s_nop 0
  v_permlane32_swap_b32 v24, v26
  v_permlane32_swap_b32 v25, v27
  v_add_f32 v24, v24, v26
  v_add_f32 v25, v25, v27
  s_cmp_eq_u32 s23, 0
  s_cbranch_scc1 SLOW5
  s_mov_b64 exec, 0xffff
  buffer_store_dwordx2 v[24:25], v38, s[4:7], s59 offen
  s_mov_b64 exec, -1
RET5:
  v_and_b32 v3, 1, v1
  v_lshlrev_b32 v3, 6, v3
  v_lshl_add_u32 v20, v2, 4, v3
  v_add_u32 v20, 159744, v20
  v_add_u32 v21, 65536, v4
  v_add_u32 v22, 106496, v4
  s_mul_i32 s55, s22, 5120
  s_add_u32 s29, s31, s55
  s_add_u32 s55, s55, 65536
  ds_read_b128 v[40:43], v20 offset:0
  ds_read_b128 v[44:47], v20 offset:128
  ds_read_b128 v[48:51], v20 offset:256
  ds_read_b128 v[52:55], v20 offset:384
  ds_read_b128 v[56:59], v20 offset:512
  ds_read_b128 v[60:63], v20 offset:640
  s_waitcnt lgkmcnt(5)
  v_mfma_f32_16x16x32_bf16 v[76:79], a[0:3], v[40:43], 0
  v_mfma_f32_16x16x32_bf16 v[80:83], a[4:7], v[40:43], 0
  v_mfma_f32_16x16x32_bf16 v[84:87], a[8:11], v[40:43], 0
  ds_read_b128 v[40:43], v20 offset:768
  s_waitcnt lgkmcnt(5)
  v_mfma_f32_16x16x32_bf16 v[76:79], a[12:15], v[44:47], v[76:79]
  v_mfma_f32_16x16x32_bf16 v[80:83], a[16:19], v[44:47], v[80:83]
  v_mfma_f32_16x16x32_bf16 v[84:87], a[20:23], v[44:47], v[84:87]
  ds_read_b128 v[44:47], v20 offset:896
  s_waitcnt lgkmcnt(5)
  v_mfma_f32_16x16x32_bf16 v[76:79], a[24:27], v[48:51], v[76:79]
  v_mfma_f32_16x16x32_bf16 v[80:83], a[28:31], v[48:51], v[80:83]
  v_mfma_f32_16x16x32_bf16 v[84:87], a[32:35], v[48:51], v[84:87]
  ds_read_b128 v[48:51], v20 offset:1024
  s_waitcnt lgkmcnt(5)
  v_mfma_f32_16x16x32_bf16 v[76:79], a[36:39], v[52:55], v[76:79]
  v_mfma_f32_16x16x32_bf16 v[80:83], a[40:43], v[52:55], v[80:83]
  v_mfma_f32_16x16x32_bf16 v[84:87], a[44:47], v[52:55], v[84:87]
  ds_read_b128 v[52:55], v20 offset:1152
  s_waitcnt lgkmcnt(5)
  v_mfma_f32_16x16x32_bf16 v[76:79], a[48:51], v[56:59], v[76:79]
  v_mfma_f32_16x16x32_bf16 v[80:83], a[52:55], v[56:59], v[80:83]
  v_mfma_f32_16x16x32_bf16 v[84:87], a[56:59], v[56:59], v[84:87]
  ds_read_b128 v[56:59], v20 offset:1280
  s_waitcnt lgkmcnt(5)
  v_mfma_f32_16x16x32_bf16 v[76:79], a[60:63], v[60:63], v[76:79]
  v_mfma_f32_16x16x32_bf16 v[80:83], a[64:67], v[60:63], v[80:83]
  v_mfma_f32_16x16x32_bf16 v[84:87], a[68:71], v[60:63], v[84:87]
  ds_read_b128 v[60:63], v20 offset:1408
  s_add_u32 s72, s24, 2
  v_mov_b32 v3, s72
  s_waitcnt vmcnt(0)
  s_cmp_eq_u32 s23, 0
  s_cbranch_scc1 SLOW6
  buffer_store_dword v3, off, s[4:7], s26
RET6:
  s_waitcnt lgkmcnt(5)
  v_mfma_f32_16x16x32_bf16 v[76:79], a[72:75], v[40:43], v[76:79]
  v_mfma_f32_16x16x32_bf16 v[80:83], a[76:79], v[40:43], v[80:83]
  buffer_load_dwordx4 a[156:159], v4, s[4:7], s44 offen offset:0 sc1
  v_mfma_f32_16x16x32_bf16 v[84:87], a[80:83], v[40:43], v[84:87]
  ds_read_b128 v[40:43], v20 offset:1536
  buffer_load_dwordx4 a[160:163], v4, s[4:7], s45 offen offset:0 sc1
  s_waitcnt lgkmcnt(5)
  v_mfma_f32_16x16x32_bf16 v[76:79], a[84:87], v[44:47], v[76:79]
  v_mfma_f32_16x16x32_bf16 v[80:83], a[88:91], v[44:47], v[80:83]
  v_mfma_f32_16x16x32_bf16 v[84:87], a[92:95], v[44:47], v[84:87]
  buffer_load_dwordx4 a[164:167], v4, s[4:7], s46 offen offset:0 sc1
  ds_read_b128 v[44:47], v20 offset:1664
  s_waitcnt lgkmcnt(5)
  v_mfma_f32_16x16x32_bf16 v[76:79], a[96:99], v[48:51], v[76:79]
  buffer_load_dwordx4 a[168:171], v4, s[4:7], s47 offen offset:0 sc1
  v_mfma_f32_16x16x32_bf16 v[80:83], a[100:103], v[48:51], v[80:83]
  v_mfma_f32_16x16x32_bf16 v[84:87], a[104:107], v[48:51], v[84:87]
  ds_read_b128 v[48:51], v20 offset:1792
  buffer_load_dwordx4 a[172:175], v4, s[4:7], s48 offen offset:0 sc1
  s_waitcnt lgkmcnt(5)
  v_mfma_f32_16x16x32_bf16 v[76:79], a[108:111], v[52:55], v[76:79]
  v_mfma_f32_16x16x32_bf16 v[80:83], a[112:115], v[52:55], v[80:83]
  buffer_load_dwordx4 a[176:179], v4, s[4:7], s44 offen offset:1024 sc1
  v_mfma_f32_16x16x32_bf16 v[84:87], a[116:119], v[52:55], v[84:87]
  ds_read_b128 v[52:55], v20 offset:1920
  s_waitcnt lgkmcnt(5)
  v_mfma_f32_16x16x32_bf16 v[76:79], a[120:123], v[56:59], v[76:79]
  v_mfma_f32_16x16x32_bf16 v[80:83], a[124:127], v[56:59], v[80:83]
  v_mfma_f32_16x16x32_bf16 v[84:87], a[128:131], v[56:59], v[84:87]
  ds_read_b128 v[56:59], v20 offset:2048
  s_waitcnt lgkmcnt(5)
  v_mfma_f32_16x16x32_bf16 v[76:79], a[132:135], v[60:63], v[76:79]
  v_mfma_f32_16x16x32_bf16 v[80:83], a[136:139], v[60:63], v[80:83]
  v_mfma_f32_16x16x32_bf16 v[84:87], a[140:143], v[60:63], v[84:87]
  ds_read_b128 v[60:63], v20 offset:2176
  s_waitcnt lgkmcnt(5)
  v_mfma_f32_16x16x32_bf16 v[76:79], a[144:147], v[40:43], v[76:79]
  v_mfma_f32_16x16x32_bf16 v[80:83], a[148:151], v[40:43], v[80:83]
  v_mfma_f32_16x16x32_bf16 v[84:87], a[152:155], v[40:43], v[84:87]
  ds_read_b128 v[40:43], v20 offset:2304
  s_waitcnt lgkmcnt(5)
  v_mfma_f32_16x16x32_bf16 v[76:79], v[172:175], v[44:47], v[76:79]
  v_mfma_f32_16x16x32_bf16 v[80:83], v[176:179], v[44:47], v[80:83]
  v_mfma_f32_16x16x32_bf16 v[84:87], v[180:183], v[44:47], v[84:87]
  ds_read_b128 v[44:47], v20 offset:2432
  s_waitcnt lgkmcnt(5)
  v_mfma_f32_16x16x32_bf16 v[76:79], v[184:187], v[48:51], v[76:79]
  v_mfma_f32_16x16x32_bf16 v[80:83], v[188:191], v[48:51], v[80:83]
  v_mfma_f32_16x16x32_bf16 v[84:87], v[192:195], v[48:51], v[84:87]
  s_waitcnt lgkmcnt(4)
  v_mfma_f32_16x16x32_bf16 v[76:79], v[196:199], v[52:55], v[76:79]
  v_mfma_f32_16x16x32_bf16 v[80:83], v[200:203], v[52:55], v[80:83]
  v_mfma_f32_16x16x32_bf16 v[84:87], v[204:207], v[52:55], v[84:87]
  s_waitcnt lgkmcnt(3)
  v_mfma_f32_16x16x32_bf16 v[76:79], v[208:211], v[56:59], v[76:79]
  v_mfma_f32_16x16x32_bf16 v[80:83], v[212:215], v[56:59], v[80:83]
  v_mfma_f32_16x16x32_bf16 v[84:87], v[216:219], v[56:59], v[84:87]
  s_waitcnt lgkmcnt(2)
  v_mfma_f32_16x16x32_bf16 v[76:79], v[220:223], v[60:63], v[76:79]
  v_mfma_f32_16x16x32_bf16 v[80:83], v[224:227], v[60:63], v[80:83]
  v_mfma_f32_16x16x32_bf16 v[84:87], v[228:231], v[60:63], v[84:87]
  s_waitcnt lgkmcnt(1)
  v_mfma_f32_16x16x32_bf16 v[76:79], v[232:235], v[40:43], v[76:79]
  v_mfma_f32_16x16x32_bf16 v[80:83], v[236:239], v[40:43], v[80:83]
  v_mfma_f32_16x16x32_bf16 v[84:87], v[240:243], v[40:43], v[84:87]
  s_waitcnt lgkmcnt(0)
  v_mfma_f32_16x16x32_bf16 v[76:79], v[244:247], v[44:47], v[76:79]
  v_mfma_f32_16x16x32_bf16 v[80:83], v[248:251], v[44:47], v[80:83]
  v_mfma_f32_16x16x32_bf16 v[84:87], v[252:255], v[44:47], v[84:87]
  s_branch SPIN7
PDONE7:
  s_waitcnt lgkmcnt(0)
  s_add_u32 s30, s29, 0
  s_add_u32 m0, s55, 0
  s_nop 0
  buffer_load_dwordx4 v4, s[4:7], s30 offen offset:0 sc1 lds
  buffer_load_dwordx4 v4, s[4:7], s30 offen offset:1024 sc1 lds
  buffer_load_dwordx4 v4, s[4:7], s30 offen offset:2048 sc1 lds
  buffer_load_dwordx4 v4, s[4:7], s30 offen offset:3072 sc1 lds
  s_add_u32 m0, s55, 4096
  s_nop 0
  buffer_load_dwordx4 v5, s[4:7], s30 offen sc1 lds
  s_add_u32 s30, s29, 20480
  s_add_u32 m0, s55, 20480
  s_nop 0
  buffer_load_dwordx4 v4, s[4:7], s30 offen offset:0 sc1 lds
  buffer_load_dwordx4 v4, s[4:7], s30 offen offset:1024 sc1 lds
  buffer_load_dwordx4 v4, s[4:7], s30 offen offset:2048 sc1 lds
  buffer_load_dwordx4 v4, s[4:7], s30 offen offset:3072 sc1 lds
  s_add_u32 m0, s55, 24576
  s_nop 0
  buffer_load_dwordx4 v5, s[4:7], s30 offen sc1 lds
  s_add_u32 s30, s29, 40960
  s_add_u32 m0, s55, 40960
  s_nop 0
  buffer_load_dwordx4 v4, s[4:7], s30 offen offset:0 sc1 lds
  buffer_load_dwordx4 v4, s[4:7], s30 offen offset:1024 sc1 lds
  buffer_load_dwordx4 v4, s[4:7], s30 offen offset:2048 sc1 lds
  buffer_load_dwordx4 v4, s[4:7], s30 offen offset:3072 sc1 lds
  s_add_u32 m0, s55, 45056
  s_nop 0
  buffer_load_dwordx4 v5, s[4:7], s30 offen sc1 lds
  s_add_u32 s30, s29, 61440
  s_add_u32 m0, s55, 61440
  s_nop 0
  buffer_load_dwordx4 v4, s[4:7], s30 offen offset:0 sc1 lds
  buffer_load_dwordx4 v4, s[4:7], s30 offen offset:1024 sc1 lds
  buffer_load_dwordx4 v4, s[4:7], s30 offen offset:2048 sc1 lds
  buffer_load_dwordx4 v4, s[4:7], s30 offen offset:3072 sc1 lds
  s_add_u32 m0, s55, 65536
  s_nop 0
  buffer_load_dwordx4 v5, s[4:7], s30 offen sc1 lds
  v_mov_b32_dpp v88, v76 quad_perm:[0,0,2,2] row_mask:0xf bank_mask:0xf
  v_mov_b32_dpp v100, v76 quad_perm:[1,1,3,3] row_mask:0xf bank_mask:0xf
  v_mov_b32_dpp v89, v77 quad_perm:[0,0,2,2] row_mask:0xf bank_mask:0xf
  v_mov_b32_dpp v101, v77 quad_perm:[1,1,3,3] row_mask:0xf bank_mask:0xf
  v_mov_b32_dpp v90, v78 quad_perm:[0,0,2,2] row_mask:0xf bank_mask:0xf
  v_mov_b32_dpp v102, v78 quad_perm:[1,1,3,3] row_mask:0xf bank_mask:0xf
  v_mov_b32_dpp v91, v79 quad_perm:[0,0,2,2] row_mask:0xf bank_mask:0xf
  v_mov_b32_dpp v103, v79 quad_perm:[1,1,3,3] row_mask:0xf bank_mask:0xf
  v_mov_b32_dpp v92, v80 quad_perm:[0,0,2,2] row_mask:0xf bank_mask:0xf
  v_mov_b32_dpp v104, v80 quad_perm:[1,1,3,3] row_mask:0xf bank_mask:0xf
  v_mov_b32_dpp v93, v81 quad_perm:[0,0,2,2] row_mask:0xf bank_mask:0xf
  v_mov_b32_dpp v105, v81 quad_perm:[1,1,3,3] row_mask:0xf bank_mask:0xf
  v_mov_b32_dpp v94, v82 quad_perm:[0,0,2,2] row_mask:0xf bank_mask:0xf
  v_mov_b32_dpp v106, v82 quad_perm:[1,1,3,3] row_mask:0xf bank_mask:0xf
  v_mov_b32_dpp v95, v83 quad_perm:[0,0,2,2] row_mask:0xf bank_mask:0xf
  v_mov_b32_dpp v107, v83 quad_perm:[1,1,3,3] row_mask:0xf bank_mask:0xf
  v_mov_b32_dpp v96, v84 quad_perm:[0,0,2,2] row_mask:0xf bank_mask:0xf
  v_mov_b32_dpp v108, v84 quad_perm:[1,1,3,3] row_mask:0xf bank_mask:0xf
  v_mov_b32_dpp v97, v85 quad_perm:[0,0,2,2] row_mask:0xf bank_mask:0xf
  v_mov_b32_dpp v109, v85 quad_perm:[1,1,3,3] row_mask:0xf bank_mask:0xf
  v_mov_b32_dpp v98, v86 quad_perm:[0,0,2,2] row_mask:0xf bank_mask:0xf
  v_mov_b32_dpp v110, v86 quad_perm:[1,1,3,3] row_mask:0xf bank_mask:0xf
  v_mov_b32_dpp v99, v87 quad_perm:[0,0,2,2] row_mask:0xf bank_mask:0xf
  v_mov_b32_dpp v111, v87 quad_perm:[1,1,3,3] row_mask:0xf bank_mask:0xf
  v_mul_f32 v100, 0xbfb8aa3b, v100
  v_mul_f32 v101, 0xbfb8aa3b, v101
  v_mul_f32 v102, 0xbfb8aa3b, v102
  v_mul_f32 v103, 0xbfb8aa3b, v103
  v_mul_f32 v104, 0xbfb8aa3b, v104
  v_mul_f32 v105, 0xbfb8aa3b, v105
  v_mul_f32 v106, 0xbfb8aa3b, v106
  v_mul_f32 v107, 0xbfb8aa3b, v107
  v_mul_f32 v108, 0xbfb8aa3b, v108
  v_mul_f32 v109, 0xbfb8aa3b, v109
  v_mul_f32 v110, 0xbfb8aa3b, v110
  v_mul_f32 v111, 0xbfb8aa3b, v111
  s_mul_i32 s53, s21, 6144
  s_add_u32 s52, s28, s53
  s_lshr_b32 s53, s22, 1
  s_lshl_b32 s53, s53, 10
  s_add_u32 s53, s53, s52
  s_add_u32 s53, s53, 4096
  s_and_b32 s3, s22, 1
  s_lshl3_add_u32 s53, s3, s53
  s_lshl_b32 s3, s22, 10
  s_add_u32 s52, s52, s3
  s_mov_b32 s54, 0xbfb8aa3b
  s_add_u32 s30, s31, 81920
  v_lshlrev_b32 v3, 6, v1
  v_lshl_add_u32 v3, v2, 4, v3
  s_waitcnt vmcnt(15)
  s_barrier
  buffer_load_dwordx4 v[24:27], v3, s[4:7], s30 offen offset:0 sc1
  buffer_load_dwordx4 v[28:31], v3, s[4:7], s30 offen offset:1024 sc1
  buffer_load_dwordx4 v[32:35], v3, s[4:7], s30 offen offset:2048 sc1
  buffer_load_dwordx4 v[36:39], v3, s[4:7], s30 offen offset:3072 sc1
  s_mul_i32 s57, s22, 5120
  s_mul_i32 s58, s22, 3072
  s_add_u32 s58, s58, 147456
  ds_read_b128 v[40:43], v21 offset:0
  ds_read_b128 v[44:47], v21 offset:1024
  ds_read_b128 v[48:51], v21 offset:2048
  ds_read_b128 v[52:55], v21 offset:3072
  ds_read_b128 v[56:59], v21 offset:4096
  s_waitcnt lgkmcnt(4)
  v_mfma_f32_16x16x32_bf16 v[64:67], a[0:3], v[40:43], 0
  ds_read_b128 v[60:63], v21 offset:5120
  v_mfma_f32_16x16x32_bf16 v[68:71], a[4:7], v[40:43], 0
  v_mfma_f32_16x16x32_bf16 v[72:75], a[8:11], v[40:43], 0
  buffer_load_dwordx4 a[180:183], v4, s[4:7], s45 offen offset:1024 sc1
  s_waitcnt lgkmcnt(4)
  v_mfma_f32_16x16x32_bf16 v[64:67], a[12:15], v[44:47], v[64:67]
  v_mfma_f32_16x16x32_bf16 v[68:71], a[16:19], v[44:47], v[68:71]
  ds_read_b128 v[40:43], v21 offset:6144
  v_mfma_f32_16x16x32_bf16 v[72:75], a[20:23], v[44:47], v[72:75]
  s_waitcnt lgkmcnt(4)
  v_mfma_f32_16x16x32_bf16 v[64:67], a[24:27], v[48:51], v[64:67]
  ds_read_b128 v[44:47], v21 offset:7168
  buffer_load_dwordx4 a[184:187], v4, s[4:7], s46 offen offset:1024 sc1
  v_mfma_f32_16x16x32_bf16 v[68:71], a[28:31], v[48:51], v[68:71]
  v_mfma_f32_16x16x32_bf16 v[72:75], a[32:35], v[48:51], v[72:75]
  s_waitcnt lgkmcnt(4)
  v_mfma_f32_16x16x32_bf16 v[64:67], a[36:39], v[52:55], v[64:67]
  v_mfma_f32_16x16x32_bf16 v[68:71], a[40:43], v[52:55], v[68:71]
  ds_read_b128 v[48:51], v21 offset:8192
  buffer_load_dwordx4 a[188:191], v4, s[4:7], s47 offen offset:1024 sc1
  v_mfma_f32_16x16x32_bf16 v[72:75], a[44:47], v[52:55], v[72:75]
  s_waitcnt lgkmcnt(4)
  v_mfma_f32_16x16x32_bf16 v[64:67], a[48:51], v[56:59], v[64:67]
  ds_read_b128 v[52:55], v21 offset:9216
  v_mfma_f32_16x16x32_bf16 v[68:71], a[52:55], v[56:59], v[68:71]
  v_mfma_f32_16x16x32_bf16 v[72:75], a[56:59], v[56:59], v[72:75]
  buffer_load_dwordx4 a[192:195], v4, s[4:7], s48 offen offset:1024 sc1
  s_waitcnt lgkmcnt(4)
  v_mfma_f32_16x16x32_bf16 v[64:67], a[60:63], v[60:63], v[64:67]
  s_waitcnt vmcnt(7)
  v_add_f32 v24, v24, v26
  v_add_f32 v25, v25, v27
  s_waitcnt vmcnt(6)
  v_add_f32 v28, v28, v30
  v_add_f32 v29, v29, v31
  v_mfma_f32_16x16x32_bf16 v[68:71], a[64:67], v[60:63], v[68:71]
  ds_read_b128 v[56:59], v21 offset:10240
  v_mfma_f32_16x16x32_bf16 v[72:75], a[68:71], v[60:63], v[72:75]
  s_waitcnt vmcnt(5)
  v_add_f32 v32, v32, v34
  v_add_f32 v33, v33, v35
  s_waitcnt vmcnt(4)
  v_add_f32 v36, v36, v38
  v_add_f32 v37, v37, v39
  s_waitcnt lgkmcnt(4)
  v_mfma_f32_16x16x32_bf16 v[64:67], a[72:75], v[40:43], v[64:67]
  ds_read_b128 v[60:63], v21 offset:11264
  buffer_load_dwordx4 a[196:199], v4, s[4:7], s44 offen offset:2048 sc1
  v_mfma_f32_16x16x32_bf16 v[68:71], a[76:79], v[40:43], v[68:71]
  v_mov_b32 v26, v24
  v_mov_b32 v27, v25
  v_mov_b32 v30, v28
  v_mov_b32 v31, v29
  v_mfma_f32_16x16x32_bf16 v[72:75], a[80:83], v[40:43], v[72:75]
  s_waitcnt lgkmcnt(4)
  v_mfma_f32_16x16x32_bf16 v[64:67], a[84:87], v[44:47], v[64:67]
  v_mov_b32 v34, v32
  v_mov_b32 v35, v33
  v_mov_b32 v38, v36
  v_mov_b32 v39, v37
  v_mfma_f32_16x16x32_bf16 v[68:71], a[88:91], v[44:47], v[68:71]
  ds_read_b128 v[40:43], v21 offset:12288
  buffer_load_dwordx4 a[200:203], v4, s[4:7], s45 offen offset:2048 sc1
  v_mfma_f32_16x16x32_bf16 v[72:75], a[92:95], v[44:47], v[72:75]
  v_permlane16_swap_b32 v24, v26
  v_permlane16_swap_b32 v25, v27
  v_permlane16_swap_b32 v28, v30
  v_permlane16_swap_b32 v29, v31
  s_waitcnt lgkmcnt(4)
  v_mfma_f32_16x16x32_bf16 v[64:67], a[96:99], v[48:51], v[64:67]
  ds_read_b128 v[44:47], v21 offset:13312
  v_mfma_f32_16x16x32_bf16 v[68:71], a[100:103], v[48:51], v[68:71]
  v_permlane16_swap_b32 v32, v34
  v_permlane16_swap_b32 v33, v35
  v_permlane16_swap_b32 v36, v38
  v_permlane16_swap_b32 v37, v39
  v_mfma_f32_16x16x32_bf16 v[72:75], a[104:107], v[48:51], v[72:75]
  buffer_load_dwordx4 a[204:207], v4, s[4:7], s46 offen offset:2048 sc1
  s_waitcnt lgkmcnt(4)
  v_mfma_f32_16x16x32_bf16 v[64:67], a[108:111], v[52:55], v[64:67]
  v_add_f32 v24, v24, v26
  v_add_f32 v25, v25, v27
  v_add_f32 v28, v28, v30
  v_add_f32 v29, v29, v31
  v_mfma_f32_16x16x32_bf16 v[68:71], a[112:115], v[52:55], v[68:71]
  ds_read_b128 v[48:51], v21 offset:14336
  v_mfma_f32_16x16x32_bf16 v[72:75], a[116:119], v[52:55], v[72:75]
  v_add_f32 v32, v32, v34
  v_add_f32 v33, v33, v35
  v_add_f32 v36, v36, v38
  v_add_f32 v37, v37, v39
  s_waitcnt lgkmcnt(4)
  v_mfma_f32_16x16x32_bf16 v[64:67], a[120:123], v[56:59], v[64:67]
  ds_read_b128 v[52:55], v21 offset:15360
  buffer_load_dwordx4 a[208:211], v4, s[4:7], s47 offen offset:2048 sc1
  v_mfma_f32_16x16x32_bf16 v[68:71], a[124:127], v[56:59], v[68:71]
  v_mov_b32 v26, v24
  v_mov_b32 v27, v25
  v_mov_b32 v30, v28
  v_mov_b32 v31, v29
  v_mfma_f32_16x16x32_bf16 v[72:75], a[128:131], v[56:59], v[72:75]
  s_waitcnt lgkmcnt(4)
  v_mfma_f32_16x16x32_bf16 v[64:67], a[132:135], v[60:63], v[64:67]
  v_mov_b32 v34, v32
  v_mov_b32 v35, v33
  v_mov_b32 v38, v36
  v_mov_b32 v39, v37
  v_mfma_f32_16x16x32_bf16 v[68:71], a[136:139], v[60:63], v[68:71]
  ds_read_b128 v[56:59], v21 offset:16384
  buffer_load_dwordx4 a[212:215], v4, s[4:7], s48 offen offset:2048 sc1
  v_mfma_f32_16x16x32_bf16 v[72:75], a[140:143], v[60:63], v[72:75]
  v_permlane32_swap_b32 v24, v26
  v_permlane32_swap_b32 v25, v27
  v_permlane32_swap_b32 v28, v30
  v_permlane32_swap_b32 v29, v31
  s_waitcnt lgkmcnt(4)
  v_mfma_f32_16x16x32_bf16 v[64:67], a[144:147], v[40:43], v[64:67]
  ds_read_b128 v[60:63], v21 offset:17408
  v_mfma_f32_16x16x32_bf16 v[68:71], a[148:151], v[40:43], v[68:71]
  v_permlane32_swap_b32 v32, v34
  v_permlane32_swap_b32 v33, v35
  v_permlane32_swap_b32 v36, v38
  v_permlane32_swap_b32 v37, v39
  v_mfma_f32_16x16x32_bf16 v[72:75], a[152:155], v[40:43], v[72:75]
  buffer_load_dwordx4 a[216:219], v4, s[4:7], s44 offen offset:3072 sc1
  s_waitcnt lgkmcnt(4)
  v_mfma_f32_16x16x32_bf16 v[64:67], v[172:175], v[44:47], v[64:67]
  v_add_f32 v24, v24, v26
  v_add_f32 v25, v25, v27
  v_add_f32 v28, v28, v30
  v_add_f32 v29, v29, v31
  v_mfma_f32_16x16x32_bf16 v[68:71], v[176:179], v[44:47], v[68:71]
  ds_read_b128 v[40:43], v21 offset:18432
  v_mfma_f32_16x16x32_bf16 v[72:75], v[180:183], v[44:47], v[72:75]
  v_add_f32 v32, v32, v34
  v_add_f32 v33, v33, v35
  v_add_f32 v36, v36, v38
  v_add_f32 v37, v37, v39
  s_waitcnt lgkmcnt(4)
  v_mfma_f32_16x16x32_bf16 v[64:67], v[184:187], v[48:51], v[64:67]
  ds_read_b128 v[44:47], v21 offset:19456
  buffer_load_dwordx4 a[220:223], v4, s[4:7], s45 offen offset:3072 sc1
  v_mfma_f32_16x16x32_bf16 v[68:71], v[188:191], v[48:51], v[68:71]
  v_mov_b32 v3, 0x3727c5ac
  v_mul_f32 v26, s56, v24
  v_mul_f32 v30, s56, v28
  v_mul_f32 v34, s56, v32
  v_mfma_f32_16x16x32_bf16 v[72:75], v[192:195], v[48:51], v[72:75]
  s_waitcnt lgkmcnt(4)
  v_mfma_f32_16x16x32_bf16 v[64:67], v[196:199], v[52:55], v[64:67]
  v_mul_f32 v38, s56, v36
  v_fma_f32 v25, v25, s56, v3
  v_fma_f32 v29, v29, s56, v3
  v_fma_f32 v33, v33, s56, v3
  v_mfma_f32_16x16x32_bf16 v[68:71], v[200:203], v[52:55], v[68:71]
  buffer_load_dwordx4 a[224:227], v4, s[4:7], s46 offen offset:3072 sc1
  v_mfma_f32_16x16x32_bf16 v[72:75], v[204:207], v[52:55], v[72:75]
  v_fma_f32 v37, v37, s56, v3
  v_fma_f32 v25, -v26, v26, v25
  v_fma_f32 v29, -v30, v30, v29
  v_fma_f32 v33, -v34, v34, v33
  s_waitcnt lgkmcnt(3)
  v_mfma_f32_16x16x32_bf16 v[64:67], v[208:211], v[56:59], v[64:67]
  v_mfma_f32_16x16x32_bf16 v[68:71], v[212:215], v[56:59], v[68:71]
  v_fma_f32 v37, -v38, v38, v37
  v_max_f32 v25, v25, v3
  v_max_f32 v29, v29, v3
  v_max_f32 v33, v33, v3
  v_mfma_f32_16x16x32_bf16 v[72:75], v[216:219], v[56:59], v[72:75]
  buffer_load_dwordx4 a[228:231], v4, s[4:7], s47 offen offset:3072 sc1
  s_waitcnt lgkmcnt(2)
  v_mfma_f32_16x16x32_bf16 v[64:67], v[220:223], v[60:63], v[64:67]
  v_max_f32 v37, v37, v3
  v_rsq_f32 v24, v25
  v_rsq_f32 v28, v29
  v_rsq_f32 v32, v33
  v_mfma_f32_16x16x32_bf16 v[68:71], v[224:227], v[60:63], v[68:71]
  v_mfma_f32_16x16x32_bf16 v[72:75], v[228:231], v[60:63], v[72:75]
  v_rsq_f32 v36, v37
  v_mul_f32 v24, s54, v24
  v_mul_f32 v28, s54, v28
  v_mul_f32 v32, s54, v32
  s_waitcnt lgkmcnt(1)
  v_mfma_f32_16x16x32_bf16 v[64:67], v[232:235], v[40:43], v[64:67]
  v_mfma_f32_16x16x32_bf16 v[68:71], v[236:239], v[40:43], v[68:71]
  v_mul_f32 v36, s54, v36
  v_mul_f32 v25, -v26, v24
  v_mul_f32 v29, -v30, v28
  v_mul_f32 v33, -v34, v32
  v_mfma_f32_16x16x32_bf16 v[72:75], v[240:243], v[40:43], v[72:75]
  s_waitcnt lgkmcnt(0)
  v_mfma_f32_16x16x32_bf16 v[64:67], v[244:247], v[44:47], v[64:67]
  v_mul_f32 v37, -v38, v36
  v_mfma_f32_16x16x32_bf16 v[68:71], v[248:251], v[44:47], v[68:71]
  v_mfma_f32_16x16x32_bf16 v[72:75], v[252:255], v[44:47], v[72:75]
  s_mul_i32 s3, s22, 12288
  s_add_u32 s32, s28, s3
  s_add_u32 s33, s32, 49152
  s_add_u32 s34, s31, s3
  s_add_u32 s35, s34, 49152
  v_bfe_u32 v20, v0, 3, 2
  v_lshl_add_u32 v20, v20, 7, v9
  s_and_b32 s29, s27, 0xfffffe00
  s_barrier
  ds_read_b128 v[40:43], v21 offset:20480
  ds_read_b128 v[44:47], v21 offset:21504
  ds_read_b128 v[48:51], v21 offset:22528
  ds_read_b128 v[52:55], v21 offset:23552
  ds_read_b128 v[56:59], v21 offset:24576
  s_waitcnt lgkmcnt(4)
  v_mfma_f32_16x16x32_bf16 v[76:79], a[0:3], v[40:43], 0
  ds_read_b128 v[60:63], v21 offset:25600
  buffer_load_dwordx4 a[232:235], v4, s[4:7], s48 offen offset:3072 sc1
  v_mfma_f32_16x16x32_bf16 v[80:83], a[4:7], v[40:43], 0
  v_mfma_f32_16x16x32_bf16 v[84:87], a[8:11], v[40:43], 0
  buffer_load_dwordx4 a[236:239], v5, s[4:7], s44 offen offset:0 sc1
  s_waitcnt lgkmcnt(4)
  v_mfma_f32_16x16x32_bf16 v[76:79], a[12:15], v[44:47], v[76:79]
  v_fma_f32 v112, v88, v25, v100
  v_fma_f32 v113, v89, v25, v101
  v_fma_f32 v114, v90, v25, v102
  v_fma_f32 v115, v91, v25, v103
  v_fma_f32 v116, v92, v25, v104
  v_mfma_f32_16x16x32_bf16 v[80:83], a[16:19], v[44:47], v[80:83]
  ds_read_b128 v[40:43], v21 offset:26624
  v_mfma_f32_16x16x32_bf16 v[84:87], a[20:23], v[44:47], v[84:87]
  v_fma_f32 v64, v64, v24, v112
  v_fma_f32 v65, v65, v24, v113
  v_fma_f32 v66, v66, v24, v114
  v_fma_f32 v67, v67, v24, v115
  v_fma_f32 v68, v68, v24, v116
  s_waitcnt lgkmcnt(4)
  v_mfma_f32_16x16x32_bf16 v[76:79], a[24:27], v[48:51], v[76:79]
  ds_read_b128 v[44:47], v21 offset:27648
  v_exp_f32 v112, v64
  buffer_load_dwordx4 a[240:243], v5, s[4:7], s45 offen offset:0 sc1
  v_mfma_f32_16x16x32_bf16 v[80:83], a[28:31], v[48:51], v[80:83]
  v_fma_f32 v117, v93, v25, v105
  v_fma_f32 v118, v94, v25, v106
  v_fma_f32 v119, v95, v25, v107
  v_mfma_f32_16x16x32_bf16 v[84:87], a[32:35], v[48:51], v[84:87]
  v_exp_f32 v113, v65
  s_waitcnt lgkmcnt(4)
  v_mfma_f32_16x16x32_bf16 v[76:79], a[36:39], v[52:55], v[76:79]
  v_fma_f32 v112, v112, s54, s54
  v_fma_f32 v69, v69, v24, v117
  v_fma_f32 v70, v70, v24, v118
  v_mfma_f32_16x16x32_bf16 v[80:83], a[40:43], v[52:55], v[80:83]
  ds_read_b128 v[48:51], v21 offset:28672
  v_rcp_f32 v112, v112
  buffer_load_dwordx4 a[244:247], v5, s[4:7], s46 offen offset:0 sc1
  v_mfma_f32_16x16x32_bf16 v[84:87], a[44:47], v[52:55], v[84:87]
  v_fma_f32 v113, v113, s54, s54
  v_fma_f32 v71, v71, v24, v119
  v_fma_f32 v120, v96, v25, v108
  s_waitcnt lgkmcnt(4)
  v_mfma_f32_16x16x32_bf16 v[76:79], a[48:51], v[56:59], v[76:79]
  ds_read_b128 v[52:55], v21 offset:29696
  v_rcp_f32 v113, v113
  v_mfma_f32_16x16x32_bf16 v[80:83], a[52:55], v[56:59], v[80:83]
  v_fma_f32 v72, v72, v24, v120
  v_mul_f32 v64, v64, v112
  v_fma_f32 v121, v97, v25, v109
  v_mfma_f32_16x16x32_bf16 v[84:87], a[56:59], v[56:59], v[84:87]
  v_exp_f32 v114, v66
  buffer_load_dwordx4 a[248:251], v5, s[4:7], s47 offen offset:0 sc1
  s_waitcnt lgkmcnt(4)
  v_mfma_f32_16x16x32_bf16 v[76:79], a[60:63], v[60:63], v[76:79]
  v_fma_f32 v73, v73, v24, v121
  v_mul_f32 v65, v65, v113
  v_fma_f32 v122, v98, v25, v110
  v_mfma_f32_16x16x32_bf16 v[80:83], a[64:67], v[60:63], v[80:83]
  ds_read_b128 v[56:59], v21 offset:30720
  v_exp_f32 v115, v67
  v_mfma_f32_16x16x32_bf16 v[84:87], a[68:71], v[60:63], v[84:87]
  v_fma_f32 v114, v114, s54, s54
  v_fma_f32 v74, v74, v24, v122
  v_cvt_pk_bf16_f32 v112, v64, v65
  s_waitcnt lgkmcnt(4)
  v_mfma_f32_16x16x32_bf16 v[76:79], a[72:75], v[40:43], v[76:79]
  ds_read_b128 v[60:63], v21 offset:31744
  v_rcp_f32 v114, v114
  buffer_load_dwordx4 a[252:255], v5, s[4:7], s48 offen offset:0 sc1
  v_mfma_f32_16x16x32_bf16 v[80:83], a[76:79], v[40:43], v[80:83]
  v_fma_f32 v115, v115, s54, s54
  v_fma_f32 v123, v99, v25, v111
  v_mfma_f32_16x16x32_bf16 v[84:87], a[80:83], v[40:43], v[84:87]
  v_rcp_f32 v115, v115
  s_waitcnt lgkmcnt(4)
  v_mfma_f32_16x16x32_bf16 v[76:79], a[84:87], v[44:47], v[76:79]
  v_fma_f32 v75, v75, v24, v123
  v_mul_f32 v66, v66, v114
  v_mfma_f32_16x16x32_bf16 v[80:83], a[88:91], v[44:47], v[80:83]
  ds_read_b128 v[40:43], v21 offset:32768
  v_exp_f32 v116, v68
  s_add_u32 m0, s57, 19456
  s_nop 0
  buffer_load_dwordx4 v5, s[4:7], s44 offen offset:1024 sc1 lds
  v_mfma_f32_16x16x32_bf16 v[84:87], a[92:95], v[44:47], v[84:87]
  v_mul_f32 v67, v67, v115
  s_waitcnt lgkmcnt(4)
  v_mfma_f32_16x16x32_bf16 v[76:79], a[96:99], v[48:51], v[76:79]
  ds_read_b128 v[44:47], v21 offset:33792
  v_exp_f32 v117, v69
  v_mfma_f32_16x16x32_bf16 v[80:83], a[100:103], v[48:51], v[80:83]
  v_fma_f32 v116, v116, s54, s54
  v_cvt_pk_bf16_f32 v113, v66, v67
  v_mfma_f32_16x16x32_bf16 v[84:87], a[104:107], v[48:51], v[84:87]
  v_rcp_f32 v116, v116
  s_add_u32 m0, s57, 20480
  s_nop 0
  buffer_load_dwordx4 v5, s[4:7], s45 offen offset:1024 sc1 lds
  s_waitcnt lgkmcnt(4)
  v_mfma_f32_16x16x32_bf16 v[76:79], a[108:111], v[52:55], v[76:79]
  v_fma_f32 v117, v117, s54, s54
  v_mfma_f32_16x16x32_bf16 v[80:83], a[112:115], v[52:55], v[80:83]
  ds_read_b128 v[48:51], v21 offset:34816
  v_rcp_f32 v117, v117
  v_mfma_f32_16x16x32_bf16 v[84:87], a[116:119], v[52:55], v[84:87]
  v_mul_f32 v68, v68, v116
  s_waitcnt lgkmcnt(4)
  v_mfma_f32_16x16x32_bf16 v[76:79], a[120:123], v[56:59], v[76:79]
  ds_read_b128 v[52:55], v21 offset:35840
  v_exp_f32 v118, v70
  s_add_u32 m0, s57, 21504
  s_nop 0
  buffer_load_dwordx4 v5, s[4:7], s46 offen offset:1024 sc1 lds
  v_mfma_f32_16x16x32_bf16 v[80:83], a[124:127], v[56:59], v[80:83]
  v_mul_f32 v69, v69, v117
  v_mfma_f32_16x16x32_bf16 v[84:87], a[128:131], v[56:59], v[84:87]
  v_exp_f32 v119, v71
  s_waitcnt lgkmcnt(4)
  v_mfma_f32_16x16x32_bf16 v[76:79], a[132:135], v[60:63], v[76:79]
  v_fma_f32 v118, v118, s54, s54
  v_cvt_pk_bf16_f32 v114, v68, v69
  v_mfma_f32_16x16x32_bf16 v[80:83], a[136:139], v[60:63], v[80:83]
  ds_read_b128 v[56:59], v21 offset:36864
  v_rcp_f32 v118, v118
  s_add_u32 m0, s57, 22528
  s_nop 0
  buffer_load_dwordx4 v5, s[4:7], s47 offen offset:1024 sc1 lds
  v_mfma_f32_16x16x32_bf16 v[84:87], a[140:143], v[60:63], v[84:87]
  v_fma_f32 v119, v119, s54, s54
  s_waitcnt lgkmcnt(4)
  v_mfma_f32_16x16x32_bf16 v[76:79], a[144:147], v[40:43], v[76:79]
  ds_read_b128 v[60:63], v21 offset:37888
  v_rcp_f32 v119, v119
  v_mfma_f32_16x16x32_bf16 v[80:83], a[148:151], v[40:43], v[80:83]
  v_mul_f32 v70, v70, v118
  v_mfma_f32_16x16x32_bf16 v[84:87], a[152:155], v[40:43], v[84:87]
  v_exp_f32 v120, v72
  s_add_u32 m0, s57, 23552
  s_nop 0
  buffer_load_dwordx4 v5, s[4:7], s48 offen offset:1024 sc1 lds
  s_waitcnt lgkmcnt(4)
  v_mfma_f32_16x16x32_bf16 v[76:79], v[172:175], v[44:47], v[76:79]
  v_mul_f32 v71, v71, v119
  v_mfma_f32_16x16x32_bf16 v[80:83], v[176:179], v[44:47], v[80:83]
  ds_read_b128 v[40:43], v21 offset:38912
  v_exp_f32 v121, v73
  v_mfma_f32_16x16x32_bf16 v[84:87], v[180:183], v[44:47], v[84:87]
  v_fma_f32 v120, v120, s54, s54
  v_cvt_pk_bf16_f32 v115, v70, v71
  s_waitcnt lgkmcnt(4)
  v_mfma_f32_16x16x32_bf16 v[76:79], v[184:187], v[48:51], v[76:79]
  ds_read_b128 v[44:47], v21 offset:39936
  v_rcp_f32 v120, v120
  s_add_u32 m0, s57, 38912
  s_nop 0
  buffer_load_dwordx4 v5, s[4:7], s44 offen offset:2048 sc1 lds
  v_mfma_f32_16x16x32_bf16 v[80:83], v[188:191], v[48:51], v[80:83]
  v_fma_f32 v121, v121, s54, s54
  v_mfma_f32_16x16x32_bf16 v[84:87], v[192:195], v[48:51], v[84:87]
  v_rcp_f32 v121, v121
  s_waitcnt lgkmcnt(4)
  v_mfma_f32_16x16x32_bf16 v[76:79], v[196:199], v[52:55], v[76:79]
  v_mul_f32 v72, v72, v120
  v_mfma_f32_16x16x32_bf16 v[80:83], v[200:203], v[52:55], v[80:83]
  ds_read_b128 v[48:51], v22 offset:0
  v_exp_f32 v122, v74
  s_add_u32 m0, s57, 39936
  s_nop 0
  buffer_load_dwordx4 v5, s[4:7], s45 offen offset:2048 sc1 lds
  v_mfma_f32_16x16x32_bf16 v[84:87], v[204:207], v[52:55], v[84:87]
  v_mul_f32 v73, v73, v121
  s_waitcnt lgkmcnt(4)
  v_mfma_f32_16x16x32_bf16 v[76:79], v[208:211], v[56:59], v[76:79]
  ds_read_b128 v[52:55], v22 offset:1024
  v_exp_f32 v123, v75
  v_mfma_f32_16x16x32_bf16 v[80:83], v[212:215], v[56:59], v[80:83]
  v_fma_f32 v122, v122, s54, s54
  v_cvt_pk_bf16_f32 v116, v72, v73
  v_mfma_f32_16x16x32_bf16 v[84:87], v[216:219], v[56:59], v[84:87]
  v_rcp_f32 v122, v122
  s_add_u32 m0, s57, 40960
  s_nop 0
  buffer_load_dwordx4 v5, s[4:7], s46 offen offset:2048 sc1 lds
  s_waitcnt lgkmcnt(4)
  v_mfma_f32_16x16x32_bf16 v[76:79], v[220:223], v[60:63], v[76:79]
  v_fma_f32 v123, v123, s54, s54
  v_mfma_f32_16x16x32_bf16 v[80:83], v[224:227], v[60:63], v[80:83]
  ds_read_b128 v[56:59], v22 offset:2048
  v_rcp_f32 v123, v123
  v_mfma_f32_16x16x32_bf16 v[84:87], v[228:231], v[60:63], v[84:87]
  v_mul_f32 v74, v74, v122
  s_waitcnt lgkmcnt(4)
  v_mfma_f32_16x16x32_bf16 v[76:79], v[232:235], v[40:43], v[76:79]
  ds_read_b128 v[60:63], v22 offset:3072
  v_mfma_f32_16x16x32_bf16 v[80:83], v[236:239], v[40:43], v[80:83]
  v_mul_f32 v75, v75, v123
  v_mfma_f32_16x16x32_bf16 v[84:87], v[240:243], v[40:43], v[84:87]
  s_waitcnt lgkmcnt(4)
  v_mfma_f32_16x16x32_bf16 v[76:79], v[244:247], v[44:47], v[76:79]
  v_cvt_pk_bf16_f32 v117, v74, v75
  v_mfma_f32_16x16x32_bf16 v[80:83], v[248:251], v[44:47], v[80:83]
  ds_read_b128 v[40:43], v22 offset:4096
  s_cmp_eq_u32 s23, 0
  s_cbranch_scc1 SLOW8
  buffer_store_dwordx4 v[112:115], v4, s[4:7], s52 offen
  buffer_store_dwordx2 v[116:117], v4, s[4:7], s53 offen
RET8:
  s_add_u32 s52, s52, 49152
  s_add_u32 s53, s53, 49152
  v_mfma_f32_16x16x32_bf16 v[84:87], v[252:255], v[44:47], v[84:87]
  s_waitcnt lgkmcnt(4)
  v_mfma_f32_16x16x32_bf16 v[64:67], a[0:3], v[48:51], 0
  ds_read_b128 v[44:47], v22 offset:5120
  s_add_u32 m0, s57, 41984
  s_nop 0
  buffer_load_dwordx4 v5, s[4:7], s47 offen offset:2048 sc1 lds
  v_mfma_f32_16x16x32_bf16 v[68:71], a[4:7], v[48:51], 0
  v_mfma_f32_16x16x32_bf16 v[72:75], a[8:11], v[48:51], 0
  s_add_u32 m0, s57, 43008
  s_nop 0
  buffer_load_dwordx4 v5, s[4:7], s48 offen offset:2048 sc1 lds
  s_waitcnt lgkmcnt(4)
  v_mfma_f32_16x16x32_bf16 v[64:67], a[12:15], v[52:55], v[64:67]
  v_fma_f32 v112, v88, v29, v100
  v_fma_f32 v113, v89, v29, v101
  v_fma_f32 v114, v90, v29, v102
  v_fma_f32 v115, v91, v29, v103
  v_fma_f32 v116, v92, v29, v104
  v_mfma_f32_16x16x32_bf16 v[68:71], a[16:19], v[52:55], v[68:71]
  ds_read_b128 v[48:51], v22 offset:6144
  v_mfma_f32_16x16x32_bf16 v[72:75], a[20:23], v[52:55], v[72:75]
  v_fma_f32 v76, v76, v28, v112
  v_fma_f32 v77, v77, v28, v113
  v_fma_f32 v78, v78, v28, v114
  v_fma_f32 v79, v79, v28, v115
  v_fma_f32 v80, v80, v28, v116
  s_waitcnt lgkmcnt(4)
  v_mfma_f32_16x16x32_bf16 v[64:67], a[24:27], v[56:59], v[64:67]
  ds_read_b128 v[52:55], v22 offset:7168
  v_exp_f32 v112, v76
  s_add_u32 m0, s57, 0
  s_nop 0
  buffer_load_dwordx4 v6, s[4:7], s44 offen offset:0 sc1 lds
  v_mfma_f32_16x16x32_bf16 v[68:71], a[28:31], v[56:59], v[68:71]
  v_fma_f32 v117, v93, v29, v105
  v_fma_f32 v118, v94, v29, v106
  v_fma_f32 v119, v95, v29, v107
  v_mfma_f32_16x16x32_bf16 v[72:75], a[32:35], v[56:59], v[72:75]
  v_exp_f32 v113, v77
  s_waitcnt lgkmcnt(4)
  v_mfma_f32_16x16x32_bf16 v[64:67], a[36:39], v[60:63], v[64:67]
  v_fma_f32 v112, v112, s54, s54
  v_fma_f32 v81, v81, v28, v117
  v_fma_f32 v82, v82, v28, v118
  v_mfma_f32_16x16x32_bf16 v[68:71], a[40:43], v[60:63], v[68:71]
  ds_read_b128 v[56:59], v22 offset:8192
  v_rcp_f32 v112, v112
  s_add_u32 m0, s57, 1024
  s_nop 0
  buffer_load_dwordx4 v6, s[4:7], s45 offen offset:0 sc1 lds
  v_mfma_f32_16x16x32_bf16 v[72:75], a[44:47], v[60:63], v[72:75]
  v_fma_f32 v113, v113, s54, s54
  v_fma_f32 v83, v83, v28, v119
  v_fma_f32 v120, v96, v29, v108
  s_waitcnt lgkmcnt(4)
  v_mfma_f32_16x16x32_bf16 v[64:67], a[48:51], v[40:43], v[64:67]
  ds_read_b128 v[60:63], v22 offset:9216
  v_rcp_f32 v113, v113
  s_add_u32 m0, s57, 2048
  s_nop 0
  buffer_load_dwordx4 v6, s[4:7], s46 offen offset:0 sc1 lds
  v_mfma_f32_16x16x32_bf16 v[68:71], a[52:55], v[40:43], v[68:71]
  v_fma_f32 v84, v84, v28, v120
  v_mul_f32 v76, v76, v112
  v_fma_f32 v121, v97, v29, v109
  v_mfma_f32_16x16x32_bf16 v[72:75], a[56:59], v[40:43], v[72:75]
  v_exp_f32 v114, v78
  s_add_u32 s72, s24, 3
  v_mov_b32 v3, s72
  s_waitcnt vmcnt(5)
  s_cmp_eq_u32 s23, 0
  s_cbranch_scc1 SLOW9
  buffer_store_dword v3, off, s[4:7], s26
RET9:
  s_waitcnt lgkmcnt(4)
  v_mfma_f32_16x16x32_bf16 v[64:67], a[60:63], v[44:47], v[64:67]
  v_fma_f32 v85, v85, v28, v121
  v_mul_f32 v77, v77, v113
  v_fma_f32 v122, v98, v29, v110
  v_mfma_f32_16x16x32_bf16 v[68:71], a[64:67], v[44:47], v[68:71]
  ds_read_b128 v[40:43], v22 offset:10240
  v_exp_f32 v115, v79
  s_add_u32 m0, s57, 3072
  s_nop 0
  buffer_load_dwordx4 v6, s[4:7], s47 offen offset:0 sc1 lds
  v_mfma_f32_16x16x32_bf16 v[72:75], a[68:71], v[44:47], v[72:75]
  v_fma_f32 v114, v114, s54, s54
  v_fma_f32 v86, v86, v28, v122
  v_cvt_pk_bf16_f32 v112, v76, v77
  s_waitcnt lgkmcnt(4)
  v_mfma_f32_16x16x32_bf16 v[64:67], a[72:75], v[48:51], v[64:67]
  ds_read_b128 v[44:47], v22 offset:11264
  v_rcp_f32 v114, v114
  v_mfma_f32_16x16x32_bf16 v[68:71], a[76:79], v[48:51], v[68:71]
  v_fma_f32 v115, v115, s54, s54
  v_fma_f32 v123, v99, v29, v111
  v_mfma_f32_16x16x32_bf16 v[72:75], a[80:83], v[48:51], v[72:75]
  v_rcp_f32 v115, v115
  s_add_u32 m0, s57, 4096
  s_nop 0
  buffer_load_dwordx4 v6, s[4:7], s48 offen offset:0 sc1 lds
  s_waitcnt lgkmcnt(4)
  v_mfma_f32_16x16x32_bf16 v[64:67], a[84:87], v[52:55], v[64:67]
  v_fma_f32 v87, v87, v28, v123
  v_mul_f32 v78, v78, v114
  v_mfma_f32_16x16x32_bf16 v[68:71], a[88:91], v[52:55], v[68:71]
  ds_read_b128 v[48:51], v22 offset:12288
  v_exp_f32 v116, v80
  s_add_u32 m0, s58, -1024
  s_nop 0
  buffer_load_dwordx4 v6, s[4:7], s44 offen offset:1024 sc1 lds
  v_mfma_f32_16x16x32_bf16 v[72:75], a[92:95], v[52:55], v[72:75]
  v_mul_f32 v79, v79, v115
  s_waitcnt lgkmcnt(4)
  v_mfma_f32_16x16x32_bf16 v[64:67], a[96:99], v[56:59], v[64:67]
  ds_read_b128 v[52:55], v22 offset:13312
  v_exp_f32 v117, v81
  v_mfma_f32_16x16x32_bf16 v[68:71], a[100:103], v[56:59], v[68:71]
  v_fma_f32 v116, v116, s54, s54
  v_cvt_pk_bf16_f32 v113, v78, v79
  v_mfma_f32_16x16x32_bf16 v[72:75], a[104:107], v[56:59], v[72:75]
  v_rcp_f32 v116, v116
  s_add_u32 m0, s58, 0
  s_nop 0
  buffer_load_dwordx4 v6, s[4:7], s45 offen offset:1024 sc1 lds
  s_waitcnt lgkmcnt(4)
  v_mfma_f32_16x16x32_bf16 v[64:67], a[108:111], v[60:63], v[64:67]
  v_fma_f32 v117, v117, s54, s54
  v_mfma_f32_16x16x32_bf16 v[68:71], a[112:115], v[60:63], v[68:71]
  ds_read_b128 v[56:59], v22 offset:14336
  v_rcp_f32 v117, v117
  v_mfma_f32_16x16x32_bf16 v[72:75], a[116:119], v[60:63], v[72:75]
  v_mul_f32 v80, v80, v116
  s_waitcnt lgkmcnt(4)
  v_mfma_f32_16x16x32_bf16 v[64:67], a[120:123], v[40:43], v[64:67]
  ds_read_b128 v[60:63], v22 offset:15360
  v_exp_f32 v118, v82
  s_add_u32 m0, s58, 1024
  s_nop 0
  buffer_load_dwordx4 v6, s[4:7], s46 offen offset:1024 sc1 lds
  v_mfma_f32_16x16x32_bf16 v[68:71], a[124:127], v[40:43], v[68:71]
  v_mul_f32 v81, v81, v117
  v_mfma_f32_16x16x32_bf16 v[72:75], a[128:131], v[40:43], v[72:75]
  v_exp_f32 v119, v83
  s_add_u32 m0, s57, 58368
  s_nop 0
  buffer_load_dwordx4 v5, s[4:7], s44 offen offset:3072 sc1 lds
  s_waitcnt lgkmcnt(4)
  v_mfma_f32_16x16x32_bf16 v[64:67], a[132:135], v[44:47], v[64:67]
  v_fma_f32 v118, v118, s54, s54
  v_cvt_pk_bf16_f32 v114, v80, v81
  v_mfma_f32_16x16x32_bf16 v[68:71], a[136:139], v[44:47], v[68:71]
  ds_read_b128 v[40:43], v22 offset:16384
  v_rcp_f32 v118, v118
  v_mfma_f32_16x16x32_bf16 v[72:75], a[140:143], v[44:47], v[72:75]
  v_fma_f32 v119, v119, s54, s54
  s_waitcnt lgkmcnt(4)
  v_mfma_f32_16x16x32_bf16 v[64:67], a[144:147], v[48:51], v[64:67]
  ds_read_b128 v[44:47], v22 offset:17408
  v_rcp_f32 v119, v119
  s_add_u32 m0, s57, 59392
  s_nop 0
  buffer_load_dwordx4 v5, s[4:7], s45 offen offset:3072 sc1 lds
  v_mfma_f32_16x16x32_bf16 v[68:71], a[148:151], v[48:51], v[68:71]
  v_mul_f32 v82, v82, v118
  v_mfma_f32_16x16x32_bf16 v[72:75], a[152:155], v[48:51], v[72:75]
  v_exp_f32 v120, v84
  s_waitcnt lgkmcnt(4)
  v_mfma_f32_16x16x32_bf16 v[64:67], v[172:175], v[52:55], v[64:67]
  v_mul_f32 v83, v83, v119
  v_mfma_f32_16x16x32_bf16 v[68:71], v[176:179], v[52:55], v[68:71]
  ds_read_b128 v[48:51], v22 offset:18432
  v_exp_f32 v121, v85
  s_add_u32 m0, s57, 60416
  s_nop 0
  buffer_load_dwordx4 v5, s[4:7], s46 offen offset:3072 sc1 lds
  v_mfma_f32_16x16x32_bf16 v[72:75], v[180:183], v[52:55], v[72:75]
  v_fma_f32 v120, v120, s54, s54
  v_cvt_pk_bf16_f32 v115, v82, v83
  s_waitcnt lgkmcnt(4)
  v_mfma_f32_16x16x32_bf16 v[64:67], v[184:187], v[56:59], v[64:67]
  ds_read_b128 v[52:55], v22 offset:19456
  v_rcp_f32 v120, v120
  s_add_u32 m0, s57, 61440
  s_nop 0
  buffer_load_dwordx4 v5, s[4:7], s47 offen offset:3072 sc1 lds
  v_mfma_f32_16x16x32_bf16 v[68:71], v[188:191], v[56:59], v[68:71]
  v_fma_f32 v121, v121, s54, s54
  v_mfma_f32_16x16x32_bf16 v[72:75], v[192:195], v[56:59], v[72:75]
  v_rcp_f32 v121, v121
  s_waitcnt lgkmcnt(4)
  v_mfma_f32_16x16x32_bf16 v[64:67], v[196:199], v[60:63], v[64:67]
  v_mul_f32 v84, v84, v120
  v_mfma_f32_16x16x32_bf16 v[68:71], v[200:203], v[60:63], v[68:71]
  ds_read_b128 v[56:59], v22 offset:20480
  v_exp_f32 v122, v86
  s_add_u32 m0, s57, 62464
  s_nop 0
  buffer_load_dwordx4 v5, s[4:7], s48 offen offset:3072 sc1 lds
  v_mfma_f32_16x16x32_bf16 v[72:75], v[204:207], v[60:63], v[72:75]
  v_mul_f32 v85, v85, v121
  s_waitcnt lgkmcnt(4)
  v_mfma_f32_16x16x32_bf16 v[64:67], v[208:211], v[40:43], v[64:67]
  ds_read_b128 v[60:63], v22 offset:21504
  v_exp_f32 v123, v87
  v_mfma_f32_16x16x32_bf16 v[68:71], v[212:215], v[40:43], v[68:71]
  v_fma_f32 v122, v122, s54, s54
  v_cvt_pk_bf16_f32 v116, v84, v85
  v_mfma_f32_16x16x32_bf16 v[72:75], v[216:219], v[40:43], v[72:75]
  v_rcp_f32 v122, v122
  s_waitcnt lgkmcnt(4)
  v_mfma_f32_16x16x32_bf16 v[64:67], v[220:223], v[44:47], v[64:67]
  v_fma_f32 v123, v123, s54, s54
  v_mfma_f32_16x16x32_bf16 v[68:71], v[224:227], v[44:47], v[68:71]
  ds_read_b128 v[40:43], v22 offset:22528
  v_rcp_f32 v123, v123
  v_mfma_f32_16x16x32_bf16 v[72:75], v[228:231], v[44:47], v[72:75]
  v_mul_f32 v86, v86, v122
  s_waitcnt lgkmcnt(4)
  v_mfma_f32_16x16x32_bf16 v[64:67], v[232:235], v[48:51], v[64:67]
  ds_read_b128 v[44:47], v22 offset:23552
  v_mfma_f32_16x16x32_bf16 v[68:71], v[236:239], v[48:51], v[68:71]
  v_mul_f32 v87, v87, v123
  v_mfma_f32_16x16x32_bf16 v[72:75], v[240:243], v[48:51], v[72:75]
  s_waitcnt lgkmcnt(4)
  v_mfma_f32_16x16x32_bf16 v[64:67], v[244:247], v[52:55], v[64:67]
  v_cvt_pk_bf16_f32 v117, v86, v87
  v_mfma_f32_16x16x32_bf16 v[68:71], v[248:251], v[52:55], v[68:71]
  ds_read_b128 v[48:51], v22 offset:24576
  s_cmp_eq_u32 s23, 0
  s_cbranch_scc1 SLOW10
  buffer_store_dwordx4 v[112:115], v4, s[4:7], s52 offen
  buffer_store_dwordx2 v[116:117], v4, s[4:7], s53 offen
RET10:
  s_add_u32 s52, s52, 3096576
  s_add_u32 s53, s53, 3096576
  buffer_load_dword v3, v20, s[4:7], s29 offen sc1
  v_add_u32 v21, s57, v4
  v_mfma_f32_16x16x32_bf16 v[72:75], v[252:255], v[52:55], v[72:75]
  s_waitcnt lgkmcnt(4)
  v_mfma_f32_16x16x32_bf16 v[76:79], a[0:3], v[56:59], 0
  ds_read_b128 v[52:55], v22 offset:25600
  v_mfma_f32_16x16x32_bf16 v[80:83], a[4:7], v[56:59], 0
  v_mfma_f32_16x16x32_bf16 v[84:87], a[8:11], v[56:59], 0
  s_waitcnt lgkmcnt(4)
  v_mfma_f32_16x16x32_bf16 v[76:79], a[12:15], v[60:63], v[76:79]
  v_fma_f32 v112, v88, v33, v100
  v_fma_f32 v113, v89, v33, v101
  v_fma_f32 v114, v90, v33, v102
  v_fma_f32 v115, v91, v33, v103
  v_fma_f32 v116, v92, v33, v104
  v_mfma_f32_16x16x32_bf16 v[80:83], a[16:19], v[60:63], v[80:83]
  ds_read_b128 v[56:59], v22 offset:26624
  v_mfma_f32_16x16x32_bf16 v[84:87], a[20:23], v[60:63], v[84:87]
  v_fma_f32 v64, v64, v32, v112
  v_fma_f32 v65, v65, v32, v113
  v_fma_f32 v66, v66, v32, v114
  v_fma_f32 v67, v67, v32, v115
  v_fma_f32 v68, v68, v32, v116
  s_waitcnt lgkmcnt(4)
  v_mfma_f32_16x16x32_bf16 v[76:79], a[24:27], v[40:43], v[76:79]
  ds_read_b128 v[60:63], v22 offset:27648
  v_exp_f32 v112, v64
  s_waitcnt vmcnt(3)
  v_mfma_f32_16x16x32_bf16 v[80:83], a[28:31], v[40:43], v[80:83]
  v_fma_f32 v117, v93, v33, v105
  v_fma_f32 v118, v94, v33, v106
  v_fma_f32 v119, v95, v33, v107
  v_mfma_f32_16x16x32_bf16 v[84:87], a[32:35], v[40:43], v[84:87]
  v_exp_f32 v113, v65
  s_add_u32 s72, s24, 3
  s_waitcnt vmcnt(0)
  v_subrev_u32 v3, s72, v3
  v_cmp_gt_u32 vcc, 8, v3
  s_nop 3
  s_cmp_eq_u64 vcc, -1
  s_cbranch_scc0 SPIN11
PDONE11:
  ds_read_b128 a[0:3], v21 offset:20480
  s_waitcnt lgkmcnt(5)
  v_mfma_f32_16x16x32_bf16 v[76:79], a[36:39], v[44:47], v[76:79]
  v_fma_f32 v112, v112, s54, s54
  v_fma_f32 v69, v69, v32, v117
  v_fma_f32 v70, v70, v32, v118
  v_mfma_f32_16x16x32_bf16 v[80:83], a[40:43], v[44:47], v[80:83]
  ds_read_b128 v[40:43], v22 offset:28672
  v_rcp_f32 v112, v112
  ds_read_b128 a[4:7], v21 offset:21504
  buffer_load_dwordx4 v[124:127], v4, s[4:7], s32 offen offset:0 sc1
  v_mfma_f32_16x16x32_bf16 v[84:87], a[44:47], v[44:47], v[84:87]
  v_fma_f32 v113, v113, s54, s54
  v_fma_f32 v71, v71, v32, v119
  v_fma_f32 v120, v96, v33, v108
  s_waitcnt lgkmcnt(6)
  v_mfma_f32_16x16x32_bf16 v[76:79], a[48:51], v[48:51], v[76:79]
  ds_read_b128 v[44:47], v22 offset:29696
  v_rcp_f32 v113, v113
  ds_read_b128 a[8:11], v21 offset:22528
  buffer_load_dwordx4 v[128:131], v4, s[4:7], s32 offen offset:1024 sc1
  v_mfma_f32_16x16x32_bf16 v[80:83], a[52:55], v[48:51], v[80:83]
  v_fma_f32 v72, v72, v32, v120
  v_mul_f32 v64, v64, v112
  v_fma_f32 v121, v97, v33, v109
  v_mfma_f32_16x16x32_bf16 v[84:87], a[56:59], v[48:51], v[84:87]
  v_exp_f32 v114, v66
  s_add_u32 s72, s24, 4
  v_mov_b32 v3, s72
  s_cmp_eq_u32 s23, 0
  s_cbranch_scc1 SLOW12
  buffer_store_dword v3, off, s[4:7], s26
RET12:
  ds_read_b128 a[12:15], v21 offset:23552
  s_waitcnt lgkmcnt(8)
  v_mfma_f32_16x16x32_bf16 v[76:79], a[60:63], v[52:55], v[76:79]
  v_fma_f32 v73, v73, v32, v121
  v_mul_f32 v65, v65, v113
  v_fma_f32 v122, v98, v33, v110
  v_mfma_f32_16x16x32_bf16 v[80:83], a[64:67], v[52:55], v[80:83]
  ds_read_b128 v[48:51], v22 offset:30720
  v_exp_f32 v115, v67
  ds_read_b128 a[16:19], v21 offset:24576
  buffer_load_dwordx4 v[132:135], v4, s[4:7], s32 offen offset:2048 sc1
  v_mfma_f32_16x16x32_bf16 v[84:87], a[68:71], v[52:55], v[84:87]
  v_fma_f32 v114, v114, s54, s54
  v_fma_f32 v74, v74, v32, v122
  v_cvt_pk_bf16_f32 v112, v64, v65
  s_waitcnt lgkmcnt(9)
  v_mfma_f32_16x16x32_bf16 v[76:79], a[72:75], v[56:59], v[76:79]
  ds_read_b128 v[52:55], v22 offset:31744
  v_rcp_f32 v114, v114
  ds_read_b128 a[20:23], v21 offset:40960
  v_mfma_f32_16x16x32_bf16 v[80:83], a[76:79], v[56:59], v[80:83]
  v_fma_f32 v115, v115, s54, s54
  v_fma_f32 v123, v99, v33, v111
  v_mfma_f32_16x16x32_bf16 v[84:87], a[80:83], v[56:59], v[84:87]
  v_rcp_f32 v115, v115
  ds_read_b128 a[24:27], v21 offset:41984
  buffer_load_dwordx4 v[136:139], v4, s[4:7], s32 offen offset:3072 sc1
  s_waitcnt lgkmcnt(11)
  v_mfma_f32_16x16x32_bf16 v[76:79], a[84:87], v[60:63], v[76:79]
  v_fma_f32 v75, v75, v32, v123
  v_mul_f32 v66, v66, v114
  v_mfma_f32_16x16x32_bf16 v[80:83], a[88:91], v[60:63], v[80:83]
  ds_read_b128 v[56:59], v22 offset:32768
  v_exp_f32 v116, v68
  ds_read_b128 a[28:31], v21 offset:43008
  buffer_load_dwordx4 v[140:143], v5, s[4:7], s32 offen offset:0 sc1
  v_mfma_f32_16x16x32_bf16 v[84:87], a[92:95], v[60:63], v[84:87]
  v_mul_f32 v67, v67, v115
  s_waitcnt lgkmcnt(11)
  v_mfma_f32_16x16x32_bf16 v[76:79], a[96:99], v[40:43], v[76:79]
  ds_read_b128 v[60:63], v22 offset:33792
  v_exp_f32 v117, v69
  ds_read_b128 a[32:35], v21 offset:44032
  v_mfma_f32_16x16x32_bf16 v[80:83], a[100:103], v[40:43], v[80:83]
  v_fma_f32 v116, v116, s54, s54
  v_cvt_pk_bf16_f32 v113, v66, v67
  v_mfma_f32_16x16x32_bf16 v[84:87], a[104:107], v[40:43], v[84:87]
  v_rcp_f32 v116, v116
  ds_read_b128 a[36:39], v21 offset:45056
  buffer_load_dwordx4 v[144:147], v5, s[4:7], s32 offen offset:1024 sc1
  s_waitcnt lgkmcnt(12)
  v_mfma_f32_16x16x32_bf16 v[76:79], a[108:111], v[44:47], v[76:79]
  v_fma_f32 v117, v117, s54, s54
  v_mfma_f32_16x16x32_bf16 v[80:83], a[112:115], v[44:47], v[80:83]
  ds_read_b128 v[40:43], v22 offset:34816
  v_rcp_f32 v117, v117
  ds_read_b128 a[40:43], v21 offset:61440
  v_mfma_f32_16x16x32_bf16 v[84:87], a[116:119], v[44:47], v[84:87]
  v_mul_f32 v68, v68, v116
  s_waitcnt lgkmcnt(11)
  v_mfma_f32_16x16x32_bf16 v[76:79], a[120:123], v[48:51], v[76:79]
  ds_read_b128 v[44:47], v22 offset:35840
  v_exp_f32 v118, v70
  ds_read_b128 a[44:47], v21 offset:62464
  buffer_load_dwordx4 v[148:151], v5, s[4:7], s32 offen offset:2048 sc1
  v_mfma_f32_16x16x32_bf16 v[80:83], a[124:127], v[48:51], v[80:83]
  v_mul_f32 v69, v69, v117
  v_mfma_f32_16x16x32_bf16 v[84:87], a[128:131], v[48:51], v[84:87]
  v_exp_f32 v119, v71
  ds_read_b128 a[48:51], v21 offset:63488
  buffer_load_dwordx4 v[152:155], v5, s[4:7], s32 offen offset:3072 sc1
  s_waitcnt lgkmcnt(12)
  v_mfma_f32_16x16x32_bf16 v[76:79], a[132:135], v[52:55], v[76:79]
  v_fma_f32 v118, v118, s54, s54
  v_cvt_pk_bf16_f32 v114, v68, v69
  v_mfma_f32_16x16x32_bf16 v[80:83], a[136:139], v[52:55], v[80:83]
  ds_read_b128 v[48:51], v22 offset:36864
  v_rcp_f32 v118, v118
  ds_read_b128 a[52:55], v21 offset:64512
  v_mfma_f32_16x16x32_bf16 v[84:87], a[140:143], v[52:55], v[84:87]
  v_fma_f32 v119, v119, s54, s54
  s_waitcnt lgkmcnt(11)
  v_mfma_f32_16x16x32_bf16 v[76:79], a[144:147], v[56:59], v[76:79]
  ds_read_b128 v[52:55], v22 offset:37888
  v_rcp_f32 v119, v119
  buffer_load_dwordx4 v[156:159], v6, s[4:7], s32 offen offset:0 sc1
  v_mfma_f32_16x16x32_bf16 v[80:83], a[148:151], v[56:59], v[80:83]
  v_mul_f32 v70, v70, v118
  v_mfma_f32_16x16x32_bf16 v[84:87], a[152:155], v[56:59], v[84:87]
  v_exp_f32 v120, v72
  ds_read_b128 a[60:63], v21 offset:0
  s_waitcnt lgkmcnt(11)
  v_mfma_f32_16x16x32_bf16 v[76:79], v[172:175], v[60:63], v[76:79]
  v_mul_f32 v71, v71, v119
  v_mfma_f32_16x16x32_bf16 v[80:83], v[176:179], v[60:63], v[80:83]
  ds_read_b128 v[56:59], v22 offset:38912
  v_exp_f32 v121, v73
  ds_read_b128 a[64:67], v21 offset:1024
  v_mfma_f32_16x16x32_bf16 v[84:87], v[180:183], v[60:63], v[84:87]
  v_fma_f32 v120, v120, s54, s54
  v_cvt_pk_bf16_f32 v115, v70, v71
  s_waitcnt lgkmcnt(10)
  v_mfma_f32_16x16x32_bf16 v[76:79], v[184:187], v[40:43], v[76:79]
  ds_read_b128 v[60:63], v22 offset:39936
  v_rcp_f32 v120, v120
  ds_read_b128 a[68:71], v21 offset:2048
  buffer_load_dwordx4 a[92:95], v6, s[4:7], s47 offen offset:1024 sc1
  v_mfma_f32_16x16x32_bf16 v[80:83], v[188:191], v[40:43], v[80:83]
  v_fma_f32 v121, v121, s54, s54
  v_mfma_f32_16x16x32_bf16 v[84:87], v[192:195], v[40:43], v[84:87]
  v_rcp_f32 v121, v121
  ds_read_b128 a[72:75], v21 offset:3072
  buffer_load_dwordx4 a[96:99], v6, s[4:7], s48 offen offset:1024 sc1
  s_waitcnt lgkmcnt(11)
  v_mfma_f32_16x16x32_bf16 v[76:79], v[196:199], v[44:47], v[76:79]
  v_mul_f32 v72, v72, v120
  v_mfma_f32_16x16x32_bf16 v[80:83], v[200:203], v[44:47], v[80:83]
  v_exp_f32 v122, v74
  ds_read_b128 a[76:79], v21 offset:4096
  v_mfma_f32_16x16x32_bf16 v[84:87], v[204:207], v[44:47], v[84:87]
  v_mul_f32 v73, v73, v121
  s_waitcnt lgkmcnt(9)
  v_mfma_f32_16x16x32_bf16 v[76:79], v[208:211], v[48:51], v[76:79]
  v_exp_f32 v123, v75
  v_add_u32 v23, 61440, v21
  ds_read_b128 a[56:59], v23 offset:4096
  buffer_load_dwordx4 a[100:103], v6, s[4:7], s44 offen offset:2048 sc1
  v_mfma_f32_16x16x32_bf16 v[80:83], v[212:215], v[48:51], v[80:83]
  v_fma_f32 v122, v122, s54, s54
  v_cvt_pk_bf16_f32 v116, v72, v73
  v_mfma_f32_16x16x32_bf16 v[84:87], v[216:219], v[48:51], v[84:87]
  v_rcp_f32 v122, v122
  v_add_u32 v23, s58, v4
  ds_read_b128 a[80:83], v23 offset:0
  s_waitcnt lgkmcnt(9)
  v_mfma_f32_16x16x32_bf16 v[76:79], v[220:223], v[52:55], v[76:79]
  v_fma_f32 v123, v123, s54, s54
  v_mfma_f32_16x16x32_bf16 v[80:83], v[224:227], v[52:55], v[80:83]
  v_rcp_f32 v123, v123
  ds_read_b128 a[84:87], v23 offset:1024
  buffer_load_dwordx4 a[104:107], v6, s[4:7], s45 offen offset:2048 sc1
  v_mfma_f32_16x16x32_bf16 v[84:87], v[228:231], v[52:55], v[84:87]
  v_mul_f32 v74, v74, v122
  s_waitcnt lgkmcnt(8)
  v_mfma_f32_16x16x32_bf16 v[76:79], v[232:235], v[56:59], v[76:79]
  ds_read_b128 a[88:91], v23 offset:2048
  v_mfma_f32_16x16x32_bf16 v[80:83], v[236:239], v[56:59], v[80:83]
  v_mul_f32 v75, v75, v123
  v_mfma_f32_16x16x32_bf16 v[84:87], v[240:243], v[56:59], v[84:87]
  s_waitcnt lgkmcnt(7)
  v_mfma_f32_16x16x32_bf16 v[76:79], v[244:247], v[60:63], v[76:79]
  v_cvt_pk_bf16_f32 v117, v74, v75
  v_mfma_f32_16x16x32_bf16 v[80:83], v[248:251], v[60:63], v[80:83]
  s_cmp_eq_u32 s23, 0
  s_cbranch_scc1 SLOW13
  buffer_store_dwordx4 v[112:115], v4, s[4:7], s52 offen
  buffer_store_dwordx2 v[116:117], v4, s[4:7], s53 offen
RET13:
  s_add_u32 s52, s52, 49152
  s_add_u32 s53, s53, 49152
  buffer_load_dword v3, v9, s[4:7], s27 offen sc1
  v_mfma_f32_16x16x32_bf16 v[84:87], v[252:255], v[60:63], v[84:87]
  s_waitcnt vmcnt(16)
  v_mfma_f32_16x16x32_bf16 v[40:43], a[156:159], v[124:127], 0
  v_mfma_f32_16x16x32_bf16 v[44:47], a[160:163], v[124:127], 0
  v_mfma_f32_16x16x32_bf16 v[48:51], a[164:167], v[124:127], 0
  v_add_u32 v23, 61440, v21
  v_lshl_add_u32 v22, v0, 3, s58
  v_mfma_f32_16x16x32_bf16 v[52:55], a[168:171], v[124:127], 0
  v_fma_f32 v112, v88, v37, v100
  v_fma_f32 v113, v89, v37, v101
  v_fma_f32 v114, v90, v37, v102
  v_fma_f32 v115, v91, v37, v103
  v_fma_f32 v116, v92, v37, v104
  v_mfma_f32_16x16x32_bf16 v[56:59], a[172:175], v[124:127], 0
  ds_write_b64 v22, v[10:11] offset:0
  s_waitcnt vmcnt(15)
  v_mfma_f32_16x16x32_bf16 v[40:43], a[176:179], v[128:131], v[40:43]
  v_fma_f32 v76, v76, v36, v112
  v_fma_f32 v77, v77, v36, v113
  v_fma_f32 v78, v78, v36, v114
  v_fma_f32 v79, v79, v36, v115
  v_fma_f32 v80, v80, v36, v116
  v_mfma_f32_16x16x32_bf16 v[44:47], a[180:183], v[128:131], v[44:47]
  v_exp_f32 v112, v76
  s_add_u32 s72, s24, 4
  s_waitcnt vmcnt(0)
  v_subrev_u32 v3, s72, v3
  v_cmp_gt_u32 vcc, 8, v3
  s_nop 3
  s_cmp_eq_u64 vcc, -1
  s_cbranch_scc0 SPIN14
PDONE14:
  ds_write_b64 v22, v[12:13] offset:512
  v_mfma_f32_16x16x32_bf16 v[48:51], a[184:187], v[128:131], v[48:51]
  v_fma_f32 v117, v93, v37, v105
  v_fma_f32 v118, v94, v37, v106
  v_fma_f32 v119, v95, v37, v107
  v_mfma_f32_16x16x32_bf16 v[52:55], a[188:191], v[128:131], v[52:55]
  v_exp_f32 v113, v77
  ds_write_b64 v22, v[14:15] offset:1024
  buffer_load_dwordx4 v[172:175], v4, s[4:7], s33 offen offset:0 sc1
  v_mfma_f32_16x16x32_bf16 v[56:59], a[192:195], v[128:131], v[56:59]
  v_fma_f32 v112, v112, s54, s54
  v_fma_f32 v81, v81, v36, v117
  v_fma_f32 v82, v82, v36, v118
  v_mfma_f32_16x16x32_bf16 v[40:43], a[196:199], v[132:135], v[40:43]
  v_rcp_f32 v112, v112
  ds_write_b64 v22, v[16:17] offset:1536
  buffer_load_dwordx4 v[176:179], v4, s[4:7], s33 offen offset:1024 sc1
  v_mfma_f32_16x16x32_bf16 v[44:47], a[200:203], v[132:135], v[44:47]
  v_fma_f32 v113, v113, s54, s54
  v_fma_f32 v83, v83, v36, v119
  v_fma_f32 v120, v96, v37, v108
  v_mfma_f32_16x16x32_bf16 v[48:51], a[204:207], v[132:135], v[48:51]
  v_rcp_f32 v113, v113
  buffer_load_dwordx4 v[180:183], v4, s[4:7], s33 offen offset:2048 sc1
  v_mfma_f32_16x16x32_bf16 v[52:55], a[208:211], v[132:135], v[52:55]
  v_fma_f32 v84, v84, v36, v120
  v_mul_f32 v76, v76, v112
  v_fma_f32 v121, v97, v37, v109
  v_mfma_f32_16x16x32_bf16 v[56:59], a[212:215], v[132:135], v[56:59]
  v_exp_f32 v114, v78
  s_add_u32 s72, s24, 5
  v_mov_b32 v3, s72
  s_cmp_eq_u32 s23, 0
  s_cbranch_scc1 SLOW15
  buffer_store_dword v3, off, s[4:7], s26
RET15:
  buffer_load_dwordx4 v[184:187], v4, s[4:7], s33 offen offset:3072 sc1
  v_mfma_f32_16x16x32_bf16 v[40:43], a[216:219], v[136:139], v[40:43]
  v_fma_f32 v85, v85, v36, v121
  v_mul_f32 v77, v77, v113
  v_fma_f32 v122, v98, v37, v110
  v_mfma_f32_16x16x32_bf16 v[44:47], a[220:223], v[136:139], v[44:47]
  v_exp_f32 v115, v79
  buffer_load_dwordx4 v[188:191], v5, s[4:7], s33 offen offset:0 sc1
  v_mfma_f32_16x16x32_bf16 v[48:51], a[224:227], v[136:139], v[48:51]
  v_fma_f32 v114, v114, s54, s54
  v_fma_f32 v86, v86, v36, v122
  v_cvt_pk_bf16_f32 v112, v76, v77
  v_mfma_f32_16x16x32_bf16 v[52:55], a[228:231], v[136:139], v[52:55]
  v_rcp_f32 v114, v114
  v_mfma_f32_16x16x32_bf16 v[56:59], a[232:235], v[136:139], v[56:59]
  v_fma_f32 v115, v115, s54, s54
  v_fma_f32 v123, v99, v37, v111
  v_mfma_f32_16x16x32_bf16 v[40:43], a[236:239], v[140:143], v[40:43]
  v_rcp_f32 v115, v115
  buffer_load_dwordx4 v[192:195], v5, s[4:7], s33 offen offset:1024 sc1
  v_mfma_f32_16x16x32_bf16 v[44:47], a[240:243], v[140:143], v[44:47]
  v_fma_f32 v87, v87, v36, v123
  v_mul_f32 v78, v78, v114
  v_mfma_f32_16x16x32_bf16 v[48:51], a[244:247], v[140:143], v[48:51]
  v_exp_f32 v116, v80
  buffer_load_dwordx4 v[196:199], v5, s[4:7], s33 offen offset:2048 sc1
  v_mfma_f32_16x16x32_bf16 v[52:55], a[248:251], v[140:143], v[52:55]
  v_mul_f32 v79, v79, v115
  v_mfma_f32_16x16x32_bf16 v[56:59], a[252:255], v[140:143], v[56:59]
  v_exp_f32 v117, v81
  buffer_load_dwordx4 v[200:203], v5, s[4:7], s33 offen offset:3072 sc1
  v_mfma_f32_16x16x32_bf16 v[40:43], a[0:3], v[144:147], v[40:43]
  v_fma_f32 v116, v116, s54, s54
  v_cvt_pk_bf16_f32 v113, v78, v79
  v_mfma_f32_16x16x32_bf16 v[44:47], a[4:7], v[144:147], v[44:47]
  v_rcp_f32 v116, v116
  buffer_load_dwordx4 v[204:207], v6, s[4:7], s33 offen offset:0 sc1
  v_mfma_f32_16x16x32_bf16 v[48:51], a[8:11], v[144:147], v[48:51]
  v_fma_f32 v117, v117, s54, s54
  v_mfma_f32_16x16x32_bf16 v[52:55], a[12:15], v[144:147], v[52:55]
  v_rcp_f32 v117, v117
  v_mfma_f32_16x16x32_bf16 v[56:59], a[16:19], v[144:147], v[56:59]
  v_mul_f32 v80, v80, v116
  v_mfma_f32_16x16x32_bf16 v[40:43], a[20:23], v[148:151], v[40:43]
  v_exp_f32 v118, v82
  buffer_load_dwordx4 a[108:111], v6, s[4:7], s46 offen offset:2048 sc1
  v_mfma_f32_16x16x32_bf16 v[44:47], a[24:27], v[148:151], v[44:47]
  v_mul_f32 v81, v81, v117
  v_mfma_f32_16x16x32_bf16 v[48:51], a[28:31], v[148:151], v[48:51]
  v_exp_f32 v119, v83
  buffer_load_dwordx4 a[112:115], v6, s[4:7], s47 offen offset:2048 sc1
  v_mfma_f32_16x16x32_bf16 v[52:55], a[32:35], v[148:151], v[52:55]
  v_fma_f32 v118, v118, s54, s54
  v_cvt_pk_bf16_f32 v114, v80, v81
  v_mfma_f32_16x16x32_bf16 v[56:59], a[36:39], v[148:151], v[56:59]
  v_rcp_f32 v118, v118
  v_mfma_f32_16x16x32_bf16 v[40:43], a[40:43], v[152:155], v[40:43]
  v_fma_f32 v119, v119, s54, s54
  v_mfma_f32_16x16x32_bf16 v[44:47], a[44:47], v[152:155], v[44:47]
  v_rcp_f32 v119, v119
  buffer_load_dwordx4 a[116:119], v6, s[4:7], s48 offen offset:2048 sc1
  v_mfma_f32_16x16x32_bf16 v[48:51], a[48:51], v[152:155], v[48:51]
  v_mul_f32 v82, v82, v118
  v_mfma_f32_16x16x32_bf16 v[52:55], a[52:55], v[152:155], v[52:55]
  v_exp_f32 v120, v84
  buffer_load_dwordx4 a[120:123], v6, s[4:7], s44 offen offset:3072 sc1
  s_waitcnt lgkmcnt(7)
  v_mfma_f32_16x16x32_bf16 v[56:59], a[56:59], v[152:155], v[56:59]
  v_mul_f32 v83, v83, v119
  v_mfma_f32_16x16x32_bf16 v[40:43], a[60:63], v[156:159], v[40:43]
  v_exp_f32 v121, v85
  v_mfma_f32_16x16x32_bf16 v[44:47], a[64:67], v[156:159], v[44:47]
  v_fma_f32 v120, v120, s54, s54
  v_cvt_pk_bf16_f32 v115, v82, v83
  v_mfma_f32_16x16x32_bf16 v[48:51], a[68:71], v[156:159], v[48:51]
  v_rcp_f32 v120, v120
  buffer_load_dwordx4 a[124:127], v6, s[4:7], s45 offen offset:3072 sc1
  v_mfma_f32_16x16x32_bf16 v[52:55], a[72:75], v[156:159], v[52:55]
  v_fma_f32 v121, v121, s54, s54
  v_mfma_f32_16x16x32_bf16 v[56:59], a[76:79], v[156:159], v[56:59]
  v_rcp_f32 v121, v121
  buffer_load_dwordx4 a[128:131], v6, s[4:7], s46 offen offset:3072 sc1
  s_waitcnt vmcnt(15)
  v_mfma_f32_16x16x32_bf16 v[60:63], a[156:159], v[172:175], 0
  v_mul_f32 v84, v84, v120
  v_mfma_f32_16x16x32_bf16 v[64:67], a[160:163], v[172:175], 0
  v_exp_f32 v122, v86
  v_mfma_f32_16x16x32_bf16 v[68:71], a[164:167], v[172:175], 0
  v_mul_f32 v85, v85, v121
  v_mfma_f32_16x16x32_bf16 v[72:75], a[168:171], v[172:175], 0
  v_exp_f32 v123, v87
  buffer_load_dword v3, v9, s[4:7], s27 offen sc1
  buffer_load_dwordx4 a[132:135], v6, s[4:7], s47 offen offset:3072 sc1
  v_mfma_f32_16x16x32_bf16 v[24:27], a[172:175], v[172:175], 0
  v_fma_f32 v122, v122, s54, s54
  v_cvt_pk_bf16_f32 v116, v84, v85
  s_waitcnt vmcnt(16)
  v_mfma_f32_16x16x32_bf16 v[60:63], a[176:179], v[176:179], v[60:63]
  v_rcp_f32 v122, v122
  buffer_load_dwordx4 a[136:139], v6, s[4:7], s48 offen offset:3072 sc1
  v_mfma_f32_16x16x32_bf16 v[64:67], a[180:183], v[176:179], v[64:67]
  v_fma_f32 v123, v123, s54, s54
  v_mfma_f32_16x16x32_bf16 v[68:71], a[184:187], v[176:179], v[68:71]
  v_rcp_f32 v123, v123
  v_mfma_f32_16x16x32_bf16 v[72:75], a[188:191], v[176:179], v[72:75]
  v_mul_f32 v86, v86, v122
  v_mfma_f32_16x16x32_bf16 v[24:27], a[192:195], v[176:179], v[24:27]
  buffer_load_dwordx4 v[160:163], v6, s[4:7], s32 offen offset:1024 sc1
  s_waitcnt vmcnt(17)
  v_mfma_f32_16x16x32_bf16 v[60:63], a[196:199], v[180:183], v[60:63]
  v_mul_f32 v87, v87, v123
  v_mfma_f32_16x16x32_bf16 v[64:67], a[200:203], v[180:183], v[64:67]
  buffer_load_dwordx4 v[164:167], v6, s[4:7], s32 offen offset:2048 sc1
  v_mfma_f32_16x16x32_bf16 v[68:71], a[204:207], v[180:183], v[68:71]
  v_cvt_pk_bf16_f32 v117, v86, v87
  v_mfma_f32_16x16x32_bf16 v[72:75], a[208:211], v[180:183], v[72:75]
  s_cmp_eq_u32 s23, 0
  s_cbranch_scc1 SLOW16
  buffer_store_dwordx4 v[112:115], v4, s[4:7], s52 offen
  buffer_store_dwordx2 v[116:117], v4, s[4:7], s53 offen
RET16:
  s_add_u32 s52, s52, 49152
  s_add_u32 s53, s53, 49152
  v_mfma_f32_16x16x32_bf16 v[24:27], a[212:215], v[180:183], v[24:27]
  s_waitcnt vmcnt(18)
  v_mfma_f32_16x16x32_bf16 v[60:63], a[216:219], v[184:187], v[60:63]
  s_add_u32 s72, s24, 5
  s_waitcnt vmcnt(6)
  v_subrev_u32 v3, s72, v3
  v_cmp_gt_u32 vcc, 8, v3
  s_nop 3
  s_cmp_eq_u64 vcc, -1
  s_cbranch_scc0 SPIN17
PDONE17:
  buffer_load_dwordx4 v[168:171], v6, s[4:7], s32 offen offset:3072 sc1
  v_mfma_f32_16x16x32_bf16 v[64:67], a[220:223], v[184:187], v[64:67]
  v_mfma_f32_16x16x32_bf16 v[68:71], a[224:227], v[184:187], v[68:71]
  buffer_load_dwordx4 v[208:211], v6, s[4:7], s33 offen offset:1024 sc1
  v_mfma_f32_16x16x32_bf16 v[72:75], a[228:231], v[184:187], v[72:75]
  v_mfma_f32_16x16x32_bf16 v[24:27], a[232:235], v[184:187], v[24:27]
  v_mfma_f32_16x16x32_bf16 v[60:63], a[236:239], v[188:191], v[60:63]
  v_mfma_f32_16x16x32_bf16 v[64:67], a[240:243], v[188:191], v[64:67]
  buffer_load_dwordx4 v[212:215], v6, s[4:7], s33 offen offset:2048 sc1
  v_mfma_f32_16x16x32_bf16 v[68:71], a[244:247], v[188:191], v[68:71]
  v_mfma_f32_16x16x32_bf16 v[72:75], a[248:251], v[188:191], v[72:75]
  buffer_load_dwordx4 v[216:219], v6, s[4:7], s33 offen offset:3072 sc1
  v_mfma_f32_16x16x32_bf16 v[24:27], a[252:255], v[188:191], v[24:27]
  v_mfma_f32_16x16x32_bf16 v[60:63], a[0:3], v[192:195], v[60:63]
  v_mfma_f32_16x16x32_bf16 v[64:67], a[4:7], v[192:195], v[64:67]
  v_mfma_f32_16x16x32_bf16 v[68:71], a[8:11], v[192:195], v[68:71]
  s_add_u32 s72, s24, 6
  v_mov_b32 v3, s72
  s_waitcnt vmcnt(4)
  s_cmp_eq_u32 s23, 0
  s_cbranch_scc1 SLOW18
  buffer_store_dword v3, off, s[4:7], s26
RET18:
  buffer_load_dwordx4 v[80:83], v4, s[4:7], s34 offen offset:0 sc1
  v_mfma_f32_16x16x32_bf16 v[72:75], a[12:15], v[192:195], v[72:75]
  v_mfma_f32_16x16x32_bf16 v[24:27], a[16:19], v[192:195], v[24:27]
  buffer_load_dwordx4 v[84:87], v4, s[4:7], s34 offen offset:1024 sc1
  v_mfma_f32_16x16x32_bf16 v[60:63], a[20:23], v[196:199], v[60:63]
  v_mfma_f32_16x16x32_bf16 v[64:67], a[24:27], v[196:199], v[64:67]
  buffer_load_dwordx4 v[88:91], v4, s[4:7], s34 offen offset:2048 sc1
  v_mfma_f32_16x16x32_bf16 v[68:71], a[28:31], v[196:199], v[68:71]
  v_mfma_f32_16x16x32_bf16 v[72:75], a[32:35], v[196:199], v[72:75]
  v_mfma_f32_16x16x32_bf16 v[24:27], a[36:39], v[196:199], v[24:27]
  v_mfma_f32_16x16x32_bf16 v[60:63], a[40:43], v[200:203], v[60:63]
  buffer_load_dwordx4 v[92:95], v4, s[4:7], s34 offen offset:3072 sc1
  v_mfma_f32_16x16x32_bf16 v[64:67], a[44:47], v[200:203], v[64:67]
  v_mfma_f32_16x16x32_bf16 v[68:71], a[48:51], v[200:203], v[68:71]
  buffer_load_dwordx4 v[96:99], v5, s[4:7], s34 offen offset:0 sc1
  v_mfma_f32_16x16x32_bf16 v[72:75], a[52:55], v[200:203], v[72:75]
  v_mfma_f32_16x16x32_bf16 v[24:27], a[56:59], v[200:203], v[24:27]
  buffer_load_dwordx4 v[100:103], v5, s[4:7], s34 offen offset:1024 sc1
  v_mfma_f32_16x16x32_bf16 v[60:63], a[60:63], v[204:207], v[60:63]
  v_mfma_f32_16x16x32_bf16 v[64:67], a[64:67], v[204:207], v[64:67]
  v_mfma_f32_16x16x32_bf16 v[68:71], a[68:71], v[204:207], v[68:71]
  v_mfma_f32_16x16x32_bf16 v[72:75], a[72:75], v[204:207], v[72:75]
  buffer_load_dwordx4 v[104:107], v5, s[4:7], s34 offen offset:2048 sc1
  v_mfma_f32_16x16x32_bf16 v[24:27], a[76:79], v[204:207], v[24:27]
  s_waitcnt lgkmcnt(6)
  v_mfma_f32_16x16x32_bf16 v[40:43], a[80:83], v[160:163], v[40:43]
  buffer_load_dwordx4 v[108:111], v5, s[4:7], s34 offen offset:3072 sc1
  s_waitcnt lgkmcnt(5)
  v_mfma_f32_16x16x32_bf16 v[44:47], a[84:87], v[160:163], v[44:47]
  s_waitcnt lgkmcnt(4)
  v_mfma_f32_16x16x32_bf16 v[48:51], a[88:91], v[160:163], v[48:51]
  buffer_load_dwordx4 v[112:115], v6, s[4:7], s34 offen offset:0 sc1
  v_mfma_f32_16x16x32_bf16 v[52:55], a[92:95], v[160:163], v[52:55]
  v_mfma_f32_16x16x32_bf16 v[56:59], a[96:99], v[160:163], v[56:59]
  v_mfma_f32_16x16x32_bf16 v[40:43], a[100:103], v[164:167], v[40:43]
  v_mfma_f32_16x16x32_bf16 v[44:47], a[104:107], v[164:167], v[44:47]
  buffer_load_dword v3, v9, s[4:7], s27 offen sc1
  buffer_load_dwordx4 v[116:119], v6, s[4:7], s34 offen offset:1024 sc1
  v_mfma_f32_16x16x32_bf16 v[48:51], a[108:111], v[164:167], v[48:51]
  v_mfma_f32_16x16x32_bf16 v[52:55], a[112:115], v[164:167], v[52:55]
  buffer_load_dwordx4 v[120:123], v6, s[4:7], s34 offen offset:2048 sc1
  v_mfma_f32_16x16x32_bf16 v[56:59], a[116:119], v[164:167], v[56:59]
  s_waitcnt vmcnt(16)
  v_mfma_f32_16x16x32_bf16 v[40:43], a[120:123], v[168:171], v[40:43]
  buffer_load_dwordx4 v[220:223], v6, s[4:7], s34 offen offset:3072 sc1
  v_mfma_f32_16x16x32_bf16 v[44:47], a[124:127], v[168:171], v[44:47]
  v_mfma_f32_16x16x32_bf16 v[48:51], a[128:131], v[168:171], v[48:51]
  v_mfma_f32_16x16x32_bf16 v[52:55], a[132:135], v[168:171], v[52:55]
  v_mfma_f32_16x16x32_bf16 v[56:59], a[136:139], v[168:171], v[56:59]
  s_waitcnt vmcnt(16)
  v_mfma_f32_16x16x32_bf16 v[60:63], a[80:83], v[208:211], v[60:63]
  v_mfma_f32_16x16x32_bf16 v[64:67], a[84:87], v[208:211], v[64:67]
  v_mfma_f32_16x16x32_bf16 v[68:71], a[88:91], v[208:211], v[68:71]
  v_mfma_f32_16x16x32_bf16 v[72:75], a[92:95], v[208:211], v[72:75]
  s_add_u32 s72, s24, 6
  s_waitcnt vmcnt(3)
  v_subrev_u32 v3, s72, v3
  v_cmp_gt_u32 vcc, 8, v3
  s_nop 3
  s_cmp_eq_u64 vcc, -1
  s_cbranch_scc0 SPIN19
PDONE19:
  ds_write_b128 v21, v[40:43] offset:0
  v_mfma_f32_16x16x32_bf16 v[24:27], a[96:99], v[208:211], v[24:27]
  v_mfma_f32_16x16x32_bf16 v[60:63], a[100:103], v[212:215], v[60:63]
  buffer_load_dwordx4 v[224:227], v4, s[4:7], s35 offen offset:0 sc1
  buffer_load_dwordx4 v[228:231], v4, s[4:7], s35 offen offset:1024 sc1
  ds_write_b128 v21, v[44:47] offset:1024
  v_mfma_f32_16x16x32_bf16 v[64:67], a[104:107], v[212:215], v[64:67]
  v_mfma_f32_16x16x32_bf16 v[68:71], a[108:111], v[212:215], v[68:71]
  buffer_load_dwordx4 v[232:235], v4, s[4:7], s35 offen offset:2048 sc1
  ds_write_b128 v21, v[48:51] offset:2048
  v_mfma_f32_16x16x32_bf16 v[72:75], a[112:115], v[212:215], v[72:75]
  v_mfma_f32_16x16x32_bf16 v[24:27], a[116:119], v[212:215], v[24:27]
  buffer_load_dwordx4 v[236:239], v4, s[4:7], s35 offen offset:3072 sc1
  ds_write_b128 v21, v[52:55] offset:3072
  v_mfma_f32_16x16x32_bf16 v[60:63], a[120:123], v[216:219], v[60:63]
  v_mfma_f32_16x16x32_bf16 v[64:67], a[124:127], v[216:219], v[64:67]
  buffer_load_dwordx4 v[240:243], v5, s[4:7], s35 offen offset:0 sc1
  buffer_load_dwordx4 v[244:247], v5, s[4:7], s35 offen offset:1024 sc1
  ds_write_b128 v21, v[56:59] offset:4096
  v_mfma_f32_16x16x32_bf16 v[68:71], a[128:131], v[216:219], v[68:71]
  v_mfma_f32_16x16x32_bf16 v[72:75], a[132:135], v[216:219], v[72:75]
  buffer_load_dwordx4 v[248:251], v5, s[4:7], s35 offen offset:2048 sc1
  v_mfma_f32_16x16x32_bf16 v[24:27], a[136:139], v[216:219], v[24:27]
  v_mfma_f32_16x16x32_bf16 v[40:43], a[156:159], v[80:83], 0
  buffer_load_dwordx4 v[252:255], v5, s[4:7], s35 offen offset:3072 sc1
  v_mfma_f32_16x16x32_bf16 v[44:47], a[160:163], v[80:83], 0
  s_lshl_b32 s3, s22, 10
  v_add_u32 v176, s3, v4
  v_add_u32 v177, 61440, v176
  v_mfma_f32_16x16x32_bf16 v[48:51], a[164:167], v[80:83], 0
  buffer_load_dwordx4 a[140:143], v6, s[4:7], s35 offen offset:0 sc1
  buffer_load_dwordx4 a[144:147], v6, s[4:7], s35 offen offset:1024 sc1
  v_mfma_f32_16x16x32_bf16 v[52:55], a[168:171], v[80:83], 0
  s_mul_i32 s49, s22, 20480
  s_add_u32 s3, s49, 4096
  v_add_u32 v178, s3, v4
  v_mfma_f32_16x16x32_bf16 v[56:59], a[172:175], v[80:83], 0
  buffer_load_dwordx4 a[148:151], v6, s[4:7], s35 offen offset:2048 sc1
  ds_write_b128 v21, v[60:63] offset:20480
  v_mfma_f32_16x16x32_bf16 v[40:43], a[176:179], v[84:87], v[40:43]
  s_lshl_b32 s3, s22, 9
  s_add_u32 s3, s3, 147456
  v_lshl_add_u32 v179, v0, 3, s3
  v_mfma_f32_16x16x32_bf16 v[44:47], a[180:183], v[84:87], v[44:47]
  buffer_load_dwordx4 a[152:155], v6, s[4:7], s35 offen offset:3072 sc1
  ds_write_b128 v21, v[64:67] offset:21504
  v_mfma_f32_16x16x32_bf16 v[48:51], a[184:187], v[84:87], v[48:51]
  s_lshl_b32 s3, s22, 6
  v_lshl_add_u32 v180, v2, 4, s3
  v_add_u32 v180, 162944, v180
  v_mfma_f32_16x16x32_bf16 v[52:55], a[188:191], v[84:87], v[52:55]
  v_mfma_f32_16x16x32_bf16 v[56:59], a[192:195], v[84:87], v[56:59]
  v_mul_u32_u24 v181, 1280, v1
  v_lshl_add_u32 v181, v2, 3, v181
  v_add_u32 v182, s49, v181
  v_mfma_f32_16x16x32_bf16 v[40:43], a[196:199], v[88:91], v[40:43]
  s_lshl2_add_u32 s3, s2, s22
  s_and_b32 s3, s3, 0x3e3
  s_cbranch_scc0 WBL
  buffer_load_dword v20, v9, s[4:7], s27 offen sc1
WBR:
  ds_write_b128 v21, v[68:71] offset:22528
  v_mfma_f32_16x16x32_bf16 v[44:47], a[200:203], v[88:91], v[44:47]
  s_lshl_b32 s3, s22, 5
  v_add_u32 v181, s3, v181
  s_mul_i32 s49, s20, 81920
  v_mfma_f32_16x16x32_bf16 v[48:51], a[204:207], v[88:91], v[48:51]
  ds_write_b128 v21, v[72:75] offset:23552
  v_mfma_f32_16x16x32_bf16 v[52:55], a[208:211], v[88:91], v[52:55]
  s_add_u32 s61, s61, s49
  v_lshlrev_b32 v183, 4, v2
  v_add_u32 v183, 163200, v183
  v_mfma_f32_16x16x32_bf16 v[56:59], a[212:215], v[88:91], v[56:59]
  v_mfma_f32_16x16x32_bf16 v[40:43], a[216:219], v[92:95], v[40:43]
  v_mfma_f32_16x16x32_bf16 v[44:47], a[220:223], v[92:95], v[44:47]
  ds_write_b128 v21, v[24:27] offset:24576
  v_mfma_f32_16x16x32_bf16 v[48:51], a[224:227], v[92:95], v[48:51]
  v_mfma_f32_16x16x32_bf16 v[52:55], a[228:231], v[92:95], v[52:55]
  v_mfma_f32_16x16x32_bf16 v[56:59], a[232:235], v[92:95], v[56:59]
  v_mfma_f32_16x16x32_bf16 v[40:43], a[236:239], v[96:99], v[40:43]
  v_mfma_f32_16x16x32_bf16 v[44:47], a[240:243], v[96:99], v[44:47]
  v_mfma_f32_16x16x32_bf16 v[48:51], a[244:247], v[96:99], v[48:51]
  v_mfma_f32_16x16x32_bf16 v[52:55], a[248:251], v[96:99], v[52:55]
  v_mfma_f32_16x16x32_bf16 v[56:59], a[252:255], v[96:99], v[56:59]
  s_waitcnt lgkmcnt(0)
  s_barrier
  v_mfma_f32_16x16x32_bf16 v[40:43], a[0:3], v[100:103], v[40:43]
  v_mfma_f32_16x16x32_bf16 v[44:47], a[4:7], v[100:103], v[44:47]
  ds_read_b128 v[168:171], v180
  ds_read_b128 v[172:175], v183
  ds_read_b64 v[156:157], v179 offset:0
  v_mfma_f32_16x16x32_bf16 v[48:51], a[8:11], v[100:103], v[48:51]
  v_mfma_f32_16x16x32_bf16 v[52:55], a[12:15], v[100:103], v[52:55]
  ds_read_b64 v[158:159], v179 offset:3072
  ds_read_b64 v[160:161], v179 offset:6144
  v_mfma_f32_16x16x32_bf16 v[56:59], a[16:19], v[100:103], v[56:59]
  v_mfma_f32_16x16x32_bf16 v[40:43], a[20:23], v[104:107], v[40:43]
  ds_read_b64 v[162:163], v179 offset:9216
  ds_read_b128 v[124:127], v176 offset:0
  v_mfma_f32_16x16x32_bf16 v[44:47], a[24:27], v[104:107], v[44:47]
  v_mfma_f32_16x16x32_bf16 v[48:51], a[28:31], v[104:107], v[48:51]
  ds_read_b128 v[128:131], v176 offset:5120
  ds_read_b128 v[132:135], v176 offset:10240
  ds_read_b128 v[136:139], v176 offset:15360
  v_mfma_f32_16x16x32_bf16 v[52:55], a[32:35], v[104:107], v[52:55]
  v_mfma_f32_16x16x32_bf16 v[56:59], a[36:39], v[104:107], v[56:59]
  ds_read_b128 v[140:143], v176 offset:20480
  ds_read_b128 v[144:147], v176 offset:25600
  v_mfma_f32_16x16x32_bf16 v[40:43], a[40:43], v[108:111], v[40:43]
  v_mfma_f32_16x16x32_bf16 v[44:47], a[44:47], v[108:111], v[44:47]
  ds_read_b128 v[148:151], v176 offset:30720
  ds_read_b128 v[152:155], v176 offset:35840
  v_mfma_f32_16x16x32_bf16 v[48:51], a[48:51], v[108:111], v[48:51]
  s_waitcnt lgkmcnt(11)
  v_lshlrev_b32 v164, 16, v156
  v_and_b32 v165, 0xffff0000, v156
  v_lshlrev_b32 v166, 16, v157
  v_mfma_f32_16x16x32_bf16 v[52:55], a[52:55], v[108:111], v[52:55]
  v_mfma_f32_16x16x32_bf16 v[56:59], a[56:59], v[108:111], v[56:59]
  v_and_b32 v167, 0xffff0000, v157
  s_waitcnt lgkmcnt(6)
  v_add_f32 v124, v124, v128
  v_add_f32 v125, v125, v129
  v_mfma_f32_16x16x32_bf16 v[40:43], a[60:63], v[112:115], v[40:43]
  v_mfma_f32_16x16x32_bf16 v[44:47], a[64:67], v[112:115], v[44:47]
  v_add_f32 v126, v126, v130
  v_add_f32 v127, v127, v131
  s_waitcnt lgkmcnt(4)
  v_add_f32 v132, v132, v136
  v_mfma_f32_16x16x32_bf16 v[48:51], a[68:71], v[112:115], v[48:51]
  v_mfma_f32_16x16x32_bf16 v[52:55], a[72:75], v[112:115], v[52:55]
  v_add_f32 v133, v133, v137
  v_add_f32 v134, v134, v138
  v_add_f32 v135, v135, v139
  v_mfma_f32_16x16x32_bf16 v[56:59], a[76:79], v[112:115], v[56:59]
  s_waitcnt vmcnt(15)
  v_mfma_f32_16x16x32_bf16 v[40:43], a[80:83], v[116:119], v[40:43]
  v_add_f32 v124, v124, v132
  v_add_f32 v125, v125, v133
  v_add_f32 v126, v126, v134
  v_mfma_f32_16x16x32_bf16 v[44:47], a[84:87], v[116:119], v[44:47]
  v_mfma_f32_16x16x32_bf16 v[48:51], a[88:91], v[116:119], v[48:51]
  v_add_f32 v127, v127, v135
  v_fma_f32 v124, v124, v168, v164
  v_fma_f32 v125, v125, v169, v165
  v_mfma_f32_16x16x32_bf16 v[52:55], a[92:95], v[116:119], v[52:55]
  v_mfma_f32_16x16x32_bf16 v[56:59], a[96:99], v[116:119], v[56:59]
  v_fma_f32 v126, v126, v170, v166
  v_fma_f32 v127, v127, v171, v167
  v_cvt_pk_bf16_f32 v188, v124, v125
  s_waitcnt vmcnt(14)
  v_mfma_f32_16x16x32_bf16 v[40:43], a[100:103], v[120:123], v[40:43]
  v_mfma_f32_16x16x32_bf16 v[44:47], a[104:107], v[120:123], v[44:47]
  v_cvt_pk_bf16_f32 v189, v126, v127
  v_lshlrev_b32 v164, 16, v158
  v_and_b32 v165, 0xffff0000, v158
  v_mfma_f32_16x16x32_bf16 v[48:51], a[108:111], v[120:123], v[48:51]
  v_mfma_f32_16x16x32_bf16 v[52:55], a[112:115], v[120:123], v[52:55]
  v_lshlrev_b32 v166, 16, v159
  v_and_b32 v167, 0xffff0000, v159
  s_waitcnt lgkmcnt(2)
  v_add_f32 v140, v140, v144
  v_mfma_f32_16x16x32_bf16 v[56:59], a[116:119], v[120:123], v[56:59]
  s_waitcnt vmcnt(13)
  v_mfma_f32_16x16x32_bf16 v[40:43], a[120:123], v[220:223], v[40:43]
  v_add_f32 v141, v141, v145
  v_add_f32 v142, v142, v146
  v_add_f32 v143, v143, v147
  v_mfma_f32_16x16x32_bf16 v[44:47], a[124:127], v[220:223], v[44:47]
  v_mfma_f32_16x16x32_bf16 v[48:51], a[128:131], v[220:223], v[48:51]
  s_waitcnt lgkmcnt(0)
  v_add_f32 v148, v148, v152
  v_add_f32 v149, v149, v153
  v_add_f32 v150, v150, v154
  v_mfma_f32_16x16x32_bf16 v[52:55], a[132:135], v[220:223], v[52:55]
  v_mfma_f32_16x16x32_bf16 v[56:59], a[136:139], v[220:223], v[56:59]
  v_add_f32 v151, v151, v155
  v_add_f32 v140, v140, v148
  v_add_f32 v141, v141, v149
  s_waitcnt vmcnt(12)
  v_mfma_f32_16x16x32_bf16 v[60:63], a[156:159], v[224:227], 0
  v_mfma_f32_16x16x32_bf16 v[64:67], a[160:163], v[224:227], 0
  v_add_f32 v142, v142, v150
  v_add_f32 v143, v143, v151
  v_fma_f32 v140, v140, v168, v164
  v_mfma_f32_16x16x32_bf16 v[68:71], a[164:167], v[224:227], 0
  v_mfma_f32_16x16x32_bf16 v[72:75], a[168:171], v[224:227], 0
  v_fma_f32 v141, v141, v169, v165
  v_fma_f32 v142, v142, v170, v166
  v_fma_f32 v143, v143, v171, v167
  v_mfma_f32_16x16x32_bf16 v[24:27], a[172:175], v[224:227], 0
  ds_write_b128 v21, v[40:43] offset:40960
  s_waitcnt vmcnt(11)
  v_mfma_f32_16x16x32_bf16 v[60:63], a[176:179], v[228:231], v[60:63]
  v_cvt_pk_bf16_f32 v190, v140, v141
  v_cvt_pk_bf16_f32 v191, v142, v143
  v_mfma_f32_16x16x32_bf16 v[64:67], a[180:183], v[228:231], v[64:67]
  ds_write_b128 v21, v[44:47] offset:41984
  v_mfma_f32_16x16x32_bf16 v[68:71], a[184:187], v[228:231], v[68:71]
  v_mfma_f32_16x16x32_bf16 v[72:75], a[188:191], v[228:231], v[72:75]
  v_mfma_f32_16x16x32_bf16 v[24:27], a[192:195], v[228:231], v[24:27]
  s_waitcnt vmcnt(10)
  v_mfma_f32_16x16x32_bf16 v[60:63], a[196:199], v[232:235], v[60:63]
  ds_write_b128 v21, v[48:51] offset:43008
  v_mfma_f32_16x16x32_bf16 v[64:67], a[200:203], v[232:235], v[64:67]
  v_mfma_f32_16x16x32_bf16 v[68:71], a[204:207], v[232:235], v[68:71]
  ds_write_b128 v21, v[52:55] offset:44032
  v_mfma_f32_16x16x32_bf16 v[72:75], a[208:211], v[232:235], v[72:75]
  v_mfma_f32_16x16x32_bf16 v[24:27], a[212:215], v[232:235], v[24:27]
  s_waitcnt vmcnt(9)
  v_mfma_f32_16x16x32_bf16 v[60:63], a[216:219], v[236:239], v[60:63]
  v_mfma_f32_16x16x32_bf16 v[64:67], a[220:223], v[236:239], v[64:67]
  ds_write_b128 v21, v[56:59] offset:45056
  v_mfma_f32_16x16x32_bf16 v[68:71], a[224:227], v[236:239], v[68:71]
  v_mfma_f32_16x16x32_bf16 v[72:75], a[228:231], v[236:239], v[72:75]
  v_mfma_f32_16x16x32_bf16 v[24:27], a[232:235], v[236:239], v[24:27]
  s_waitcnt vmcnt(8)
  v_mfma_f32_16x16x32_bf16 v[60:63], a[236:239], v[240:243], v[60:63]
  v_mfma_f32_16x16x32_bf16 v[64:67], a[240:243], v[240:243], v[64:67]
  v_mfma_f32_16x16x32_bf16 v[68:71], a[244:247], v[240:243], v[68:71]
  v_mfma_f32_16x16x32_bf16 v[72:75], a[248:251], v[240:243], v[72:75]
  v_mfma_f32_16x16x32_bf16 v[24:27], a[252:255], v[240:243], v[24:27]
  s_waitcnt lgkmcnt(0)
  s_barrier
  s_waitcnt vmcnt(7)
  v_mfma_f32_16x16x32_bf16 v[60:63], a[0:3], v[244:247], v[60:63]
  v_mfma_f32_16x16x32_bf16 v[64:67], a[4:7], v[244:247], v[64:67]
  ds_read_b128 v[124:127], v176 offset:40960
  ds_read_b128 v[128:131], v176 offset:46080
  v_mfma_f32_16x16x32_bf16 v[68:71], a[8:11], v[244:247], v[68:71]
  v_mfma_f32_16x16x32_bf16 v[72:75], a[12:15], v[244:247], v[72:75]
  ds_read_b128 v[132:135], v176 offset:51200
  ds_read_b128 v[136:139], v176 offset:56320
  v_mfma_f32_16x16x32_bf16 v[24:27], a[16:19], v[244:247], v[24:27]
  s_waitcnt vmcnt(6)
  v_mfma_f32_16x16x32_bf16 v[60:63], a[20:23], v[248:251], v[60:63]
  v_mfma_f32_16x16x32_bf16 v[64:67], a[24:27], v[248:251], v[64:67]
  v_mfma_f32_16x16x32_bf16 v[68:71], a[28:31], v[248:251], v[68:71]
  v_mfma_f32_16x16x32_bf16 v[72:75], a[32:35], v[248:251], v[72:75]
  v_lshlrev_b32 v164, 16, v160
  v_and_b32 v165, 0xffff0000, v160
  v_lshlrev_b32 v166, 16, v161
  v_mfma_f32_16x16x32_bf16 v[24:27], a[36:39], v[248:251], v[24:27]
  s_waitcnt vmcnt(5)
  v_mfma_f32_16x16x32_bf16 v[60:63], a[40:43], v[252:255], v[60:63]
  v_and_b32 v167, 0xffff0000, v161
  s_waitcnt lgkmcnt(2)
  v_add_f32 v124, v124, v128
  v_add_f32 v125, v125, v129
  v_mfma_f32_16x16x32_bf16 v[64:67], a[44:47], v[252:255], v[64:67]
  v_mfma_f32_16x16x32_bf16 v[68:71], a[48:51], v[252:255], v[68:71]
  v_add_f32 v126, v126, v130
  v_add_f32 v127, v127, v131
  s_waitcnt lgkmcnt(0)
  v_add_f32 v132, v132, v136
  v_mfma_f32_16x16x32_bf16 v[72:75], a[52:55], v[252:255], v[72:75]
  v_mfma_f32_16x16x32_bf16 v[24:27], a[56:59], v[252:255], v[24:27]
  v_add_f32 v133, v133, v137
  v_add_f32 v134, v134, v138
  v_add_f32 v135, v135, v139
  s_waitcnt vmcnt(4)
  v_mfma_f32_16x16x32_bf16 v[60:63], a[60:63], a[140:143], v[60:63]
  v_mfma_f32_16x16x32_bf16 v[64:67], a[64:67], a[140:143], v[64:67]
  v_add_f32 v124, v124, v132
  v_add_f32 v125, v125, v133
  v_add_f32 v126, v126, v134
  v_mfma_f32_16x16x32_bf16 v[68:71], a[68:71], a[140:143], v[68:71]
  v_mfma_f32_16x16x32_bf16 v[72:75], a[72:75], a[140:143], v[72:75]
  v_add_f32 v127, v127, v135
  v_fma_f32 v124, v124, v168, v164
  v_fma_f32 v125, v125, v169, v165
  v_mfma_f32_16x16x32_bf16 v[24:27], a[76:79], a[140:143], v[24:27]
  s_waitcnt vmcnt(3)
  v_mfma_f32_16x16x32_bf16 v[60:63], a[80:83], a[144:147], v[60:63]
  v_fma_f32 v126, v126, v170, v166
  v_fma_f32 v127, v127, v171, v167
  v_cvt_pk_bf16_f32 v192, v124, v125
  v_mfma_f32_16x16x32_bf16 v[64:67], a[84:87], a[144:147], v[64:67]
  v_mfma_f32_16x16x32_bf16 v[68:71], a[88:91], a[144:147], v[68:71]
  v_cvt_pk_bf16_f32 v193, v126, v127
  v_lshlrev_b32 v184, 16, v18
  v_and_b32 v185, 0xffff0000, v18
  v_mfma_f32_16x16x32_bf16 v[72:75], a[92:95], a[144:147], v[72:75]
  v_mfma_f32_16x16x32_bf16 v[24:27], a[96:99], a[144:147], v[24:27]
  v_lshlrev_b32 v186, 16, v19
  v_and_b32 v187, 0xffff0000, v19
  s_waitcnt vmcnt(2)
  v_mfma_f32_16x16x32_bf16 v[60:63], a[100:103], a[148:151], v[60:63]
  v_mfma_f32_16x16x32_bf16 v[64:67], a[104:107], a[148:151], v[64:67]
  v_mfma_f32_16x16x32_bf16 v[68:71], a[108:111], a[148:151], v[68:71]
  v_mfma_f32_16x16x32_bf16 v[72:75], a[112:115], a[148:151], v[72:75]
  v_mfma_f32_16x16x32_bf16 v[24:27], a[116:119], a[148:151], v[24:27]
  s_waitcnt vmcnt(1)
  v_mfma_f32_16x16x32_bf16 v[60:63], a[120:123], a[152:155], v[60:63]
  v_mfma_f32_16x16x32_bf16 v[64:67], a[124:127], a[152:155], v[64:67]
  v_mfma_f32_16x16x32_bf16 v[68:71], a[128:131], a[152:155], v[68:71]
  v_mfma_f32_16x16x32_bf16 v[72:75], a[132:135], a[152:155], v[72:75]
  v_mfma_f32_16x16x32_bf16 v[24:27], a[136:139], a[152:155], v[24:27]
  s_nop 3
  ds_write_b128 v23, v[60:63] offset:0
  ds_write_b128 v23, v[64:67] offset:1024
  ds_write_b128 v23, v[68:71] offset:2048
  ds_write_b128 v23, v[72:75] offset:3072
  ds_write_b128 v23, v[24:27] offset:4096
  s_add_u32 s3, s61, 0
  buffer_store_dwordx2 v[188:189], v181, s[16:19], s3 offen
  s_add_u32 s3, s61, 20480
  buffer_store_dwordx2 v[190:191], v181, s[16:19], s3 offen
  s_add_u32 s3, s61, 40960
  buffer_store_dwordx2 v[192:193], v181, s[16:19], s3 offen
  s_waitcnt lgkmcnt(0)
  s_barrier
  ds_read_b128 v[140:143], v177 offset:0
  ds_read_b128 v[144:147], v177 offset:5120
  ds_read_b128 v[148:151], v177 offset:10240
  ds_read_b128 v[152:155], v177 offset:15360
  ds_read_b128 v[124:127], v178 offset:0
  ds_read_b128 v[128:131], v178 offset:5120
  ds_read_b128 v[132:135], v178 offset:10240
  ds_read_b128 v[136:139], v178 offset:15360
  v_lshlrev_b32 v164, 16, v162
  v_and_b32 v165, 0xffff0000, v162
  v_lshlrev_b32 v166, 16, v163
  v_and_b32 v167, 0xffff0000, v163
  s_waitcnt lgkmcnt(6)
  v_add_f32 v140, v140, v144
  v_add_f32 v141, v141, v145
  v_add_f32 v142, v142, v146
  v_add_f32 v143, v143, v147
  s_waitcnt lgkmcnt(4)
  v_add_f32 v148, v148, v152
  v_add_f32 v149, v149, v153
  v_add_f32 v150, v150, v154
  v_add_f32 v151, v151, v155
  v_add_f32 v140, v140, v148
  v_add_f32 v141, v141, v149
  v_add_f32 v142, v142, v150
  v_add_f32 v143, v143, v151
  v_fma_f32 v140, v140, v168, v164
  v_fma_f32 v141, v141, v169, v165
  v_fma_f32 v142, v142, v170, v166
  v_fma_f32 v143, v143, v171, v167
  v_cvt_pk_bf16_f32 v194, v140, v141
  v_cvt_pk_bf16_f32 v195, v142, v143
  s_add_u32 s3, s61, 61440
  buffer_store_dwordx2 v[194:195], v181, s[16:19], s3 offen
  s_waitcnt lgkmcnt(2)
  v_add_f32 v124, v124, v128
  v_add_f32 v125, v125, v129
  v_add_f32 v126, v126, v130
  v_add_f32 v127, v127, v131
  s_waitcnt lgkmcnt(0)
  v_add_f32 v132, v132, v136
  v_add_f32 v133, v133, v137
  v_add_f32 v134, v134, v138
  v_add_f32 v135, v135, v139
  v_add_f32 v124, v124, v132
  v_add_f32 v125, v125, v133
  v_add_f32 v126, v126, v134
  v_add_f32 v127, v127, v135
  v_fma_f32 v124, v124, v172, v184
  v_fma_f32 v125, v125, v173, v185
  v_fma_f32 v126, v126, v174, v186
  v_fma_f32 v127, v127, v175, v187
  v_cvt_pk_bf16_f32 v196, v124, v125
  v_cvt_pk_bf16_f32 v197, v126, v127
  buffer_store_dwordx2 v[196:197], v182, s[16:19], s61 offen offset:128
EXIT_p0:
  s_endpgm
DEC_WO:
  s_sub_u32 s28, s2, 120
  s_and_b32 s29, s28, 1
  s_lshr_b32 s28, s28, 1
  s_mul_i32 s48, s29, 640
  s_mul_i32 s30, s28, 13108
  s_lshr_b32 s30, s30, 16
  s_mul_i32 s31, s30, 5
  s_sub_u32 s3, s28, s31
  s_lshl_b32 s3, s3, 2
  s_lshr_b32 s30, 0x47520, s3
  s_and_b32 s30, s30, 15
  s_lshl1_add_u32 s30, s31, s30
  s_lshr_b32 s3, 0x98631, s3
  s_and_b32 s3, s3, 15
  s_lshl1_add_u32 s31, s31, s3
  s_sub_u32 s31, s31, s30
  s_mul_i32 s31, s31, 20480
  s_lshl2_add_u32 s30, s30, s22
  s_mul_i32 s30, s30, 5120
  s_add_u32 s33, s30, s48
  v_bfe_u32 v3, v0, 3, 2
  s_movk_i32 s3, 1280
  v_mad_u32_u24 v33, v3, s3, v5
  v_lshrrev_b32 v3, 5, v0
  v_mad_u32_u24 v33, v3, s31, v33
  s_mov_b32 s70, 819200
  s_branch DEC_WO_RET
FRONT_B2:
  s_lshl_b32 s44, s44, 10
  s_lshl2_add_u32 s45, s45, s44
  s_add_u32 s45, s45, 16384
  s_lshl_b32 s3, s21, 2
  s_mov_b32 s50, 0x21043210
  s_movk_i32 s51, 0x1043
  s_lshr_b64 s[50:51], s[50:51], s3
  s_mov_b32 s73, s50
  s_lshl_b32 s3, s20, 6
  s_mul_i32 s79, s22, 20
  s_add_u32 s3, s3, s79
  s_sub_u32 s3, s3, 16
  s_movk_i32 s51, 1280
  v_add_u32 v244, s3, v2
  v_lshlrev_b32 v39, 4, v1
  s_mov_b32 s10, 2621440
  s_mov_b32 s11, 0x20000
  s_bfe_u32 s3, s73, 0x40000
  v_lshl_add_u32 v3, s3, 2, v244
  v_max_i32 v3, 0, v3
  v_mad_u32_u24 v240, v3, s51, v39
  s_bfe_u32 s3, s73, 0x40004
  v_lshl_add_u32 v3, s3, 2, v244
  v_max_i32 v3, 0, v3
  v_mad_u32_u24 v241, v3, s51, v39
  s_bfe_u32 s3, s73, 0x40008
  v_lshl_add_u32 v3, s3, 2, v244
  v_max_i32 v3, 0, v3
  v_mad_u32_u24 v242, v3, s51, v39
  s_bfe_u32 s3, s73, 0x4000c
  v_lshl_add_u32 v3, s3, 2, v244
  v_max_i32 v3, 0, v3
  v_mad_u32_u24 v243, v3, s51, v39
  s_bfe_u32 s3, s73, 0x40010
  v_lshl_add_u32 v3, s3, 2, v244
  v_max_i32 v3, 0, v3
  v_mad_u32_u24 v244, v3, s51, v39
  s_and_b32 s9, s9, 0xffff
  s_getpc_b64 s[50:51]
PCB:
  s_lshr_b32 s3, s2, 3
  s_lshl2_add_u32 s3, s3, s22
  s_mul_i32 s3, s3, 3
  v_min_u32 v237, 2, v0
  v_add_u32 v237, s3, v237
  v_min_u32 v237, (CODE_END-FRONT_A2-4)/128, v237
  v_lshlrev_b32 v237, 7, v237
  s_add_u32 s50, s50, FRONT_A2-PCB
  s_addc_u32 s51, s51, -1
  v_mov_b32 v239, s51
  v_add_co_u32 v238, vcc, s50, v237
  s_nop 1
  v_addc_co_u32 v239, vcc, 0, v239, vcc
  global_load_dword v237, v[238:239], off sc1
  s_lshl_b32 s47, s22, 13
  s_add_u32 s47, s47, 102400
  s_mov_b32 s71, 0x20000
  v_and_b32 v5, 7, v0
  v_lshlrev_b32 v5, 4, v5
  s_sub_u32 s28, s2, 160
  s_min_u32 s28, s28, 79
  s_and_b32 s29, s28, 3
  s_lshr_b32 s28, s28, 2
  s_mul_i32 s62, s29, 24
  s_add_u32 s62, s62, s22
  s_mul_i32 s62, s62, 20480
  s_lshl_b32 s3, s28, 10
  s_add_u32 s62, s62, s3
  s_add_u32 s62, s62, 5242880
  s_mul_i32 s48, s29, 768
  s_mul_i32 s30, s28, 13108
  s_lshr_b32 s30, s30, 16
  s_mul_i32 s31, s30, 5
  s_sub_u32 s3, s28, s31
  s_lshl_b32 s3, s3, 2
  s_lshr_b32 s30, 0x47520, s3
  s_and_b32 s30, s30, 15
  s_lshl1_add_u32 s30, s31, s30
  s_lshr_b32 s3, 0x98631, s3
  s_and_b32 s3, s3, 15
  s_lshl1_add_u32 s31, s31, s3
  s_sub_u32 s31, s31, s30
  s_mul_i32 s31, s31, 49152
  s_lshl2_add_u32 s30, s30, s22
  s_mul_i32 s30, s30, 12288
  s_add_u32 s33, s30, s48
  v_bfe_u32 v3, v0, 3, 2
  s_movk_i32 s3, 3072
  v_mad_u32_u24 v33, v3, s3, v5
  v_lshrrev_b32 v3, 5, v0
  v_mad_u32_u24 v33, v3, s31, v33
  s_mov_b32 s70, 1966080
  s_mov_b32 s18, 2621440
  s_mov_b32 s19, 0x20000
  s_and_b32 s17, s17, 0xffff
  v_lshlrev_b32 v4, 4, v0
  v_add_u32 v5, 4096, v4
  v_add_u32 v6, 8192, v4
  v_add_u32 v7, 12288, v4
  s_waitcnt vmcnt(11)
  v_lshlrev_b32 v28, 16, v28
  s_waitcnt vmcnt(10)
  v_lshlrev_b32 v29, 16, v29
  s_waitcnt vmcnt(9)
  v_lshlrev_b32 v30, 16, v30
  s_waitcnt vmcnt(8)
  v_lshlrev_b32 v31, 16, v31
  s_waitcnt vmcnt(7)
  v_lshlrev_b32 v32, 16, v32
  v_mul_f32 v246, 0xbfb8aa3b, v28
  v_mul_f32 v247, 0xbfb8aa3b, v29
  v_mul_f32 v248, 0xbfb8aa3b, v30
  v_mul_f32 v249, 0xbfb8aa3b, v31
  v_mul_f32 v250, 0xbfb8aa3b, v32
  v_exp_f32 v246, v246
  v_exp_f32 v247, v247
  v_exp_f32 v248, v248
  v_exp_f32 v249, v249
  v_exp_f32 v250, v250
  v_add_f32 v246, 1.0, v246
  v_add_f32 v247, 1.0, v247
  v_add_f32 v248, 1.0, v248
  v_add_f32 v249, 1.0, v249
  v_add_f32 v250, 1.0, v250
  v_rcp_f32 v246, v246
  v_rcp_f32 v247, v247
  v_rcp_f32 v248, v248
  v_rcp_f32 v249, v249
  v_rcp_f32 v250, v250
  v_mul_f32 v28, v28, v246
  v_mul_f32 v29, v29, v247
  v_mul_f32 v30, v30, v248
  v_mul_f32 v31, v31, v249
  v_mul_f32 v32, v32, v250
  v_cvt_pk_bf16_f32 v28, v28, 0
  v_cvt_pk_bf16_f32 v29, v29, 0
  v_cvt_pk_bf16_f32 v30, v30, 0
  v_cvt_pk_bf16_f32 v31, v31, 0
  v_cvt_pk_bf16_f32 v32, v32, 0
  v_lshlrev_b32 v37, 16, v28
  s_waitcnt vmcnt(6)
  v_dot2_f32_bf16 v246, v8, v28, 0
  v_dot2_f32_bf16 v247, v8, v37, 0
  v_dot2_f32_bf16 v248, v9, v28, 0
  v_dot2_f32_bf16 v249, v9, v37, 0
  v_dot2_f32_bf16 v250, v10, v28, 0
  v_dot2_f32_bf16 v251, v10, v37, 0
  v_dot2_f32_bf16 v252, v11, v28, 0
  v_dot2_f32_bf16 v253, v11, v37, 0
  v_lshlrev_b32 v37, 16, v29
  s_waitcnt vmcnt(5)
  v_dot2_f32_bf16 v246, v12, v29, v246
  v_dot2_f32_bf16 v247, v12, v37, v247
  v_dot2_f32_bf16 v248, v13, v29, v248
  v_dot2_f32_bf16 v249, v13, v37, v249
  v_dot2_f32_bf16 v250, v14, v29, v250
  v_dot2_f32_bf16 v251, v14, v37, v251
  v_dot2_f32_bf16 v252, v15, v29, v252
  v_dot2_f32_bf16 v253, v15, v37, v253
  v_lshlrev_b32 v37, 16, v30
  s_waitcnt vmcnt(4)
  v_dot2_f32_bf16 v246, v16, v30, v246
  v_dot2_f32_bf16 v247, v16, v37, v247
  v_dot2_f32_bf16 v248, v17, v30, v248
  v_dot2_f32_bf16 v249, v17, v37, v249
  v_dot2_f32_bf16 v250, v18, v30, v250
  v_dot2_f32_bf16 v251, v18, v37, v251
  v_dot2_f32_bf16 v252, v19, v30, v252
  v_dot2_f32_bf16 v253, v19, v37, v253
  buffer_load_dwordx4 v[44:47], v240, s[8:11], 0 offen offset:0
  buffer_load_dwordx4 v[52:55], v240, s[8:11], 0 offen offset:256
  buffer_load_dwordx4 v[60:63], v240, s[8:11], 0 offen offset:512
  buffer_load_dwordx4 v[68:71], v240, s[8:11], 0 offen offset:768
  buffer_load_dwordx4 v[76:79], v240, s[8:11], 0 offen offset:1024
  v_lshlrev_b32 v37, 16, v31
  s_waitcnt vmcnt(8)
  v_dot2_f32_bf16 v246, v20, v31, v246
  v_dot2_f32_bf16 v247, v20, v37, v247
  v_dot2_f32_bf16 v248, v21, v31, v248
  v_dot2_f32_bf16 v249, v21, v37, v249
  v_dot2_f32_bf16 v250, v22, v31, v250
  v_dot2_f32_bf16 v251, v22, v37, v251
  v_dot2_f32_bf16 v252, v23, v31, v252
  v_dot2_f32_bf16 v253, v23, v37, v253
  v_lshlrev_b32 v37, 16, v32
  s_waitcnt vmcnt(7)
  v_dot2_f32_bf16 v246, v24, v32, v246
  v_dot2_f32_bf16 v247, v24, v37, v247
  v_dot2_f32_bf16 v248, v25, v32, v248
  v_dot2_f32_bf16 v249, v25, v37, v249
  v_dot2_f32_bf16 v250, v26, v32, v250
  v_dot2_f32_bf16 v251, v26, v37, v251
  v_dot2_f32_bf16 v252, v27, v32, v252
  v_dot2_f32_bf16 v253, v27, v37, v253
  buffer_load_dwordx4 v[84:87], v241, s[8:11], 0 offen offset:0
  buffer_load_dwordx4 v[92:95], v241, s[8:11], 0 offen offset:256
  buffer_load_dwordx4 v[100:103], v241, s[8:11], 0 offen offset:512
  buffer_load_dwordx4 v[108:111], v241, s[8:11], 0 offen offset:768
  buffer_load_dwordx4 v[116:119], v241, s[8:11], 0 offen offset:1024
  v_and_b32 v37, 7, v0
  v_lshlrev_b32 v37, 5, v37
  v_lshl_add_u32 v37, v2, 3, v37
  v_permlane32_swap_b32 v246, v250
  v_permlane32_swap_b32 v247, v251
  v_permlane32_swap_b32 v248, v252
  v_permlane32_swap_b32 v249, v253
  v_add_f32 v246, v246, v250
  v_add_f32 v247, v247, v251
  v_add_f32 v248, v248, v252
  v_add_f32 v249, v249, v253
  s_lshl_b32 s44, s22, 8
  s_add_u32 s44, s44, 143360
  v_permlane16_swap_b32 v246, v248
  v_permlane16_swap_b32 v247, v249
  v_add_f32 v246, v246, v248
  v_add_f32 v247, v247, v249
  v_add_u32 v37, s44, v37
  v_lshlrev_b32 v252, 2, v0
  v_add_f32_dpp v246, v246, v246 row_ror:8 row_mask:0xf bank_mask:0xf
  v_add_f32_dpp v247, v247, v247 row_ror:8 row_mask:0xf bank_mask:0xf
  v_add_u32 v252, 143360, v252
  ds_write_b64 v37, v[246:247]
  s_waitcnt vmcnt(11)
  v_readfirstlane_b32 s24, v38
  s_add_u32 s24, s24, 0x9E3779B1
  s_waitcnt lgkmcnt(0)
  s_barrier
  ds_read2st64_b32 v[246:247], v252 offset0:0 offset1:1
  ds_read2st64_b32 v[248:249], v252 offset0:2 offset1:3
  s_cmp_eq_u32 s22, 0
  s_cselect_b32 s44, 0, 0x80000000
  v_or_b32 v253, s44, v4
  s_bfe_u32 s44, s24, 0xa0000
  s_movk_i32 s46, 0xfc00
  s_waitcnt lgkmcnt(1)
  v_add_f32 v246, v246, v247
  s_waitcnt lgkmcnt(0)
  v_add_f32 v248, v248, v249
  v_mov_b32 v251, s44
  v_add_f32 v246, v246, v248
  v_add_u32 v246, 0x200, v246
  v_and_or_b32 v246, v246, s46, v251
  buffer_store_dword v246, v253, s[4:7], s45 offen sc1
  s_waitcnt vmcnt(10)
  v_lshlrev_b32 v40, 16, v44
  buffer_load_dwordx4 v[124:127], v242, s[8:11], 0 offen offset:0
  v_and_b32 v41, 0xffff0000, v44
  v_lshlrev_b32 v42, 16, v45
  v_and_b32 v43, 0xffff0000, v45
  v_lshlrev_b32 v44, 16, v46
  v_and_b32 v45, 0xffff0000, v46
  v_lshlrev_b32 v46, 16, v47
  buffer_load_dwordx4 v[132:135], v242, s[8:11], 0 offen offset:256
  v_and_b32 v47, 0xffff0000, v47
  v_pk_mul_f32 v[252:253], v[40:41], v[40:41]
  v_pk_fma_f32 v[252:253], v[42:43], v[42:43], v[252:253]
  v_pk_add_f32 v[250:251], v[40:41], v[42:43]
  v_pk_fma_f32 v[252:253], v[44:45], v[44:45], v[252:253]
  v_pk_add_f32 v[250:251], v[250:251], v[44:45]
  buffer_load_dwordx4 v[140:143], v242, s[8:11], 0 offen offset:512
  v_pk_fma_f32 v[252:253], v[46:47], v[46:47], v[252:253]
  v_pk_add_f32 v[250:251], v[250:251], v[46:47]
  s_waitcnt vmcnt(12)
  v_lshlrev_b32 v48, 16, v52
  v_and_b32 v49, 0xffff0000, v52
  v_lshlrev_b32 v50, 16, v53
  v_and_b32 v51, 0xffff0000, v53
  buffer_load_dwordx4 v[148:151], v242, s[8:11], 0 offen offset:768
  v_lshlrev_b32 v52, 16, v54
  v_and_b32 v53, 0xffff0000, v54
  v_lshlrev_b32 v54, 16, v55
  v_and_b32 v55, 0xffff0000, v55
  v_pk_fma_f32 v[252:253], v[48:49], v[48:49], v[252:253]
  v_pk_add_f32 v[250:251], v[250:251], v[48:49]
  buffer_load_dwordx4 v[156:159], v242, s[8:11], 0 offen offset:1024
  v_pk_fma_f32 v[252:253], v[50:51], v[50:51], v[252:253]
  v_pk_add_f32 v[250:251], v[250:251], v[50:51]
  v_pk_fma_f32 v[252:253], v[52:53], v[52:53], v[252:253]
  v_pk_add_f32 v[250:251], v[250:251], v[52:53]
  v_pk_fma_f32 v[252:253], v[54:55], v[54:55], v[252:253]
  v_pk_add_f32 v[250:251], v[250:251], v[54:55]
  buffer_load_dwordx4 v[164:167], v243, s[8:11], 0 offen offset:0
  s_waitcnt vmcnt(14)
  v_lshlrev_b32 v56, 16, v60
  v_and_b32 v57, 0xffff0000, v60
  v_lshlrev_b32 v58, 16, v61
  v_and_b32 v59, 0xffff0000, v61
  v_lshlrev_b32 v60, 16, v62
  v_and_b32 v61, 0xffff0000, v62
  buffer_load_dwordx4 v[172:175], v243, s[8:11], 0 offen offset:256
  v_lshlrev_b32 v62, 16, v63
  v_and_b32 v63, 0xffff0000, v63
  v_pk_fma_f32 v[252:253], v[56:57], v[56:57], v[252:253]
  v_pk_add_f32 v[250:251], v[250:251], v[56:57]
  v_pk_fma_f32 v[252:253], v[58:59], v[58:59], v[252:253]
  v_pk_add_f32 v[250:251], v[250:251], v[58:59]
  buffer_load_dwordx4 v[180:183], v243, s[8:11], 0 offen offset:512
  v_pk_fma_f32 v[252:253], v[60:61], v[60:61], v[252:253]
  v_pk_add_f32 v[250:251], v[250:251], v[60:61]
  v_pk_fma_f32 v[252:253], v[62:63], v[62:63], v[252:253]
  v_pk_add_f32 v[250:251], v[250:251], v[62:63]
  s_waitcnt vmcnt(15)
  v_lshlrev_b32 v64, 16, v68
  v_and_b32 v65, 0xffff0000, v68
  buffer_load_dwordx4 v[188:191], v243, s[8:11], 0 offen offset:768
  v_lshlrev_b32 v66, 16, v69
  v_and_b32 v67, 0xffff0000, v69
  v_lshlrev_b32 v68, 16, v70
  v_and_b32 v69, 0xffff0000, v70
  v_lshlrev_b32 v70, 16, v71
  v_and_b32 v71, 0xffff0000, v71
  buffer_load_dwordx4 v[196:199], v243, s[8:11], 0 offen offset:1024
  v_pk_fma_f32 v[252:253], v[64:65], v[64:65], v[252:253]
  v_pk_add_f32 v[250:251], v[250:251], v[64:65]
  v_pk_fma_f32 v[252:253], v[66:67], v[66:67], v[252:253]
  v_pk_add_f32 v[250:251], v[250:251], v[66:67]
  v_pk_fma_f32 v[252:253], v[68:69], v[68:69], v[252:253]
  v_pk_add_f32 v[250:251], v[250:251], v[68:69]
  v_pk_fma_f32 v[252:253], v[70:71], v[70:71], v[252:253]
  v_pk_add_f32 v[250:251], v[250:251], v[70:71]
  s_waitcnt vmcnt(16)
  v_lshlrev_b32 v72, 16, v76
  v_and_b32 v73, 0xffff0000, v76
  v_lshlrev_b32 v74, 16, v77
  v_and_b32 v75, 0xffff0000, v77
  v_lshlrev_b32 v76, 16, v78
  v_and_b32 v77, 0xffff0000, v78
  v_lshlrev_b32 v78, 16, v79
  v_and_b32 v79, 0xffff0000, v79
  v_pk_fma_f32 v[252:253], v[72:73], v[72:73], v[252:253]
  v_pk_add_f32 v[250:251], v[250:251], v[72:73]
  v_pk_fma_f32 v[252:253], v[74:75], v[74:75], v[252:253]
  v_pk_add_f32 v[250:251], v[250:251], v[74:75]
  v_pk_fma_f32 v[252:253], v[76:77], v[76:77], v[252:253]
  v_pk_add_f32 v[250:251], v[250:251], v[76:77]
  v_pk_fma_f32 v[252:253], v[78:79], v[78:79], v[252:253]
  v_pk_add_f32 v[250:251], v[250:251], v[78:79]
  v_add_f32 v240, v250, v251
  v_add_f32 v241, v252, v253
  s_waitcnt vmcnt(15)
  v_lshlrev_b32 v80, 16, v84
  buffer_load_dwordx4 v[204:207], v244, s[8:11], 0 offen offset:0
  v_and_b32 v81, 0xffff0000, v84
  v_lshlrev_b32 v82, 16, v85
  v_and_b32 v83, 0xffff0000, v85
  v_lshlrev_b32 v84, 16, v86
  v_and_b32 v85, 0xffff0000, v86
  v_lshlrev_b32 v86, 16, v87
  v_and_b32 v87, 0xffff0000, v87
  v_pk_mul_f32 v[252:253], v[80:81], v[80:81]
  buffer_load_dwordx4 v[212:215], v244, s[8:11], 0 offen offset:256
  v_pk_fma_f32 v[252:253], v[82:83], v[82:83], v[252:253]
  v_pk_add_f32 v[250:251], v[80:81], v[82:83]
  v_pk_fma_f32 v[252:253], v[84:85], v[84:85], v[252:253]
  v_pk_add_f32 v[250:251], v[250:251], v[84:85]
  v_pk_fma_f32 v[252:253], v[86:87], v[86:87], v[252:253]
  v_pk_add_f32 v[250:251], v[250:251], v[86:87]
  s_waitcnt vmcnt(16)
  v_lshlrev_b32 v88, 16, v92
  v_and_b32 v89, 0xffff0000, v92
  buffer_load_dwordx4 v[220:223], v244, s[8:11], 0 offen offset:512
  v_lshlrev_b32 v90, 16, v93
  v_and_b32 v91, 0xffff0000, v93
  v_lshlrev_b32 v92, 16, v94
  v_and_b32 v93, 0xffff0000, v94
  v_lshlrev_b32 v94, 16, v95
  v_and_b32 v95, 0xffff0000, v95
  v_pk_fma_f32 v[252:253], v[88:89], v[88:89], v[252:253]
  v_pk_add_f32 v[250:251], v[250:251], v[88:89]
  buffer_load_dwordx4 v[228:231], v244, s[8:11], 0 offen offset:768
  v_pk_fma_f32 v[252:253], v[90:91], v[90:91], v[252:253]
  v_pk_add_f32 v[250:251], v[250:251], v[90:91]
  v_pk_fma_f32 v[252:253], v[92:93], v[92:93], v[252:253]
  v_pk_add_f32 v[250:251], v[250:251], v[92:93]
  v_pk_fma_f32 v[252:253], v[94:95], v[94:95], v[252:253]
  v_pk_add_f32 v[250:251], v[250:251], v[94:95]
  s_waitcnt vmcnt(17)
  v_lshlrev_b32 v96, 16, v100
  v_and_b32 v97, 0xffff0000, v100
  buffer_load_dwordx4 v[236:239], v244, s[8:11], 0 offen offset:1024
  v_lshlrev_b32 v98, 16, v101
  v_and_b32 v99, 0xffff0000, v101
  v_lshlrev_b32 v100, 16, v102
  v_and_b32 v101, 0xffff0000, v102
  v_lshlrev_b32 v102, 16, v103
  v_and_b32 v103, 0xffff0000, v103
  v_pk_fma_f32 v[252:253], v[96:97], v[96:97], v[252:253]
  v_pk_add_f32 v[250:251], v[250:251], v[96:97]
  v_pk_fma_f32 v[252:253], v[98:99], v[98:99], v[252:253]
  v_pk_add_f32 v[250:251], v[250:251], v[98:99]
  v_pk_fma_f32 v[252:253], v[100:101], v[100:101], v[252:253]
  v_pk_add_f32 v[250:251], v[250:251], v[100:101]
  v_pk_fma_f32 v[252:253], v[102:103], v[102:103], v[252:253]
  v_pk_add_f32 v[250:251], v[250:251], v[102:103]
  s_waitcnt vmcnt(17)
  v_lshlrev_b32 v104, 16, v108
  v_and_b32 v105, 0xffff0000, v108
  v_lshlrev_b32 v106, 16, v109
  v_and_b32 v107, 0xffff0000, v109
  v_lshlrev_b32 v108, 16, v110
  v_and_b32 v109, 0xffff0000, v110
  v_lshlrev_b32 v110, 16, v111
  v_and_b32 v111, 0xffff0000, v111
  v_pk_fma_f32 v[252:253], v[104:105], v[104:105], v[252:253]
  v_pk_add_f32 v[250:251], v[250:251], v[104:105]
  v_pk_fma_f32 v[252:253], v[106:107], v[106:107], v[252:253]
  v_pk_add_f32 v[250:251], v[250:251], v[106:107]
  v_pk_fma_f32 v[252:253], v[108:109], v[108:109], v[252:253]
  v_pk_add_f32 v[250:251], v[250:251], v[108:109]
  v_pk_fma_f32 v[252:253], v[110:111], v[110:111], v[252:253]
  v_pk_add_f32 v[250:251], v[250:251], v[110:111]
  s_waitcnt vmcnt(16)
  v_lshlrev_b32 v112, 16, v116
  v_and_b32 v113, 0xffff0000, v116
  v_lshlrev_b32 v114, 16, v117
  v_and_b32 v115, 0xffff0000, v117
  v_lshlrev_b32 v116, 16, v118
  v_and_b32 v117, 0xffff0000, v118
  v_lshlrev_b32 v118, 16, v119
  v_and_b32 v119, 0xffff0000, v119
  v_pk_fma_f32 v[252:253], v[112:113], v[112:113], v[252:253]
  v_pk_add_f32 v[250:251], v[250:251], v[112:113]
  v_pk_fma_f32 v[252:253], v[114:115], v[114:115], v[252:253]
  v_pk_add_f32 v[250:251], v[250:251], v[114:115]
  v_pk_fma_f32 v[252:253], v[116:117], v[116:117], v[252:253]
  v_pk_add_f32 v[250:251], v[250:251], v[116:117]
  v_pk_fma_f32 v[252:253], v[118:119], v[118:119], v[252:253]
  v_pk_add_f32 v[250:251], v[250:251], v[118:119]
  v_add_f32 v242, v250, v251
  v_add_f32 v243, v252, v253
  v_min_u32 v31, 59, v0
  s_mul_i32 s3, s22, 240
  v_lshl_add_u32 v31, v31, 2, s3
  s_lshr_b32 s50, s21, 2
  s_mul_i32 s50, s50, 960
  s_add_u32 s50, s50, 299008
  s_mul_i32 s49, s22, 5120
  s_add_u32 s49, s49, 16384
  s_min_u32 s52, s2, 239
  s_mul_i32 s28, s52, 13108
  s_lshr_b32 s28, s28, 16
  s_mul_i32 s53, s28, 5
  s_sub_u32 s52, s52, s53
  s_lshl3_add_u32 s63, s52, s22
  s_mul_i32 s63, s63, 49152
  s_lshl_b32 s53, s28, 10
  s_add_u32 s63, s63, s53
  s_add_u32 s63, s63, 7340032
  s_lshl_b32 s52, s52, 8
  v_and_b32 v34, 7, v0
  v_lshlrev_b32 v34, 4, v34
  s_mul_i32 s53, s28, 10923
  s_lshr_b32 s53, s53, 16
  s_mul_i32 s55, s53, 6
  s_sub_u32 s3, s28, s55
  s_lshl_b32 s3, s3, 2
  s_lshr_b32 s53, 0x829630, s3
  s_and_b32 s53, s53, 15
  s_lshl1_add_u32 s53, s55, s53
  s_lshr_b32 s3, 0xb5a741, s3
  s_and_b32 s3, s3, 15
  s_lshl1_add_u32 s55, s55, s3
  s_sub_u32 s55, s55, s53
  s_mul_i32 s55, s55, 20480
  s_lshl2_add_u32 s53, s53, s22
  s_mul_i32 s53, s53, 5120
  s_add_u32 s52, s53, s52
  v_bfe_u32 v3, v0, 3, 2
  s_movk_i32 s3, 1280
  v_mad_u32_u24 v34, v3, s3, v34
  v_lshrrev_b32 v3, 5, v0
  v_mad_u32_u24 v34, v3, s55, v34
  s_mov_b32 s66, 1966080
  s_mov_b32 s67, 0x20000
  s_and_b32 s65, s65, 0xffff
  s_lshl_b32 s53, s22, 11
  s_add_u32 s53, s53, 135168
  s_lshl3_add_u32 s61, s20, s21
  s_and_b32 s3, s22, 1
  s_lshl1_add_u32 s61, s61, s3
  s_mul_i32 s61, s61, 6144
  s_lshr_b32 s3, s22, 1
  s_mul_i32 s3, s3, 3145728
  s_add_u32 s61, s61, s3
  s_add_u32 s61, s61, 9437184
  s_mul_i32 s3, s22, 1280
  s_add_u32 s3, s3, 147456
  v_lshl_add_u32 v30, v0, 2, s3
  s_cmp_ge_u32 s22, 2
  s_cselect_b32 s51, 1.0, 0
  s_mov_b32 s48, s24
  s_waitcnt vmcnt(14)
  v_lshlrev_b32 v120, 16, v124
  s_and_b32 s69, s69, 0xffff
  v_and_b32 v121, 0xffff0000, v124
  v_lshlrev_b32 v122, 16, v125
  v_and_b32 v123, 0xffff0000, v125
  v_lshlrev_b32 v124, 16, v126
  v_and_b32 v125, 0xffff0000, v126
  v_lshlrev_b32 v126, 16, v127
  v_and_b32 v127, 0xffff0000, v127
  v_pk_mul_f32 v[252:253], v[120:121], v[120:121]
  s_add_u32 m0, s47, 0
  s_nop 0
  buffer_load_dwordx4 v33, s[68:71], s33 offen offset:0 nt lds
  v_pk_fma_f32 v[252:253], v[122:123], v[122:123], v[252:253]
  v_pk_add_f32 v[250:251], v[120:121], v[122:123]
  v_pk_fma_f32 v[252:253], v[124:125], v[124:125], v[252:253]
  v_pk_add_f32 v[250:251], v[250:251], v[124:125]
  v_pk_fma_f32 v[252:253], v[126:127], v[126:127], v[252:253]
  v_pk_add_f32 v[250:251], v[250:251], v[126:127]
  s_waitcnt vmcnt(14)
  v_lshlrev_b32 v128, 16, v132
  v_and_b32 v129, 0xffff0000, v132
  s_add_u32 m0, s47, 896
  s_nop 0
  buffer_load_dwordx4 v33, s[68:71], s33 offen offset:128 nt lds
  v_lshlrev_b32 v130, 16, v133
  v_and_b32 v131, 0xffff0000, v133
  v_lshlrev_b32 v132, 16, v134
  v_and_b32 v133, 0xffff0000, v134
  v_lshlrev_b32 v134, 16, v135
  v_and_b32 v135, 0xffff0000, v135
  v_pk_fma_f32 v[252:253], v[128:129], v[128:129], v[252:253]
  v_pk_add_f32 v[250:251], v[250:251], v[128:129]
  s_add_u32 m0, s47, 1792
  s_nop 0
  buffer_load_dwordx4 v33, s[68:71], s33 offen offset:256 nt lds
  v_pk_fma_f32 v[252:253], v[130:131], v[130:131], v[252:253]
  v_pk_add_f32 v[250:251], v[250:251], v[130:131]
  v_pk_fma_f32 v[252:253], v[132:133], v[132:133], v[252:253]
  v_pk_add_f32 v[250:251], v[250:251], v[132:133]
  v_pk_fma_f32 v[252:253], v[134:135], v[134:135], v[252:253]
  v_pk_add_f32 v[250:251], v[250:251], v[134:135]
  s_waitcnt vmcnt(15)
  v_lshlrev_b32 v136, 16, v140
  v_and_b32 v137, 0xffff0000, v140
  s_add_u32 m0, s47, 2688
  s_nop 0
  buffer_load_dwordx4 v33, s[68:71], s33 offen offset:384 nt lds
  v_lshlrev_b32 v138, 16, v141
  v_and_b32 v139, 0xffff0000, v141
  v_lshlrev_b32 v140, 16, v142
  v_and_b32 v141, 0xffff0000, v142
  v_lshlrev_b32 v142, 16, v143
  v_and_b32 v143, 0xffff0000, v143
  v_pk_fma_f32 v[252:253], v[136:137], v[136:137], v[252:253]
  v_pk_add_f32 v[250:251], v[250:251], v[136:137]
  s_add_u32 m0, s47, 3584
  s_nop 0
  buffer_load_dwordx4 v33, s[68:71], s33 offen offset:512 nt lds
  v_pk_fma_f32 v[252:253], v[138:139], v[138:139], v[252:253]
  v_pk_add_f32 v[250:251], v[250:251], v[138:139]
  v_pk_fma_f32 v[252:253], v[140:141], v[140:141], v[252:253]
  v_pk_add_f32 v[250:251], v[250:251], v[140:141]
  v_pk_fma_f32 v[252:253], v[142:143], v[142:143], v[252:253]
  v_pk_add_f32 v[250:251], v[250:251], v[142:143]
  s_waitcnt vmcnt(16)
  v_lshlrev_b32 v144, 16, v148
  v_and_b32 v145, 0xffff0000, v148
  s_add_u32 m0, s47, 4480
  s_nop 0
  buffer_load_dwordx4 v33, s[68:71], s33 offen offset:640 nt lds
  v_lshlrev_b32 v146, 16, v149
  v_and_b32 v147, 0xffff0000, v149
  v_lshlrev_b32 v148, 16, v150
  v_and_b32 v149, 0xffff0000, v150
  v_lshlrev_b32 v150, 16, v151
  v_and_b32 v151, 0xffff0000, v151
  v_pk_fma_f32 v[252:253], v[144:145], v[144:145], v[252:253]
  v_pk_add_f32 v[250:251], v[250:251], v[144:145]
  s_add_u32 m0, s53, 0
  s_nop 0
  buffer_load_dwordx4 v34, s[64:67], s52 offen offset:0 nt lds
  v_pk_fma_f32 v[252:253], v[146:147], v[146:147], v[252:253]
  v_pk_add_f32 v[250:251], v[250:251], v[146:147]
  v_pk_fma_f32 v[252:253], v[148:149], v[148:149], v[252:253]
  v_pk_add_f32 v[250:251], v[250:251], v[148:149]
  v_pk_fma_f32 v[252:253], v[150:151], v[150:151], v[252:253]
  v_pk_add_f32 v[250:251], v[250:251], v[150:151]
  s_waitcnt vmcnt(17)
  v_lshlrev_b32 v152, 16, v156
  v_and_b32 v153, 0xffff0000, v156
  s_add_u32 m0, s53, 896
  s_nop 0
  buffer_load_dwordx4 v34, s[64:67], s52 offen offset:128 nt lds
  v_lshlrev_b32 v154, 16, v157
  v_and_b32 v155, 0xffff0000, v157
  v_lshlrev_b32 v156, 16, v158
  v_and_b32 v157, 0xffff0000, v158
  v_lshlrev_b32 v158, 16, v159
  v_and_b32 v159, 0xffff0000, v159
  v_pk_fma_f32 v[252:253], v[152:153], v[152:153], v[252:253]
  v_pk_add_f32 v[250:251], v[250:251], v[152:153]
  v_pk_fma_f32 v[252:253], v[154:155], v[154:155], v[252:253]
  v_pk_add_f32 v[250:251], v[250:251], v[154:155]
  v_pk_fma_f32 v[252:253], v[156:157], v[156:157], v[252:253]
  v_pk_add_f32 v[250:251], v[250:251], v[156:157]
  v_pk_fma_f32 v[252:253], v[158:159], v[158:159], v[252:253]
  v_pk_add_f32 v[250:251], v[250:251], v[158:159]
  v_add_f32 v244, v250, v251
  v_add_f32 v245, v252, v253
  s_waitcnt vmcnt(17)
  v_lshlrev_b32 v160, 16, v164
  v_and_b32 v161, 0xffff0000, v164
  v_lshlrev_b32 v162, 16, v165
  v_and_b32 v163, 0xffff0000, v165
  v_lshlrev_b32 v164, 16, v166
  v_and_b32 v165, 0xffff0000, v166
  v_lshlrev_b32 v166, 16, v167
  v_and_b32 v167, 0xffff0000, v167
  v_pk_mul_f32 v[252:253], v[160:161], v[160:161]
  v_pk_fma_f32 v[252:253], v[162:163], v[162:163], v[252:253]
  v_pk_add_f32 v[250:251], v[160:161], v[162:163]
  v_pk_fma_f32 v[252:253], v[164:165], v[164:165], v[252:253]
  v_pk_add_f32 v[250:251], v[250:251], v[164:165]
  v_pk_fma_f32 v[252:253], v[166:167], v[166:167], v[252:253]
  v_pk_add_f32 v[250:251], v[250:251], v[166:167]
  s_waitcnt vmcnt(16)
  v_lshlrev_b32 v168, 16, v172
  v_and_b32 v169, 0xffff0000, v172
  v_lshlrev_b32 v170, 16, v173
  v_and_b32 v171, 0xffff0000, v173
  v_lshlrev_b32 v172, 16, v174
  v_and_b32 v173, 0xffff0000, v174
  v_lshlrev_b32 v174, 16, v175
  v_and_b32 v175, 0xffff0000, v175
  v_pk_fma_f32 v[252:253], v[168:169], v[168:169], v[252:253]
  v_pk_add_f32 v[250:251], v[250:251], v[168:169]
  v_pk_fma_f32 v[252:253], v[170:171], v[170:171], v[252:253]
  v_pk_add_f32 v[250:251], v[250:251], v[170:171]
  v_pk_fma_f32 v[252:253], v[172:173], v[172:173], v[252:253]
  v_pk_add_f32 v[250:251], v[250:251], v[172:173]
  v_pk_fma_f32 v[252:253], v[174:175], v[174:175], v[252:253]
  v_pk_add_f32 v[250:251], v[250:251], v[174:175]
  s_waitcnt vmcnt(15)
  v_lshlrev_b32 v176, 16, v180
  v_and_b32 v177, 0xffff0000, v180
  v_lshlrev_b32 v178, 16, v181
  v_and_b32 v179, 0xffff0000, v181
  v_lshlrev_b32 v180, 16, v182
  v_and_b32 v181, 0xffff0000, v182
  v_lshlrev_b32 v182, 16, v183
  v_and_b32 v183, 0xffff0000, v183
  v_pk_fma_f32 v[252:253], v[176:177], v[176:177], v[252:253]
  v_pk_add_f32 v[250:251], v[250:251], v[176:177]
  v_pk_fma_f32 v[252:253], v[178:179], v[178:179], v[252:253]
  v_pk_add_f32 v[250:251], v[250:251], v[178:179]
  v_pk_fma_f32 v[252:253], v[180:181], v[180:181], v[252:253]
  v_pk_add_f32 v[250:251], v[250:251], v[180:181]
  v_pk_fma_f32 v[252:253], v[182:183], v[182:183], v[252:253]
  v_pk_add_f32 v[250:251], v[250:251], v[182:183]
  s_waitcnt vmcnt(14)
  v_lshlrev_b32 v184, 16, v188
  v_and_b32 v185, 0xffff0000, v188
  v_lshlrev_b32 v186, 16, v189
  v_and_b32 v187, 0xffff0000, v189
  v_lshlrev_b32 v188, 16, v190
  v_and_b32 v189, 0xffff0000, v190
  v_lshlrev_b32 v190, 16, v191
  v_and_b32 v191, 0xffff0000, v191
  v_pk_fma_f32 v[252:253], v[184:185], v[184:185], v[252:253]
  v_pk_add_f32 v[250:251], v[250:251], v[184:185]
  v_pk_fma_f32 v[252:253], v[186:187], v[186:187], v[252:253]
  v_pk_add_f32 v[250:251], v[250:251], v[186:187]
  v_pk_fma_f32 v[252:253], v[188:189], v[188:189], v[252:253]
  v_pk_add_f32 v[250:251], v[250:251], v[188:189]
  v_pk_fma_f32 v[252:253], v[190:191], v[190:191], v[252:253]
  v_pk_add_f32 v[250:251], v[250:251], v[190:191]
  s_waitcnt vmcnt(13)
  v_lshlrev_b32 v192, 16, v196
  v_and_b32 v193, 0xffff0000, v196
  v_lshlrev_b32 v194, 16, v197
  v_and_b32 v195, 0xffff0000, v197
  v_lshlrev_b32 v196, 16, v198
  v_and_b32 v197, 0xffff0000, v198
  v_lshlrev_b32 v198, 16, v199
  v_and_b32 v199, 0xffff0000, v199
  v_pk_fma_f32 v[252:253], v[192:193], v[192:193], v[252:253]
  v_pk_add_f32 v[250:251], v[250:251], v[192:193]
  v_pk_fma_f32 v[252:253], v[194:195], v[194:195], v[252:253]
  v_pk_add_f32 v[250:251], v[250:251], v[194:195]
  v_pk_fma_f32 v[252:253], v[196:197], v[196:197], v[252:253]
  v_pk_add_f32 v[250:251], v[250:251], v[196:197]
  v_pk_fma_f32 v[252:253], v[198:199], v[198:199], v[252:253]
  v_pk_add_f32 v[250:251], v[250:251], v[198:199]
  v_add_f32 v246, v250, v251
  v_add_f32 v247, v252, v253
  s_waitcnt vmcnt(12)
  v_lshlrev_b32 v200, 16, v204
  v_and_b32 v201, 0xffff0000, v204
  v_lshlrev_b32 v202, 16, v205
  v_and_b32 v203, 0xffff0000, v205
  v_lshlrev_b32 v204, 16, v206
  v_and_b32 v205, 0xffff0000, v206
  v_lshlrev_b32 v206, 16, v207
  v_and_b32 v207, 0xffff0000, v207
  v_pk_mul_f32 v[252:253], v[200:201], v[200:201]
  v_pk_fma_f32 v[252:253], v[202:203], v[202:203], v[252:253]
  v_pk_add_f32 v[250:251], v[200:201], v[202:203]
  v_pk_fma_f32 v[252:253], v[204:205], v[204:205], v[252:253]
  v_pk_add_f32 v[250:251], v[250:251], v[204:205]
  v_pk_fma_f32 v[252:253], v[206:207], v[206:207], v[252:253]
  v_pk_add_f32 v[250:251], v[250:251], v[206:207]
  s_waitcnt vmcnt(11)
  v_lshlrev_b32 v208, 16, v212
  v_and_b32 v209, 0xffff0000, v212
  v_lshlrev_b32 v210, 16, v213
  v_and_b32 v211, 0xffff0000, v213
  v_lshlrev_b32 v212, 16, v214
  v_and_b32 v213, 0xffff0000, v214
  v_lshlrev_b32 v214, 16, v215
  v_and_b32 v215, 0xffff0000, v215
  v_pk_fma_f32 v[252:253], v[208:209], v[208:209], v[252:253]
  v_pk_add_f32 v[250:251], v[250:251], v[208:209]
  v_pk_fma_f32 v[252:253], v[210:211], v[210:211], v[252:253]
  v_pk_add_f32 v[250:251], v[250:251], v[210:211]
  v_pk_fma_f32 v[252:253], v[212:213], v[212:213], v[252:253]
  v_pk_add_f32 v[250:251], v[250:251], v[212:213]
  v_pk_fma_f32 v[252:253], v[214:215], v[214:215], v[252:253]
  v_pk_add_f32 v[250:251], v[250:251], v[214:215]
  s_waitcnt vmcnt(10)
  v_lshlrev_b32 v216, 16, v220
  v_and_b32 v217, 0xffff0000, v220
  v_lshlrev_b32 v218, 16, v221
  v_and_b32 v219, 0xffff0000, v221
  v_lshlrev_b32 v220, 16, v222
  v_and_b32 v221, 0xffff0000, v222
  v_lshlrev_b32 v222, 16, v223
  v_and_b32 v223, 0xffff0000, v223
  v_pk_fma_f32 v[252:253], v[216:217], v[216:217], v[252:253]
  v_pk_add_f32 v[250:251], v[250:251], v[216:217]
  v_pk_fma_f32 v[252:253], v[218:219], v[218:219], v[252:253]
  v_pk_add_f32 v[250:251], v[250:251], v[218:219]
  v_pk_fma_f32 v[252:253], v[220:221], v[220:221], v[252:253]
  v_pk_add_f32 v[250:251], v[250:251], v[220:221]
  v_pk_fma_f32 v[252:253], v[222:223], v[222:223], v[252:253]
  v_pk_add_f32 v[250:251], v[250:251], v[222:223]
  s_waitcnt vmcnt(9)
  v_lshlrev_b32 v224, 16, v228
  v_and_b32 v225, 0xffff0000, v228
  v_lshlrev_b32 v226, 16, v229
  v_and_b32 v227, 0xffff0000, v229
  v_lshlrev_b32 v228, 16, v230
  v_and_b32 v229, 0xffff0000, v230
  v_lshlrev_b32 v230, 16, v231
  v_and_b32 v231, 0xffff0000, v231
  v_pk_fma_f32 v[252:253], v[224:225], v[224:225], v[252:253]
  v_pk_add_f32 v[250:251], v[250:251], v[224:225]
  v_pk_fma_f32 v[252:253], v[226:227], v[226:227], v[252:253]
  v_pk_add_f32 v[250:251], v[250:251], v[226:227]
  v_pk_fma_f32 v[252:253], v[228:229], v[228:229], v[252:253]
  v_pk_add_f32 v[250:251], v[250:251], v[228:229]
  v_pk_fma_f32 v[252:253], v[230:231], v[230:231], v[252:253]
  v_pk_add_f32 v[250:251], v[250:251], v[230:231]
  s_waitcnt vmcnt(8)
  v_lshlrev_b32 v232, 16, v236
  v_and_b32 v233, 0xffff0000, v236
  v_lshlrev_b32 v234, 16, v237
  v_and_b32 v235, 0xffff0000, v237
  v_lshlrev_b32 v236, 16, v238
  v_and_b32 v237, 0xffff0000, v238
  v_lshlrev_b32 v238, 16, v239
  v_and_b32 v239, 0xffff0000, v239
  v_pk_fma_f32 v[252:253], v[232:233], v[232:233], v[252:253]
  v_pk_add_f32 v[250:251], v[250:251], v[232:233]
  v_pk_fma_f32 v[252:253], v[234:235], v[234:235], v[252:253]
  v_pk_add_f32 v[250:251], v[250:251], v[234:235]
  v_pk_fma_f32 v[252:253], v[236:237], v[236:237], v[252:253]
  v_pk_add_f32 v[250:251], v[250:251], v[236:237]
  v_pk_fma_f32 v[252:253], v[238:239], v[238:239], v[252:253]
  buffer_load_dwordx4 v[8:11], v4, s[4:7], s49 offen offset:0 sc1
  buffer_load_dwordx4 v[12:15], v4, s[4:7], s49 offen offset:1024 sc1
  buffer_load_dwordx4 v[16:19], v4, s[4:7], s49 offen offset:2048 sc1
  buffer_load_dwordx4 v[20:23], v4, s[4:7], s49 offen offset:3072 sc1
  buffer_load_dwordx4 v[24:27], v5, s[4:7], s49 offen offset:0 sc1
  buffer_load_dword v28, v31, s[4:7], s50 offen sc1 sc0
  v_pk_add_f32 v[250:251], v[250:251], v[238:239]
  v_add_f32 v248, v250, v251
  v_add_f32 v249, v252, v253
  v_add_f32_dpp v240, v240, v240 row_ror:8 row_mask:0xf bank_mask:0xf
  v_add_f32_dpp v241, v241, v241 row_ror:8 row_mask:0xf bank_mask:0xf
  v_add_f32_dpp v242, v242, v242 row_ror:8 row_mask:0xf bank_mask:0xf
  v_add_f32_dpp v243, v243, v243 row_ror:8 row_mask:0xf bank_mask:0xf
  v_add_f32_dpp v244, v244, v244 row_ror:8 row_mask:0xf bank_mask:0xf
  v_add_f32_dpp v245, v245, v245 row_ror:8 row_mask:0xf bank_mask:0xf
  v_add_f32_dpp v246, v246, v246 row_ror:8 row_mask:0xf bank_mask:0xf
  v_add_f32_dpp v247, v247, v247 row_ror:8 row_mask:0xf bank_mask:0xf
  v_add_f32_dpp v248, v248, v248 row_ror:8 row_mask:0xf bank_mask:0xf
  v_add_f32_dpp v249, v249, v249 row_ror:8 row_mask:0xf bank_mask:0xf
  v_add_f32_dpp v240, v240, v240 row_ror:4 row_mask:0xf bank_mask:0xf
  v_add_f32_dpp v241, v241, v241 row_ror:4 row_mask:0xf bank_mask:0xf
  v_add_f32_dpp v242, v242, v242 row_ror:4 row_mask:0xf bank_mask:0xf
  v_add_f32_dpp v243, v243, v243 row_ror:4 row_mask:0xf bank_mask:0xf
  v_add_f32_dpp v244, v244, v244 row_ror:4 row_mask:0xf bank_mask:0xf
  v_add_f32_dpp v245, v245, v245 row_ror:4 row_mask:0xf bank_mask:0xf
  v_add_f32_dpp v246, v246, v246 row_ror:4 row_mask:0xf bank_mask:0xf
  v_add_f32_dpp v247, v247, v247 row_ror:4 row_mask:0xf bank_mask:0xf
  v_add_f32_dpp v248, v248, v248 row_ror:4 row_mask:0xf bank_mask:0xf
  v_add_f32_dpp v249, v249, v249 row_ror:4 row_mask:0xf bank_mask:0xf
  v_add_f32_dpp v240, v240, v240 row_ror:2 row_mask:0xf bank_mask:0xf
  v_add_f32_dpp v241, v241, v241 row_ror:2 row_mask:0xf bank_mask:0xf
  v_add_f32_dpp v242, v242, v242 row_ror:2 row_mask:0xf bank_mask:0xf
  v_add_f32_dpp v243, v243, v243 row_ror:2 row_mask:0xf bank_mask:0xf
  v_add_f32_dpp v244, v244, v244 row_ror:2 row_mask:0xf bank_mask:0xf
  v_add_f32_dpp v245, v245, v245 row_ror:2 row_mask:0xf bank_mask:0xf
  v_add_f32_dpp v246, v246, v246 row_ror:2 row_mask:0xf bank_mask:0xf
  v_add_f32_dpp v247, v247, v247 row_ror:2 row_mask:0xf bank_mask:0xf
  v_add_f32_dpp v248, v248, v248 row_ror:2 row_mask:0xf bank_mask:0xf
  v_add_f32_dpp v249, v249, v249 row_ror:2 row_mask:0xf bank_mask:0xf
  v_add_f32_dpp v240, v240, v240 row_ror:1 row_mask:0xf bank_mask:0xf
  v_add_f32_dpp v241, v241, v241 row_ror:1 row_mask:0xf bank_mask:0xf
  v_add_f32_dpp v242, v242, v242 row_ror:1 row_mask:0xf bank_mask:0xf
  v_add_f32_dpp v243, v243, v243 row_ror:1 row_mask:0xf bank_mask:0xf
  v_add_f32_dpp v244, v244, v244 row_ror:1 row_mask:0xf bank_mask:0xf
  v_add_f32_dpp v245, v245, v245 row_ror:1 row_mask:0xf bank_mask:0xf
  v_add_f32_dpp v246, v246, v246 row_ror:1 row_mask:0xf bank_mask:0xf
  v_add_f32_dpp v247, v247, v247 row_ror:1 row_mask:0xf bank_mask:0xf
  v_add_f32_dpp v248, v248, v248 row_ror:1 row_mask:0xf bank_mask:0xf
  v_add_f32_dpp v249, v249, v249 row_ror:1 row_mask:0xf bank_mask:0xf
  s_mov_b32 s60, 0x3acccccd
  v_mov_b32 v3, 0x3727c5ac
  v_mul_f32 v250, s60, v240
  v_mul_f32 v251, s60, v242
  v_mul_f32 v252, s60, v244
  v_mul_f32 v253, s60, v246
  v_mul_f32 v254, s60, v248
  v_fma_f32 v241, v241, s60, v3
  v_fma_f32 v243, v243, s60, v3
  v_fma_f32 v245, v245, s60, v3
  v_fma_f32 v247, v247, s60, v3
  v_fma_f32 v249, v249, s60, v3
  v_fma_f32 v241, -v250, v250, v241
  v_fma_f32 v243, -v251, v251, v243
  v_fma_f32 v245, -v252, v252, v245
  v_fma_f32 v247, -v253, v253, v247
  v_fma_f32 v249, -v254, v254, v249
  v_max_f32 v241, v241, v3
  v_max_f32 v243, v243, v3
  v_max_f32 v245, v245, v3
  v_max_f32 v247, v247, v3
  v_max_f32 v249, v249, v3
  v_rsq_f32 v240, v241
  v_rsq_f32 v242, v243
  v_rsq_f32 v244, v245
  v_rsq_f32 v246, v247
  v_rsq_f32 v248, v249
  v_mul_f32 v241, -v250, v240
  v_mul_f32 v243, -v251, v242
  v_mul_f32 v245, -v252, v244
  v_mul_f32 v247, -v253, v246
  v_mul_f32 v249, -v254, v248
  v_pk_fma_f32 v[40:41], v[40:41], v[240:241], v[240:241] op_sel:[0,0,1] op_sel_hi:[1,0,1]
  v_pk_fma_f32 v[42:43], v[42:43], v[240:241], v[240:241] op_sel:[0,0,1] op_sel_hi:[1,0,1]
  v_pk_fma_f32 v[44:45], v[44:45], v[240:241], v[240:241] op_sel:[0,0,1] op_sel_hi:[1,0,1]
  v_pk_fma_f32 v[46:47], v[46:47], v[240:241], v[240:241] op_sel:[0,0,1] op_sel_hi:[1,0,1]
  v_pk_fma_f32 v[48:49], v[48:49], v[240:241], v[240:241] op_sel:[0,0,1] op_sel_hi:[1,0,1]
  v_pk_fma_f32 v[50:51], v[50:51], v[240:241], v[240:241] op_sel:[0,0,1] op_sel_hi:[1,0,1]
  v_pk_fma_f32 v[52:53], v[52:53], v[240:241], v[240:241] op_sel:[0,0,1] op_sel_hi:[1,0,1]
  v_pk_fma_f32 v[54:55], v[54:55], v[240:241], v[240:241] op_sel:[0,0,1] op_sel_hi:[1,0,1]
  v_pk_fma_f32 v[56:57], v[56:57], v[240:241], v[240:241] op_sel:[0,0,1] op_sel_hi:[1,0,1]
  v_pk_fma_f32 v[58:59], v[58:59], v[240:241], v[240:241] op_sel:[0,0,1] op_sel_hi:[1,0,1]
  v_pk_fma_f32 v[60:61], v[60:61], v[240:241], v[240:241] op_sel:[0,0,1] op_sel_hi:[1,0,1]
  v_pk_fma_f32 v[62:63], v[62:63], v[240:241], v[240:241] op_sel:[0,0,1] op_sel_hi:[1,0,1]
  v_pk_fma_f32 v[64:65], v[64:65], v[240:241], v[240:241] op_sel:[0,0,1] op_sel_hi:[1,0,1]
  v_pk_fma_f32 v[66:67], v[66:67], v[240:241], v[240:241] op_sel:[0,0,1] op_sel_hi:[1,0,1]
  v_pk_fma_f32 v[68:69], v[68:69], v[240:241], v[240:241] op_sel:[0,0,1] op_sel_hi:[1,0,1]
  v_pk_fma_f32 v[70:71], v[70:71], v[240:241], v[240:241] op_sel:[0,0,1] op_sel_hi:[1,0,1]
  v_pk_fma_f32 v[72:73], v[72:73], v[240:241], v[240:241] op_sel:[0,0,1] op_sel_hi:[1,0,1]
  v_pk_fma_f32 v[74:75], v[74:75], v[240:241], v[240:241] op_sel:[0,0,1] op_sel_hi:[1,0,1]
  v_pk_fma_f32 v[76:77], v[76:77], v[240:241], v[240:241] op_sel:[0,0,1] op_sel_hi:[1,0,1]
  v_pk_fma_f32 v[78:79], v[78:79], v[240:241], v[240:241] op_sel:[0,0,1] op_sel_hi:[1,0,1]
  v_pk_fma_f32 v[80:81], v[80:81], v[242:243], v[242:243] op_sel:[0,0,1] op_sel_hi:[1,0,1]
  v_pk_fma_f32 v[82:83], v[82:83], v[242:243], v[242:243] op_sel:[0,0,1] op_sel_hi:[1,0,1]
  v_pk_fma_f32 v[84:85], v[84:85], v[242:243], v[242:243] op_sel:[0,0,1] op_sel_hi:[1,0,1]
  v_pk_fma_f32 v[86:87], v[86:87], v[242:243], v[242:243] op_sel:[0,0,1] op_sel_hi:[1,0,1]
  v_pk_fma_f32 v[88:89], v[88:89], v[242:243], v[242:243] op_sel:[0,0,1] op_sel_hi:[1,0,1]
  v_pk_fma_f32 v[90:91], v[90:91], v[242:243], v[242:243] op_sel:[0,0,1] op_sel_hi:[1,0,1]
  v_pk_fma_f32 v[92:93], v[92:93], v[242:243], v[242:243] op_sel:[0,0,1] op_sel_hi:[1,0,1]
  v_pk_fma_f32 v[94:95], v[94:95], v[242:243], v[242:243] op_sel:[0,0,1] op_sel_hi:[1,0,1]
  v_pk_fma_f32 v[96:97], v[96:97], v[242:243], v[242:243] op_sel:[0,0,1] op_sel_hi:[1,0,1]
  v_pk_fma_f32 v[98:99], v[98:99], v[242:243], v[242:243] op_sel:[0,0,1] op_sel_hi:[1,0,1]
  v_pk_fma_f32 v[100:101], v[100:101], v[242:243], v[242:243] op_sel:[0,0,1] op_sel_hi:[1,0,1]
  v_pk_fma_f32 v[102:103], v[102:103], v[242:243], v[242:243] op_sel:[0,0,1] op_sel_hi:[1,0,1]
  v_pk_fma_f32 v[104:105], v[104:105], v[242:243], v[242:243] op_sel:[0,0,1] op_sel_hi:[1,0,1]
  v_pk_fma_f32 v[106:107], v[106:107], v[242:243], v[242:243] op_sel:[0,0,1] op_sel_hi:[1,0,1]
  v_pk_fma_f32 v[108:109], v[108:109], v[242:243], v[242:243] op_sel:[0,0,1] op_sel_hi:[1,0,1]
  v_pk_fma_f32 v[110:111], v[110:111], v[242:243], v[242:243] op_sel:[0,0,1] op_sel_hi:[1,0,1]
  v_pk_fma_f32 v[112:113], v[112:113], v[242:243], v[242:243] op_sel:[0,0,1] op_sel_hi:[1,0,1]
  v_pk_fma_f32 v[114:115], v[114:115], v[242:243], v[242:243] op_sel:[0,0,1] op_sel_hi:[1,0,1]
  v_pk_fma_f32 v[116:117], v[116:117], v[242:243], v[242:243] op_sel:[0,0,1] op_sel_hi:[1,0,1]
  v_pk_fma_f32 v[118:119], v[118:119], v[242:243], v[242:243] op_sel:[0,0,1] op_sel_hi:[1,0,1]
  v_pk_fma_f32 v[120:121], v[120:121], v[244:245], v[244:245] op_sel:[0,0,1] op_sel_hi:[1,0,1]
  v_pk_fma_f32 v[122:123], v[122:123], v[244:245], v[244:245] op_sel:[0,0,1] op_sel_hi:[1,0,1]
  v_pk_fma_f32 v[124:125], v[124:125], v[244:245], v[244:245] op_sel:[0,0,1] op_sel_hi:[1,0,1]
  v_pk_fma_f32 v[126:127], v[126:127], v[244:245], v[244:245] op_sel:[0,0,1] op_sel_hi:[1,0,1]
  v_pk_fma_f32 v[128:129], v[128:129], v[244:245], v[244:245] op_sel:[0,0,1] op_sel_hi:[1,0,1]
  v_pk_fma_f32 v[130:131], v[130:131], v[244:245], v[244:245] op_sel:[0,0,1] op_sel_hi:[1,0,1]
  v_pk_fma_f32 v[132:133], v[132:133], v[244:245], v[244:245] op_sel:[0,0,1] op_sel_hi:[1,0,1]
  v_pk_fma_f32 v[134:135], v[134:135], v[244:245], v[244:245] op_sel:[0,0,1] op_sel_hi:[1,0,1]
  v_pk_fma_f32 v[136:137], v[136:137], v[244:245], v[244:245] op_sel:[0,0,1] op_sel_hi:[1,0,1]
  v_pk_fma_f32 v[138:139], v[138:139], v[244:245], v[244:245] op_sel:[0,0,1] op_sel_hi:[1,0,1]
  v_pk_fma_f32 v[140:141], v[140:141], v[244:245], v[244:245] op_sel:[0,0,1] op_sel_hi:[1,0,1]
  v_pk_fma_f32 v[142:143], v[142:143], v[244:245], v[244:245] op_sel:[0,0,1] op_sel_hi:[1,0,1]
  v_pk_fma_f32 v[144:145], v[144:145], v[244:245], v[244:245] op_sel:[0,0,1] op_sel_hi:[1,0,1]
  v_pk_fma_f32 v[146:147], v[146:147], v[244:245], v[244:245] op_sel:[0,0,1] op_sel_hi:[1,0,1]
  v_pk_fma_f32 v[148:149], v[148:149], v[244:245], v[244:245] op_sel:[0,0,1] op_sel_hi:[1,0,1]
  v_pk_fma_f32 v[150:151], v[150:151], v[244:245], v[244:245] op_sel:[0,0,1] op_sel_hi:[1,0,1]
  v_pk_fma_f32 v[152:153], v[152:153], v[244:245], v[244:245] op_sel:[0,0,1] op_sel_hi:[1,0,1]
  v_pk_fma_f32 v[154:155], v[154:155], v[244:245], v[244:245] op_sel:[0,0,1] op_sel_hi:[1,0,1]
  v_pk_fma_f32 v[156:157], v[156:157], v[244:245], v[244:245] op_sel:[0,0,1] op_sel_hi:[1,0,1]
  v_pk_fma_f32 v[158:159], v[158:159], v[244:245], v[244:245] op_sel:[0,0,1] op_sel_hi:[1,0,1]
  v_pk_fma_f32 v[160:161], v[160:161], v[246:247], v[246:247] op_sel:[0,0,1] op_sel_hi:[1,0,1]
  v_pk_fma_f32 v[162:163], v[162:163], v[246:247], v[246:247] op_sel:[0,0,1] op_sel_hi:[1,0,1]
  v_pk_fma_f32 v[164:165], v[164:165], v[246:247], v[246:247] op_sel:[0,0,1] op_sel_hi:[1,0,1]
  v_pk_fma_f32 v[166:167], v[166:167], v[246:247], v[246:247] op_sel:[0,0,1] op_sel_hi:[1,0,1]
  v_pk_fma_f32 v[168:169], v[168:169], v[246:247], v[246:247] op_sel:[0,0,1] op_sel_hi:[1,0,1]
  v_pk_fma_f32 v[170:171], v[170:171], v[246:247], v[246:247] op_sel:[0,0,1] op_sel_hi:[1,0,1]
  v_pk_fma_f32 v[172:173], v[172:173], v[246:247], v[246:247] op_sel:[0,0,1] op_sel_hi:[1,0,1]
  v_pk_fma_f32 v[174:175], v[174:175], v[246:247], v[246:247] op_sel:[0,0,1] op_sel_hi:[1,0,1]
  v_pk_fma_f32 v[176:177], v[176:177], v[246:247], v[246:247] op_sel:[0,0,1] op_sel_hi:[1,0,1]
  v_pk_fma_f32 v[178:179], v[178:179], v[246:247], v[246:247] op_sel:[0,0,1] op_sel_hi:[1,0,1]
  v_pk_fma_f32 v[180:181], v[180:181], v[246:247], v[246:247] op_sel:[0,0,1] op_sel_hi:[1,0,1]
  v_pk_fma_f32 v[182:183], v[182:183], v[246:247], v[246:247] op_sel:[0,0,1] op_sel_hi:[1,0,1]
  v_pk_fma_f32 v[184:185], v[184:185], v[246:247], v[246:247] op_sel:[0,0,1] op_sel_hi:[1,0,1]
  v_pk_fma_f32 v[186:187], v[186:187], v[246:247], v[246:247] op_sel:[0,0,1] op_sel_hi:[1,0,1]
  v_pk_fma_f32 v[188:189], v[188:189], v[246:247], v[246:247] op_sel:[0,0,1] op_sel_hi:[1,0,1]
  v_pk_fma_f32 v[190:191], v[190:191], v[246:247], v[246:247] op_sel:[0,0,1] op_sel_hi:[1,0,1]
  v_pk_fma_f32 v[192:193], v[192:193], v[246:247], v[246:247] op_sel:[0,0,1] op_sel_hi:[1,0,1]
  v_pk_fma_f32 v[194:195], v[194:195], v[246:247], v[246:247] op_sel:[0,0,1] op_sel_hi:[1,0,1]
  v_pk_fma_f32 v[196:197], v[196:197], v[246:247], v[246:247] op_sel:[0,0,1] op_sel_hi:[1,0,1]
  v_pk_fma_f32 v[198:199], v[198:199], v[246:247], v[246:247] op_sel:[0,0,1] op_sel_hi:[1,0,1]
  v_pk_fma_f32 v[200:201], v[200:201], v[248:249], v[248:249] op_sel:[0,0,1] op_sel_hi:[1,0,1]
  v_pk_fma_f32 v[202:203], v[202:203], v[248:249], v[248:249] op_sel:[0,0,1] op_sel_hi:[1,0,1]
  v_pk_fma_f32 v[204:205], v[204:205], v[248:249], v[248:249] op_sel:[0,0,1] op_sel_hi:[1,0,1]
  v_pk_fma_f32 v[206:207], v[206:207], v[248:249], v[248:249] op_sel:[0,0,1] op_sel_hi:[1,0,1]
  v_pk_fma_f32 v[208:209], v[208:209], v[248:249], v[248:249] op_sel:[0,0,1] op_sel_hi:[1,0,1]
  v_pk_fma_f32 v[210:211], v[210:211], v[248:249], v[248:249] op_sel:[0,0,1] op_sel_hi:[1,0,1]
  v_pk_fma_f32 v[212:213], v[212:213], v[248:249], v[248:249] op_sel:[0,0,1] op_sel_hi:[1,0,1]
  v_pk_fma_f32 v[214:215], v[214:215], v[248:249], v[248:249] op_sel:[0,0,1] op_sel_hi:[1,0,1]
  v_pk_fma_f32 v[216:217], v[216:217], v[248:249], v[248:249] op_sel:[0,0,1] op_sel_hi:[1,0,1]
  v_pk_fma_f32 v[218:219], v[218:219], v[248:249], v[248:249] op_sel:[0,0,1] op_sel_hi:[1,0,1]
  v_pk_fma_f32 v[220:221], v[220:221], v[248:249], v[248:249] op_sel:[0,0,1] op_sel_hi:[1,0,1]
  v_pk_fma_f32 v[222:223], v[222:223], v[248:249], v[248:249] op_sel:[0,0,1] op_sel_hi:[1,0,1]
  v_pk_fma_f32 v[224:225], v[224:225], v[248:249], v[248:249] op_sel:[0,0,1] op_sel_hi:[1,0,1]
  v_pk_fma_f32 v[226:227], v[226:227], v[248:249], v[248:249] op_sel:[0,0,1] op_sel_hi:[1,0,1]
  v_pk_fma_f32 v[228:229], v[228:229], v[248:249], v[248:249] op_sel:[0,0,1] op_sel_hi:[1,0,1]
  v_pk_fma_f32 v[230:231], v[230:231], v[248:249], v[248:249] op_sel:[0,0,1] op_sel_hi:[1,0,1]
  v_pk_fma_f32 v[232:233], v[232:233], v[248:249], v[248:249] op_sel:[0,0,1] op_sel_hi:[1,0,1]
  v_pk_fma_f32 v[234:235], v[234:235], v[248:249], v[248:249] op_sel:[0,0,1] op_sel_hi:[1,0,1]
  v_pk_fma_f32 v[236:237], v[236:237], v[248:249], v[248:249] op_sel:[0,0,1] op_sel_hi:[1,0,1]
  v_pk_fma_f32 v[238:239], v[238:239], v[248:249], v[248:249] op_sel:[0,0,1] op_sel_hi:[1,0,1]
  v_lshrrev_b32 v3, 2, v1
  v_lshlrev_b32 v3, 10, v3
  v_and_b32 v33, 3, v1
  v_lshl_add_u32 v3, v33, 8, v3
  v_and_b32 v33, 7, v1
  s_movk_i32 s52, 20480
  v_add_u32 v35, s79, v2
  s_bfe_u32 s3, s73, 0x40000
  v_lshl_add_u32 v36, s3, 2, v35
  v_and_b32 v37, 15, v36
  v_xor_b32 v37, v37, v33
  v_lshrrev_b32 v36, 4, v36
  v_mad_u32_u24 v36, v36, s52, v3
  v_lshl_add_u32 v250, v37, 4, v36
  s_bfe_u32 s3, s73, 0x40004
  v_lshl_add_u32 v36, s3, 2, v35
  v_and_b32 v37, 15, v36
  v_xor_b32 v37, v37, v33
  v_lshrrev_b32 v36, 4, v36
  v_mad_u32_u24 v36, v36, s52, v3
  v_lshl_add_u32 v251, v37, 4, v36
  s_bfe_u32 s3, s73, 0x40008
  v_lshl_add_u32 v36, s3, 2, v35
  v_and_b32 v37, 15, v36
  v_xor_b32 v37, v37, v33
  v_lshrrev_b32 v36, 4, v36
  v_mad_u32_u24 v36, v36, s52, v3
  v_lshl_add_u32 v252, v37, 4, v36
  s_bfe_u32 s3, s73, 0x4000c
  v_lshl_add_u32 v36, s3, 2, v35
  v_and_b32 v37, 15, v36
  v_xor_b32 v37, v37, v33
  v_lshrrev_b32 v36, 4, v36
  v_mad_u32_u24 v36, v36, s52, v3
  v_lshl_add_u32 v253, v37, 4, v36
  s_bfe_u32 s3, s73, 0x40010
  v_lshl_add_u32 v36, s3, 2, v35
  v_and_b32 v37, 15, v36
  v_xor_b32 v37, v37, v33
  v_lshrrev_b32 v36, 4, v36
  v_mad_u32_u24 v36, v36, s52, v3
  v_lshl_add_u32 v254, v37, 4, v36
  v_lshlrev_b32 v255, 5, v1
  v_add_u32 v255, 147456, v255
  s_mul_i32 s52, s21, 5
  s_add_u32 s53, s52, s22
  s_add_u32 s32, s53, 40
  s_add_u32 s33, s53, 80
  s_mov_b32 s35, s53
  s_lshl_b32 s54, s22, 3
  s_lshr_b32 s34, 0x04542c, s54
  s_and_b32 s34, s34, 0xff
  s_add_u32 s34, s34, s52
  s_mul_i32 s32, s32, 20480
  s_add_u32 s32, s32, 1048576
  s_mul_i32 s33, s33, 20480
  s_add_u32 s33, s33, 1048576
  s_mul_i32 s34, s34, 20480
  s_add_u32 s34, s34, 1048576
  s_mul_i32 s35, s35, 20480
  s_add_u32 s35, s35, 1048576
  s_mov_b64 s[12:13], s[4:5]
  s_cmp_eq_u32 s22, 3
  s_cselect_b32 s14, 0, s6
  s_mov_b32 s15, 0x20000
  s_waitcnt vmcnt(0)
  s_branch JOIN
MSPIN:
  s_mov_b32 s72, 0x8000
MSPINL:
  s_andn2_b64 exec, exec, vcc
  buffer_load_dwordx4 v[8:11], v4, s[4:7], s49 offen offset:0 sc1
  buffer_load_dwordx4 v[12:15], v4, s[4:7], s49 offen offset:1024 sc1
  buffer_load_dwordx4 v[16:19], v4, s[4:7], s49 offen offset:2048 sc1
  buffer_load_dwordx4 v[20:23], v4, s[4:7], s49 offen offset:3072 sc1
  buffer_load_dwordx4 v[24:27], v5, s[4:7], s49 offen offset:0 sc1
  s_waitcnt vmcnt(0)
  v_xor_b32 v29, s48, v8
  v_bitop3_b32 v29, v29, s48, v9 bitop3:0xf6
  v_bitop3_b32 v29, v29, s48, v10 bitop3:0xf6
  v_bitop3_b32 v29, v29, s48, v11 bitop3:0xf6
  v_bitop3_b32 v29, v29, s48, v12 bitop3:0xf6
  v_bitop3_b32 v29, v29, s48, v13 bitop3:0xf6
  v_bitop3_b32 v29, v29, s48, v14 bitop3:0xf6
  v_bitop3_b32 v29, v29, s48, v15 bitop3:0xf6
  v_bitop3_b32 v29, v29, s48, v16 bitop3:0xf6
  v_bitop3_b32 v29, v29, s48, v17 bitop3:0xf6
  v_bitop3_b32 v29, v29, s48, v18 bitop3:0xf6
  v_bitop3_b32 v29, v29, s48, v19 bitop3:0xf6
  v_bitop3_b32 v29, v29, s48, v20 bitop3:0xf6
  v_bitop3_b32 v29, v29, s48, v21 bitop3:0xf6
  v_bitop3_b32 v29, v29, s48, v22 bitop3:0xf6
  v_bitop3_b32 v29, v29, s48, v23 bitop3:0xf6
  v_bitop3_b32 v29, v29, s48, v24 bitop3:0xf6
  v_bitop3_b32 v29, v29, s48, v25 bitop3:0xf6
  v_bitop3_b32 v29, v29, s48, v26 bitop3:0xf6
  v_bitop3_b32 v29, v29, s48, v27 bitop3:0xf6
  v_lshlrev_b32 v29, 22, v29
  v_cmp_eq_u32 vcc, 0, v29
  s_sub_u32 s72, s72, 1
  s_cbranch_scc1 MOUT
  s_nop 1
  s_cmp_eq_u64 vcc, exec
  s_cbranch_scc0 MSPINL
  s_mov_b64 exec, -1
  buffer_load_dwordx4 v[8:11], v4, s[4:7], s49 offen offset:0 sc1
  buffer_load_dwordx4 v[12:15], v4, s[4:7], s49 offen offset:1024 sc1
  buffer_load_dwordx4 v[16:19], v4, s[4:7], s49 offen offset:2048 sc1
  buffer_load_dwordx4 v[20:23], v4, s[4:7], s49 offen offset:3072 sc1
  buffer_load_dwordx4 v[24:27], v5, s[4:7], s49 offen offset:0 sc1
  s_waitcnt vmcnt(0)
  v_xor_b32 v29, s48, v8
  v_bitop3_b32 v29, v29, s48, v9 bitop3:0xf6
  v_bitop3_b32 v29, v29, s48, v10 bitop3:0xf6
  v_bitop3_b32 v29, v29, s48, v11 bitop3:0xf6
  v_bitop3_b32 v29, v29, s48, v12 bitop3:0xf6
  v_bitop3_b32 v29, v29, s48, v13 bitop3:0xf6
  v_bitop3_b32 v29, v29, s48, v14 bitop3:0xf6
  v_bitop3_b32 v29, v29, s48, v15 bitop3:0xf6
  v_bitop3_b32 v29, v29, s48, v16 bitop3:0xf6
  v_bitop3_b32 v29, v29, s48, v17 bitop3:0xf6
  v_bitop3_b32 v29, v29, s48, v18 bitop3:0xf6
  v_bitop3_b32 v29, v29, s48, v19 bitop3:0xf6
  v_bitop3_b32 v29, v29, s48, v20 bitop3:0xf6
  v_bitop3_b32 v29, v29, s48, v21 bitop3:0xf6
  v_bitop3_b32 v29, v29, s48, v22 bitop3:0xf6
  v_bitop3_b32 v29, v29, s48, v23 bitop3:0xf6
  v_bitop3_b32 v29, v29, s48, v24 bitop3:0xf6
  v_bitop3_b32 v29, v29, s48, v25 bitop3:0xf6
  v_bitop3_b32 v29, v29, s48, v26 bitop3:0xf6
  v_bitop3_b32 v29, v29, s48, v27 bitop3:0xf6
  v_lshlrev_b32 v29, 22, v29
  v_cmp_eq_u32 vcc, 0, v29
  s_nop 3
  s_cmp_eq_u64 vcc, -1
  s_cbranch_scc0 MSPINL
MOUT:
  s_mov_b64 exec, -1
  s_branch MDONE
FASPIN:
  s_mov_b32 s72, 0x8000
FASPINL:
  s_andn2_b64 exec, exec, vcc
  buffer_load_dword v28, v31, s[4:7], s50 offen sc1 sc0
  s_waitcnt vmcnt(0)
  v_cmp_eq_u32 vcc, s24, v28
  s_sub_u32 s72, s72, 1
  s_cbranch_scc1 FAOUT
  s_nop 1
  s_cmp_eq_u64 vcc, exec
  s_cbranch_scc0 FASPINL
FAOUT:
  s_mov_b64 exec, -1
  s_branch FADONE
WOSPIN:
  s_mov_b32 s72, 0x8000
WOSPINL:
  s_andn2_b64 exec, exec, vcc
  buffer_load_dword v247, v250, s[4:7], 0 offen offset:2048 sc1 sc0
  s_waitcnt vmcnt(0)
  v_cmp_eq_u32 vcc, s24, v247
  s_sub_u32 s72, s72, 1
  s_cbranch_scc1 WOOUT
  s_nop 1
  s_cmp_eq_u64 vcc, exec
  s_cbranch_scc0 WOSPINL
WOOUT:
  s_mov_b64 exec, -1
  s_branch WODONE
FBSPIN:
  s_mov_b32 s72, 0x8000
FBSPINL:
  s_andn2_b64 exec, exec, vcc
  buffer_load_dword v232, v233, s[4:7], s51 offen sc1 sc0
  s_waitcnt vmcnt(0)
  v_subrev_u32 v232, s24, v232
  v_cmp_gt_u32 vcc, 16, v232
  s_sub_u32 s72, s72, 1
  s_cbranch_scc1 FBOUT
  s_nop 1
  s_cmp_eq_u64 vcc, exec
  s_cbranch_scc0 FBSPINL
FBOUT:
  s_mov_b64 exec, -1
  s_branch FBDONE
SLOW1:
  buffer_store_dwordx4 v[80:83], v4, s[4:7], s57 offen sc1
  buffer_store_dwordx4 v[84:87], v4, s[4:7], s57 offen offset:1024 sc1
  buffer_store_dwordx2 v[88:89], v4, s[4:7], s58 offen sc1
  s_branch RET1
M2SPIN:
  s_mov_b32 s72, 0x8000
M2SPINL:
  s_andn2_b64 exec, exec, vcc
  buffer_load_dwordx4 v[228:231], v252, s[4:7], s63 offen sc1
  buffer_load_dwordx4 v[208:211], v254, s[4:7], s63 offen offset:0 sc1
  buffer_load_dwordx4 v[212:215], v254, s[4:7], s63 offen offset:512 sc1
  buffer_load_dwordx4 v[216:219], v254, s[4:7], s63 offen offset:1280 sc1
  buffer_load_dwordx4 v[220:223], v254, s[4:7], s63 offen offset:1792 sc1
  buffer_load_dwordx4 v[224:227], v255, s[4:7], s63 offen offset:1024 sc1
  s_waitcnt vmcnt(0)
  v_xor_b32 v232, s3, v208
  v_bitop3_b32 v232, v232, s3, v209 bitop3:0xf6
  v_bitop3_b32 v232, v232, s3, v210 bitop3:0xf6
  v_bitop3_b32 v232, v232, s3, v211 bitop3:0xf6
  v_bitop3_b32 v232, v232, s3, v212 bitop3:0xf6
  v_bitop3_b32 v232, v232, s3, v213 bitop3:0xf6
  v_bitop3_b32 v232, v232, s3, v214 bitop3:0xf6
  v_bitop3_b32 v232, v232, s3, v215 bitop3:0xf6
  v_bitop3_b32 v232, v232, s3, v216 bitop3:0xf6
  v_bitop3_b32 v232, v232, s3, v217 bitop3:0xf6
  v_bitop3_b32 v232, v232, s3, v218 bitop3:0xf6
  v_bitop3_b32 v232, v232, s3, v219 bitop3:0xf6
  v_bitop3_b32 v232, v232, s3, v220 bitop3:0xf6
  v_bitop3_b32 v232, v232, s3, v221 bitop3:0xf6
  v_bitop3_b32 v232, v232, s3, v222 bitop3:0xf6
  v_bitop3_b32 v232, v232, s3, v223 bitop3:0xf6
  v_bitop3_b32 v232, v232, s3, v224 bitop3:0xf6
  v_bitop3_b32 v232, v232, s3, v225 bitop3:0xf6
  v_bitop3_b32 v232, v232, s3, v226 bitop3:0xf6
  v_bitop3_b32 v232, v232, s3, v227 bitop3:0xf6
  v_bitop3_b32 v232, v232, s3, v228 bitop3:0xf6
  v_bitop3_b32 v232, v232, s3, v229 bitop3:0xf6
  v_bitop3_b32 v232, v232, s3, v230 bitop3:0xf6
  v_bitop3_b32 v232, v232, s3, v231 bitop3:0xf6
  v_lshlrev_b32 v232, 22, v232
  v_cmp_eq_u32 vcc, 0, v232
  s_sub_u32 s72, s72, 1
  s_cbranch_scc1 M2OUT
  s_nop 1
  s_cmp_eq_u64 vcc, exec
  s_cbranch_scc0 M2SPINL
  s_mov_b64 exec, -1
  buffer_load_dwordx4 v[228:231], v252, s[4:7], s63 offen sc1
  buffer_load_dwordx4 v[208:211], v254, s[4:7], s63 offen offset:0 sc1
  buffer_load_dwordx4 v[212:215], v254, s[4:7], s63 offen offset:512 sc1
  buffer_load_dwordx4 v[216:219], v254, s[4:7], s63 offen offset:1280 sc1
  buffer_load_dwordx4 v[220:223], v254, s[4:7], s63 offen offset:1792 sc1
  buffer_load_dwordx4 v[224:227], v255, s[4:7], s63 offen offset:1024 sc1
  s_waitcnt vmcnt(0)
  v_xor_b32 v232, s3, v208
  v_bitop3_b32 v232, v232, s3, v209 bitop3:0xf6
  v_bitop3_b32 v232, v232, s3, v210 bitop3:0xf6
  v_bitop3_b32 v232, v232, s3, v211 bitop3:0xf6
  v_bitop3_b32 v232, v232, s3, v212 bitop3:0xf6
  v_bitop3_b32 v232, v232, s3, v213 bitop3:0xf6
  v_bitop3_b32 v232, v232, s3, v214 bitop3:0xf6
  v_bitop3_b32 v232, v232, s3, v215 bitop3:0xf6
  v_bitop3_b32 v232, v232, s3, v216 bitop3:0xf6
  v_bitop3_b32 v232, v232, s3, v217 bitop3:0xf6
  v_bitop3_b32 v232, v232, s3, v218 bitop3:0xf6
  v_bitop3_b32 v232, v232, s3, v219 bitop3:0xf6
  v_bitop3_b32 v232, v232, s3, v220 bitop3:0xf6
  v_bitop3_b32 v232, v232, s3, v221 bitop3:0xf6
  v_bitop3_b32 v232, v232, s3, v222 bitop3:0xf6
  v_bitop3_b32 v232, v232, s3, v223 bitop3:0xf6
  v_bitop3_b32 v232, v232, s3, v224 bitop3:0xf6
  v_bitop3_b32 v232, v232, s3, v225 bitop3:0xf6
  v_bitop3_b32 v232, v232, s3, v226 bitop3:0xf6
  v_bitop3_b32 v232, v232, s3, v227 bitop3:0xf6
  v_bitop3_b32 v232, v232, s3, v228 bitop3:0xf6
  v_bitop3_b32 v232, v232, s3, v229 bitop3:0xf6
  v_bitop3_b32 v232, v232, s3, v230 bitop3:0xf6
  v_bitop3_b32 v232, v232, s3, v231 bitop3:0xf6
  v_lshlrev_b32 v232, 22, v232
  v_cmp_eq_u32 vcc, 0, v232
  s_nop 3
  s_cmp_eq_u64 vcc, -1
  s_cbranch_scc0 M2SPINL
M2OUT:
  s_mov_b64 exec, -1
  s_branch M2DONE
SLOW2:
  buffer_store_dword v3, off, s[4:7], s26 sc1
  s_branch RET2
SPIN3:
  s_mov_b32 s72, 0x8000
SPINL3:
  buffer_load_dword v3, v9, s[4:7], s27 offen sc1
  s_waitcnt vmcnt(0)
  v_subrev_u32 v3, s24, v3
  v_add_u32 v3, -1, v3
  v_cmp_gt_u32 vcc, 8, v3
  s_sub_u32 s72, s72, 1
  s_cbranch_scc1 PDONE3
  s_cmp_eq_u64 vcc, -1
  s_cbranch_scc0 SPINL3
  s_branch PDONE3
SLOW4:
  buffer_store_dwordx4 v[80:83], v4, s[4:7], s57 offen sc1
  buffer_store_dwordx4 v[84:87], v4, s[4:7], s57 offen offset:1024 sc1
  buffer_store_dwordx2 v[88:89], v4, s[4:7], s58 offen sc1
  s_branch RET4
SLOW5:
  s_mov_b64 exec, 0xffff
  buffer_store_dwordx2 v[24:25], v38, s[4:7], s59 offen sc1
  s_mov_b64 exec, -1
  s_branch RET5
SLOW6:
  buffer_store_dword v3, off, s[4:7], s26 sc1
  s_branch RET6
SPIN7:
  s_mov_b32 s72, 0x8000
SPINL7:
  buffer_load_dword v3, v9, s[4:7], s27 offen sc1
  s_waitcnt vmcnt(0)
  v_subrev_u32 v3, s24, v3
  v_add_u32 v3, -2, v3
  v_cmp_gt_u32 vcc, 8, v3
  s_sub_u32 s72, s72, 1
  s_cbranch_scc1 PDONE7
  s_cmp_eq_u64 vcc, -1
  s_cbranch_scc0 SPINL7
  s_branch PDONE7
SLOW8:
  buffer_store_dwordx4 v[112:115], v4, s[4:7], s52 offen sc1
  buffer_store_dwordx2 v[116:117], v4, s[4:7], s53 offen sc1
  s_branch RET8
SLOW9:
  buffer_store_dword v3, off, s[4:7], s26 sc1
  s_branch RET9
SLOW10:
  buffer_store_dwordx4 v[112:115], v4, s[4:7], s52 offen sc1
  buffer_store_dwordx2 v[116:117], v4, s[4:7], s53 offen sc1
  s_branch RET10
SPIN11:
  s_mov_b32 s72, 0x8000
SPINL11:
  buffer_load_dword v3, v20, s[4:7], s29 offen sc1
  s_waitcnt vmcnt(0)
  v_subrev_u32 v3, s24, v3
  v_add_u32 v3, -3, v3
  v_cmp_gt_u32 vcc, 8, v3
  s_sub_u32 s72, s72, 1
  s_cbranch_scc1 PDONE11
  s_cmp_eq_u64 vcc, -1
  s_cbranch_scc0 SPINL11
  s_branch PDONE11
SLOW12:
  buffer_store_dword v3, off, s[4:7], s26 sc1
  s_branch RET12
SLOW13:
  buffer_store_dwordx4 v[112:115], v4, s[4:7], s52 offen sc1
  buffer_store_dwordx2 v[116:117], v4, s[4:7], s53 offen sc1
  s_branch RET13
SPIN14:
  s_mov_b32 s72, 0x8000
SPINL14:
  buffer_load_dword v3, v9, s[4:7], s27 offen sc1
  s_waitcnt vmcnt(0)
  v_subrev_u32 v3, s24, v3
  v_add_u32 v3, -4, v3
  v_cmp_gt_u32 vcc, 8, v3
  s_sub_u32 s72, s72, 1
  s_cbranch_scc1 PDONE14
  s_cmp_eq_u64 vcc, -1
  s_cbranch_scc0 SPINL14
  s_branch PDONE14
SLOW15:
  buffer_store_dword v3, off, s[4:7], s26 sc1
  s_branch RET15
SLOW16:
  buffer_store_dwordx4 v[112:115], v4, s[4:7], s52 offen sc1
  buffer_store_dwordx2 v[116:117], v4, s[4:7], s53 offen sc1
  s_branch RET16
SPIN17:
  s_mov_b32 s72, 0x8000
SPINL17:
  buffer_load_dword v3, v9, s[4:7], s27 offen sc1
  s_waitcnt vmcnt(0)
  v_subrev_u32 v3, s24, v3
  v_add_u32 v3, -5, v3
  v_cmp_gt_u32 vcc, 8, v3
  s_sub_u32 s72, s72, 1
  s_cbranch_scc1 PDONE17
  s_cmp_eq_u64 vcc, -1
  s_cbranch_scc0 SPINL17
  s_branch PDONE17
SLOW18:
  buffer_store_dword v3, off, s[4:7], s26 sc1
  s_branch RET18
SPIN19:
  s_mov_b32 s72, 0x8000
SPINL19:
  buffer_load_dword v3, v9, s[4:7], s27 offen sc1
  s_waitcnt vmcnt(0)
  v_subrev_u32 v3, s24, v3
  v_add_u32 v3, -6, v3
  v_cmp_gt_u32 vcc, 8, v3
  s_sub_u32 s72, s72, 1
  s_cbranch_scc1 PDONE19
  s_cmp_eq_u64 vcc, -1
  s_cbranch_scc0 SPINL19
  s_branch PDONE19
WBL:
  buffer_wbl2 sc1
  s_branch WBR
CODE_END:
.section .rodata,"a"
.p2align 6
.amdhsa_kernel adaLN_cond__sliding_local_dilated__dense_activation_silu__prompt_kernel
  .amdhsa_next_free_vgpr 512
  .amdhsa_next_free_sgpr 102
  .amdhsa_accum_offset 256
  .amdhsa_group_segment_fixed_size 0
  .amdhsa_kernarg_size 88
  .amdhsa_user_sgpr_count 2
  .amdhsa_user_sgpr_kernarg_segment_ptr 1
  .amdhsa_system_sgpr_workgroup_id_x 1
.end_amdhsa_kernel
```
